```python
import torch

def _softmax(x, axis=-1):
    return torch.softmax(x, dim=axis)
def _gelu(x):
    return torch.nn.functional.gelu(x, approximate="tanh")
def _silu(x):
    return torch.nn.functional.silu(x)
def _sigmoid(x):
    return torch.sigmoid(x)
def _layernorm(x, axis=-1, eps=1e-5):
    m = x.mean(dim=axis, keepdim=True)
    v = x.var(dim=axis, keepdim=True, unbiased=False)
    return (x - m) / torch.sqrt(v + eps)
def _scatter_add(tgt, idx, src, axis=0):
    return tgt.clone().index_add_(axis, idx, src)
def _segment_sum(src, seg, n):
    out = torch.zeros((n,) + src.shape[1:], dtype=src.dtype)
    return out.index_add_(0, seg, src)
def _pad(x, pw):
    flat = tuple(v for pair in reversed(pw) for v in pair)
    return torch.nn.functional.pad(x, flat)

kernel_name = 'parallel_sum__sliding_block__dense_activation_gelu__prompt'

def setup_inputs():

    _w = (lambda a: (lambda t: t.to(torch.bfloat16) if t.is_floating_point() else t)(torch.as_tensor(a)))
    def _A_setup():
        B, S, D = 1, 2048, 1024
        return {
            "x": _w((lambda *s: torch.randn(*s, dtype=torch.bfloat16) * 0.05)(B, S, D)),
            "wqkv": _w((lambda *s: torch.randn(*s, dtype=torch.bfloat16) * 0.05)(D, 3 * D)),
            "wo": _w((lambda *s: torch.randn(*s, dtype=torch.bfloat16) * 0.05)(D, D)),
        }
    _A_in = _A_setup()

    def _B_setup():
        B, S, D, F = 1, 2048, 1024, 3584
        return {
            "x": _w((lambda *s: torch.randn(*s, dtype=torch.bfloat16) * 0.05)(B, S, D)),
            "w1": _w((lambda *s: torch.randn(*s, dtype=torch.bfloat16) * 3.2)(D, F) * (D ** -0.5)),
            "b1": _w((lambda *s: torch.randn(*s, dtype=torch.bfloat16) * 3.2)(F) * 0.01),
            "w2": _w((lambda *s: torch.randn(*s, dtype=torch.bfloat16) * 0.4)(F, D) * (F ** -0.5)),
            "b2": _w((lambda *s: torch.randn(*s, dtype=torch.bfloat16) * 0.4)(D) * 0.01),
        }
    _B_in = _B_setup()

    return {
        "A_x": _A_in["x"],
        "A_wqkv": _A_in["wqkv"],
        "A_wo": _A_in["wo"],
        "B_x": _B_in["x"],
        "B_w1": _B_in["w1"],
        "B_b1": _B_in["b1"],
        "B_w2": _B_in["w2"],
        "B_b2": _B_in["b2"],
    }

def reference(A_x, A_wqkv, A_wo, B_x, B_w1, B_b1, B_w2, B_b2):
    def _A_ref(x, wqkv, wo):
        B, S, D = x.shape
        H = 32; Dh = D // H; W = 256
        qkv = (lambda x, *d: x.permute(*d))((x @ wqkv).reshape(B, S, 3, H, Dh), 2, 0, 3, 1, 4)
        q, k, v = qkv[0], qkv[1], qkv[2]
        scores = torch.einsum("bhqd,bhkd->bhqk", q, k) * (Dh ** -0.5)
        idx = torch.arange(S)
        mask = (idx[:, None] - idx[None, :] >= 0) & (idx[:, None] - idx[None, :] < W)
        scores = torch.where(mask[None, None], scores, -1e9)
        p = _softmax(scores, axis=-1)
        o = torch.einsum("bhqk,bhkd->bhqd", p, v)
        return (lambda x, *d: x.permute(*d))(o, 0, 2, 1, 3).reshape(B, S, D) @ wo

    def _B_ref(x, w1, b1, w2, b2):
        h = torch.einsum("bsd,df->bsf", x, w1) + b1
        h = _gelu(h)
        return torch.einsum("bsf,fd->bsd", h, w2) + b2

    x = A_x
    xn = _layernorm(x, axis=-1)
    return x + _A_ref(xn, A_wqkv, A_wo) + _B_ref(xn, B_w1, B_b1, B_w2, B_b2)
```

```asm
; @launch grid=(256,1,1) block=(256,1,1) lds=131072
.amdgcn_target "amdgcn-amd-amdhsa--gfx950"
.text
.globl parallel_sum__sliding_block__dense_activation_gelu__prompt_kernel
.p2align 8
.type parallel_sum__sliding_block__dense_activation_gelu__prompt_kernel,@function
parallel_sum__sliding_block__dense_activation_gelu__prompt_kernel:
  s_cmp_ge_u32 s2, 256
  s_cbranch_scc1 L_end
  s_load_dwordx16 s[40:55], s[0:1], 0
  s_load_dwordx4 s[56:59], s[0:1], 64
  s_load_dwordx2 s[60:61], s[0:1], 80
  v_lshrrev_b32 v16, 6, v0
  v_and_b32 v17, 63, v0
  v_readfirstlane_b32 s30, v16
  s_and_b32 s3, s2, 7
  s_lshr_b32 s31, s2, 3
  s_and_b32 s32, s31, 3
  s_lshl_b32 s28, s3, 2
  s_add_u32 s28, s28, s32
  s_lshr_b32 s29, s31, 2
  s_lshl_b32 s70, s29, 5
  s_add_u32 s70, s70, s28
  s_getpc_b64 s[78:79]
L_pc:
  s_lshl_b32 s32, s31, 1
  s_add_u32 s32, s32, s30
  s_sub_u32 s32, s32, 2
  s_lshl_b32 s32, s32, 10
  s_cmp_lt_u32 s30, 2
  s_cbranch_scc1 L_cpf1
  s_cmp_gt_u32 s32, L_end - L_pc - 1024
  s_cbranch_scc1 L_cpf1
  v_lshlrev_b32 v30, 4, v17
  v_add_u32 v30, s32, v30
  global_load_dwordx4 a[248:251], v30, s[78:79]
L_cpf1:
  v_and_b32 v18, 3, v17
  v_lshrrev_b32 v19, 2, v17
  v_lshlrev_b32 v20, 11, v18
  v_lshl_add_u32 v20, v19, 4, v20
  s_lshl_b32 s33, s70, 14
  s_lshl_b32 s32, s30, 13
  s_add_u32 s33, s33, s32
  s_mov_b32 s6, 0x400000
  s_mov_b32 s7, 0x20000
  s_waitcnt lgkmcnt(0)
  s_mov_b32 s4, s40
  s_mov_b32 s5, s41
  s_mov_b32 s64, s58
  s_mov_b32 s65, s59
  s_mov_b32 s66, 256
  s_mov_b32 s67, 0x20000
  s_cmp_ge_u32 s30, 2
  s_cbranch_scc1 L_nox2
  buffer_load_dwordx4 v[48:51], v20, s[4:7], s33 offen offset:0
  buffer_load_dwordx4 v[52:55], v20, s[4:7], s33 offen offset:256
  buffer_load_dwordx4 v[56:59], v20, s[4:7], s33 offen offset:512
  buffer_load_dwordx4 v[60:63], v20, s[4:7], s33 offen offset:768
  buffer_load_dwordx4 v[64:67], v20, s[4:7], s33 offen offset:1024
  buffer_load_dwordx4 v[68:71], v20, s[4:7], s33 offen offset:1280
  buffer_load_dwordx4 v[72:75], v20, s[4:7], s33 offen offset:1536
  buffer_load_dwordx4 v[76:79], v20, s[4:7], s33 offen offset:1792
L_nox2:
  s_xor_b32 s32, s30, 3
  s_or_b32 s32, s2, s32
  s_cmp_lg_u32 s32, 0
  s_cbranch_scc1 L_non3
  s_memrealtime s[78:79]
  s_waitcnt lgkmcnt(0)
  s_or_b32 s78, s78, 1
  v_mov_b32 v24, s78
  v_mov_b32 v25, s79
  s_mov_b64 exec, 1
  buffer_store_dwordx2 v[24:25], off, s[64:67], 0 sc1
  s_mov_b64 exec, -1
L_non3:
  s_and_b32 s62, s28, 1
  s_lshr_b32 s32, s3, 1
  s_lshl_b32 s68, s32, 2
  s_lshr_b32 s32, s31, 3
  s_add_u32 s68, s68, s32
  s_and_b32 s32, s31, 7
  s_lshl_b32 s69, s32, 1
  s_and_b32 s32, s3, 1
  s_add_u32 s69, s69, s32
  s_mov_b32 s12, s42
  s_mov_b32 s13, s43
  s_mov_b32 s14, 6291456
  s_mov_b32 s15, 0x20000
  s_mov_b32 s16, s48
  s_mov_b32 s17, s49
  s_mov_b32 s18, 7340032
  s_mov_b32 s19, 0x20000
  v_and_b32 v28, 1, v17
  v_lshrrev_b32 v29, 1, v17
  s_movk_i32 s37, 43
  s_movk_i32 s38, 6144
  s_lshl_b32 s39, s28, 6
  v_add_u32 v20, 0, v29
  v_mul_u32_u24 v21, s37, v20
  v_lshrrev_b32 v21, 8, v21
  v_mul_u32_u24 v22, 6, v21
  v_sub_u32 v22, v20, v22
  v_bfe_u32 v23, v21, 3, 1
  v_xor_b32 v22, v22, v23
  v_mul_u32_u24 v30, s38, v21
  v_lshrrev_b32 v23, 1, v22
  v_lshl_add_u32 v30, v23, 11, v30
  v_and_b32 v23, 1, v22
  v_lshl_add_u32 v30, v23, 5, v30
  v_lshl_add_u32 v30, v28, 4, v30
  v_add_u32 v3, s39, v30
  v_add_u32 v20, 32, v29
  v_mul_u32_u24 v21, s37, v20
  v_lshrrev_b32 v21, 8, v21
  v_mul_u32_u24 v22, 6, v21
  v_sub_u32 v22, v20, v22
  v_bfe_u32 v23, v21, 3, 1
  v_xor_b32 v22, v22, v23
  v_mul_u32_u24 v30, s38, v21
  v_lshrrev_b32 v23, 1, v22
  v_lshl_add_u32 v30, v23, 11, v30
  v_and_b32 v23, 1, v22
  v_lshl_add_u32 v30, v23, 5, v30
  v_lshl_add_u32 v30, v28, 4, v30
  v_add_u32 v4, s39, v30
  v_add_u32 v20, 64, v29
  v_mul_u32_u24 v21, s37, v20
  v_lshrrev_b32 v21, 8, v21
  v_mul_u32_u24 v22, 6, v21
  v_sub_u32 v22, v20, v22
  v_bfe_u32 v23, v21, 3, 1
  v_xor_b32 v22, v22, v23
  v_mul_u32_u24 v30, s38, v21
  v_lshrrev_b32 v23, 1, v22
  v_lshl_add_u32 v30, v23, 11, v30
  v_and_b32 v23, 1, v22
  v_lshl_add_u32 v30, v23, 5, v30
  v_lshl_add_u32 v30, v28, 4, v30
  v_add_u32 v5, s39, v30
  s_movk_i32 s37, 37
  s_movk_i32 s38, 7168
  s_mul_i32 s39, s28, 224
  v_mov_b32 v47, 0x40000000
  v_subrev_u32 v20, 0, v29
  v_cmp_gt_u32 vcc, 28, v20
  v_mul_u32_u24 v21, s37, v20
  v_lshrrev_b32 v21, 8, v21
  v_mul_u32_u24 v22, 7, v21
  v_sub_u32 v22, v20, v22
  v_add_u32 v22, s62, v22
  v_cmp_eq_u32 s[76:77], 7, v22
  v_mul_u32_u24 v30, s38, v21
  s_nop 0
  v_cndmask_b32 v22, v22, 0, s[76:77]
  v_lshl_add_u32 v30, v22, 5, v30
  v_lshl_add_u32 v30, v28, 4, v30
  v_add_u32 v30, s39, v30
  v_add_u32 v31, 0, v30
  v_cndmask_b32 v6, v47, v31, vcc
  v_add_u32 v31, 28672, v30
  v_cndmask_b32 v7, v47, v31, vcc
  v_subrev_u32 v20, 4, v29
  v_cmp_gt_u32 vcc, 28, v20
  v_mul_u32_u24 v21, s37, v20
  v_lshrrev_b32 v21, 8, v21
  v_mul_u32_u24 v22, 7, v21
  v_sub_u32 v22, v20, v22
  v_add_u32 v22, s62, v22
  v_cmp_eq_u32 s[76:77], 7, v22
  v_mul_u32_u24 v30, s38, v21
  s_nop 0
  v_cndmask_b32 v22, v22, 0, s[76:77]
  v_lshl_add_u32 v30, v22, 5, v30
  v_lshl_add_u32 v30, v28, 4, v30
  v_add_u32 v30, s39, v30
  v_add_u32 v31, 57344, v30
  v_cndmask_b32 v8, v47, v31, vcc
  v_add_u32 v31, 86016, v30
  v_cndmask_b32 v9, v47, v31, vcc
  s_and_b32 s31, s29, 7
  s_mul_i32 s33, s31, 786432
  s_mul_i32 s34, s31, 917504
  s_lshl_b32 s31, s31, 14
  s_cmp_lt_u32 s30, 2
  s_cbranch_scc1 L_nob4
  s_sub_u32 s3, s30, 2
L_bpass5:
  s_add_u32 s32, s3, s29
  s_and_b32 s32, s32, 7
  s_mul_i32 s76, s32, 786432
  s_mul_i32 s77, s32, 917504
  s_mul_i32 s32, s3, 28672
  s_mov_b32 s37, s32
  s_add_u32 m0, s32, 0
  s_nop 0
  buffer_load_dwordx4 v3, s[12:15], s76 offen lds
  s_add_u32 m0, s32, 1024
  s_nop 0
  buffer_load_dwordx4 v4, s[12:15], s76 offen lds
  s_add_u32 m0, s32, 2048
  s_nop 0
  buffer_load_dwordx4 v5, s[12:15], s76 offen lds
  s_add_u32 m0, s32, 12288
  s_nop 0
  buffer_load_dwordx4 v6, s[16:19], s77 offen lds
  s_add_u32 m0, s32, 13312
  s_nop 0
  buffer_load_dwordx4 v7, s[16:19], s77 offen lds
  s_add_u32 m0, s32, 14336
  s_nop 0
  buffer_load_dwordx4 v8, s[16:19], s77 offen lds
  s_add_u32 m0, s32, 15360
  s_nop 0
  buffer_load_dwordx4 v9, s[16:19], s77 offen lds
  s_add_u32 s76, s76, 98304
  s_add_u32 s77, s77, 114688
L_nob4:
  s_add_u32 s72, s60, 62914560
  s_addc_u32 s73, s61, 0
  s_mov_b32 s74, 524288
  s_mov_b32 s75, 0x20000
  s_mov_b32 s20, s60
  s_mov_b32 s21, s61
  s_mov_b32 s22, 35651584
  s_mov_b32 s23, 0x20000
  s_lshl_b32 s98, s70, 11
  s_lshl_b32 s99, s68, 4
  s_add_u32 s99, s99, s69
  s_lshl_b32 s99, s99, 11
  s_lshl_b32 s71, s29, 16
  s_lshl_b32 s32, s28, 3
  s_add_u32 s71, s71, s32
  v_and_b32 v0, 31, v17
  v_lshlrev_b32 v0, 3, v0
  v_lshlrev_b32 v23, 3, v17
  s_mov_b32 s24, s50
  s_mov_b32 s25, s51
  s_mov_b32 s26, 7168
  s_mov_b32 s27, 0x20000
  v_lshrrev_b32 v31, 4, v17
  v_lshlrev_b32 v31, 3, v31
  s_mul_i32 s39, s28, 224
  v_add_u32 v31, s39, v31
  s_lshr_b32 s32, s70, 3
  s_mul_i32 s32, s32, 131328
  s_add_u32 s3, s32, 131072
  buffer_load_dword v26, off, s[20:23], s3
  s_add_u32 s3, s99, 512
  s_cmp_eq_u32 s30, 0
  s_cselect_b32 s3, s98, s3
  buffer_load_dwordx2 v[26:27], v23, s[72:75], s3 offen sc1
  buffer_load_dwordx2 v[26:27], off, s[72:75], s98 offset:1024 sc1
  s_lshl_b32 s3, s62, 5
  s_mul_i32 s39, s62, 192
  s_sub_u32 s39, 192, s39
  buffer_load_dwordx2 v[32:33], v31, s[24:27], s3 offen offset:0
  buffer_load_dwordx2 v[34:35], v31, s[24:27], s3 offen offset:32
  buffer_load_dwordx2 v[36:37], v31, s[24:27], s3 offen offset:64
  buffer_load_dwordx2 v[38:39], v31, s[24:27], s3 offen offset:96
  buffer_load_dwordx2 v[40:41], v31, s[24:27], s3 offen offset:128
  buffer_load_dwordx2 v[42:43], v31, s[24:27], s3 offen offset:160
  buffer_load_dwordx2 v[44:45], v31, s[24:27], s39 offen
  s_mul_i32 s35, s30, 3072
  s_lshl_b32 s36, s30, 12
  s_add_u32 s36, s36, 12288
  s_add_u32 s33, s33, 786432
  s_cmp_ge_u32 s33, 6291456
  s_cselect_b32 s3, 6291456, 0
  s_sub_u32 s33, s33, s3
  s_add_u32 s34, s34, 917504
  s_cmp_ge_u32 s34, 7340032
  s_cselect_b32 s3, 7340032, 0
  s_sub_u32 s34, s34, s3
  s_add_u32 s33, s33, 786432
  s_cmp_ge_u32 s33, 6291456
  s_cselect_b32 s3, 6291456, 0
  s_sub_u32 s33, s33, s3
  s_add_u32 s34, s34, 917504
  s_cmp_ge_u32 s34, 7340032
  s_cselect_b32 s3, 7340032, 0
  s_sub_u32 s34, s34, s3
  v_lshrrev_b32 v28, 4, v17
  v_bfe_u32 v29, v17, 2, 2
  v_and_b32 v20, 3, v17
  v_and_b32 v21, 1, v28
  v_lshrrev_b32 v22, 1, v28
  v_mul_u32_u24 v24, 3072, v22
  v_mul_u32_u24 v30, 1536, v21
  v_add_u32 v24, v24, v30
  v_mul_u32_u24 v30, 192, v29
  v_add_u32 v24, v24, v30
  v_lshl_add_u32 v24, v20, 3, v24
  v_lshlrev_b32 v30, 5, v21
  v_add_u32 v10, v24, v30
  v_sub_u32 v12, v24, v30
  v_add_u32 v11, 57344, v10
  v_add_u32 v13, 57344, v12
  v_lshlrev_b32 v24, 11, v28
  v_mul_u32_u24 v30, 224, v29
  v_add_u32 v24, v24, v30
  v_lshl_add_u32 v24, v21, 7, v24
  v_lshl_add_u32 v14, v20, 3, v24
  v_add_u32 v15, 57344, v14
  v_lshlrev_b32 v1, 8, v29
  v_lshl_add_u32 v1, v28, 6, v1
  v_lshl_add_u32 v1, v20, 4, v1
  v_add_u32 v2, 0x1000, v1
  s_lshl_b32 s3, s29, 2
  s_add_u32 s3, s3, s30
  s_mul_i32 s3, s3, 131328
  s_add_u32 s8, s60, s3
  s_addc_u32 s9, s61, 0
  s_mov_b32 s10, 131072
  s_mov_b32 s11, 0x20000
  s_mov_b32 s38, 0xffff0000
  s_cmp_ge_u32 s30, 2
  s_cbranch_scc1 L_noln6
  v_and_b32 v20, 15, v17
  v_lshlrev_b32 v20, 4, v20
  v_lshl_add_u32 v20, v28, 12, v20
  s_bfe_u32 s3, s70, 0x20001
  s_lshl_b32 s3, s3, 10
  s_add_u32 s32, s32, s3
  s_lshl_b32 s3, s62, 9
  s_add_u32 s32, s32, s3
  s_lshl_b32 s3, s30, 8
  s_add_u32 s32, s32, s3
  s_waitcnt vmcnt(10)
  buffer_load_dwordx2 v[26:27], off, s[64:67], 0 sc1
  v_lshlrev_b32 v80, 16, v48
  v_and_b32 v81, s38, v48
  v_lshlrev_b32 v82, 16, v49
  v_and_b32 v83, s38, v49
  v_lshlrev_b32 v84, 16, v50
  v_and_b32 v85, s38, v50
  v_lshlrev_b32 v86, 16, v51
  v_and_b32 v87, s38, v51
  v_lshlrev_b32 v88, 16, v52
  v_and_b32 v89, s38, v52
  v_lshlrev_b32 v90, 16, v53
  v_and_b32 v91, s38, v53
  v_lshlrev_b32 v92, 16, v54
  v_and_b32 v93, s38, v54
  v_lshlrev_b32 v94, 16, v55
  v_and_b32 v95, s38, v55
  v_lshlrev_b32 v96, 16, v56
  v_and_b32 v97, s38, v56
  v_lshlrev_b32 v98, 16, v57
  v_and_b32 v99, s38, v57
  v_lshlrev_b32 v100, 16, v58
  v_and_b32 v101, s38, v58
  v_lshlrev_b32 v102, 16, v59
  v_and_b32 v103, s38, v59
  v_lshlrev_b32 v104, 16, v60
  v_and_b32 v105, s38, v60
  v_lshlrev_b32 v106, 16, v61
  v_and_b32 v107, s38, v61
  v_lshlrev_b32 v108, 16, v62
  v_and_b32 v109, s38, v62
  v_lshlrev_b32 v110, 16, v63
  v_and_b32 v111, s38, v63
  v_lshlrev_b32 v112, 16, v64
  v_and_b32 v113, s38, v64
  v_lshlrev_b32 v114, 16, v65
  v_and_b32 v115, s38, v65
  v_lshlrev_b32 v116, 16, v66
  v_and_b32 v117, s38, v66
  v_lshlrev_b32 v118, 16, v67
  v_and_b32 v119, s38, v67
  v_lshlrev_b32 v120, 16, v68
  v_and_b32 v121, s38, v68
  v_lshlrev_b32 v122, 16, v69
  v_and_b32 v123, s38, v69
  v_lshlrev_b32 v124, 16, v70
  v_and_b32 v125, s38, v70
  v_lshlrev_b32 v126, 16, v71
  v_and_b32 v127, s38, v71
  v_lshlrev_b32 v128, 16, v72
  v_and_b32 v129, s38, v72
  v_lshlrev_b32 v130, 16, v73
  v_and_b32 v131, s38, v73
  v_lshlrev_b32 v132, 16, v74
  v_and_b32 v133, s38, v74
  v_lshlrev_b32 v134, 16, v75
  v_and_b32 v135, s38, v75
  v_lshlrev_b32 v136, 16, v76
  v_and_b32 v137, s38, v76
  v_lshlrev_b32 v138, 16, v77
  v_and_b32 v139, s38, v77
  v_lshlrev_b32 v140, 16, v78
  v_and_b32 v141, s38, v78
  v_lshlrev_b32 v142, 16, v79
  v_and_b32 v143, s38, v79
  v_pk_add_f32 v[144:145], v[80:81], v[82:83]
  v_pk_add_f32 v[146:147], v[84:85], v[86:87]
  v_pk_add_f32 v[144:145], v[144:145], v[88:89]
  v_pk_add_f32 v[146:147], v[146:147], v[90:91]
  v_pk_add_f32 v[144:145], v[144:145], v[92:93]
  v_pk_add_f32 v[146:147], v[146:147], v[94:95]
  v_pk_add_f32 v[144:145], v[144:145], v[96:97]
  v_pk_add_f32 v[146:147], v[146:147], v[98:99]
  v_pk_add_f32 v[144:145], v[144:145], v[100:101]
  v_pk_add_f32 v[146:147], v[146:147], v[102:103]
  v_pk_add_f32 v[144:145], v[144:145], v[104:105]
  v_pk_add_f32 v[146:147], v[146:147], v[106:107]
  v_pk_add_f32 v[144:145], v[144:145], v[108:109]
  v_pk_add_f32 v[146:147], v[146:147], v[110:111]
  v_pk_add_f32 v[144:145], v[144:145], v[112:113]
  v_pk_add_f32 v[146:147], v[146:147], v[114:115]
  v_pk_add_f32 v[144:145], v[144:145], v[116:117]
  v_pk_add_f32 v[146:147], v[146:147], v[118:119]
  v_pk_add_f32 v[144:145], v[144:145], v[120:121]
  v_pk_add_f32 v[146:147], v[146:147], v[122:123]
  v_pk_add_f32 v[144:145], v[144:145], v[124:125]
  v_pk_add_f32 v[146:147], v[146:147], v[126:127]
  v_pk_add_f32 v[144:145], v[144:145], v[128:129]
  v_pk_add_f32 v[146:147], v[146:147], v[130:131]
  v_pk_add_f32 v[144:145], v[144:145], v[132:133]
  v_pk_add_f32 v[146:147], v[146:147], v[134:135]
  v_pk_add_f32 v[144:145], v[144:145], v[136:137]
  v_pk_add_f32 v[146:147], v[146:147], v[138:139]
  v_pk_add_f32 v[144:145], v[144:145], v[140:141]
  v_pk_add_f32 v[146:147], v[146:147], v[142:143]
  v_pk_add_f32 v[144:145], v[144:145], v[146:147]
  v_add_f32 v144, v144, v145
  s_nop 1
  v_add_f32_dpp v144, v144, v144 row_ror:8 row_mask:0xf bank_mask:0xf
  s_nop 1
  v_add_f32_dpp v144, v144, v144 row_ror:4 row_mask:0xf bank_mask:0xf
  v_mov_b32 v145, v144
  s_nop 1
  v_permlane16_swap_b32 v145, v144
  s_nop 1
  v_add_f32 v144, v144, v145
  v_mov_b32 v145, v144
  s_nop 1
  v_permlane32_swap_b32 v145, v144
  s_nop 1
  v_add_f32 v144, v144, v145
  v_mul_f32 v144, 0x3a800000, v144
  v_sub_f32 v146, 0, v144
  v_mov_b32 v147, v146
  v_pk_add_f32 v[148:149], v[80:81], v[146:147]
  v_pk_mul_f32 v[152:153], v[148:149], v[148:149]
  v_pk_add_f32 v[150:151], v[82:83], v[146:147]
  v_pk_mul_f32 v[154:155], v[150:151], v[150:151]
  v_pk_add_f32 v[148:149], v[84:85], v[146:147]
  v_pk_fma_f32 v[152:153], v[148:149], v[148:149], v[152:153]
  v_pk_add_f32 v[150:151], v[86:87], v[146:147]
  v_pk_fma_f32 v[154:155], v[150:151], v[150:151], v[154:155]
  v_pk_add_f32 v[148:149], v[88:89], v[146:147]
  v_pk_fma_f32 v[152:153], v[148:149], v[148:149], v[152:153]
  v_pk_add_f32 v[150:151], v[90:91], v[146:147]
  v_pk_fma_f32 v[154:155], v[150:151], v[150:151], v[154:155]
  v_pk_add_f32 v[148:149], v[92:93], v[146:147]
  v_pk_fma_f32 v[152:153], v[148:149], v[148:149], v[152:153]
  v_pk_add_f32 v[150:151], v[94:95], v[146:147]
  v_pk_fma_f32 v[154:155], v[150:151], v[150:151], v[154:155]
  v_pk_add_f32 v[148:149], v[96:97], v[146:147]
  v_pk_fma_f32 v[152:153], v[148:149], v[148:149], v[152:153]
  v_pk_add_f32 v[150:151], v[98:99], v[146:147]
  v_pk_fma_f32 v[154:155], v[150:151], v[150:151], v[154:155]
  v_pk_add_f32 v[148:149], v[100:101], v[146:147]
  v_pk_fma_f32 v[152:153], v[148:149], v[148:149], v[152:153]
  v_pk_add_f32 v[150:151], v[102:103], v[146:147]
  v_pk_fma_f32 v[154:155], v[150:151], v[150:151], v[154:155]
  v_pk_add_f32 v[148:149], v[104:105], v[146:147]
  v_pk_fma_f32 v[152:153], v[148:149], v[148:149], v[152:153]
  v_pk_add_f32 v[150:151], v[106:107], v[146:147]
  v_pk_fma_f32 v[154:155], v[150:151], v[150:151], v[154:155]
  v_pk_add_f32 v[148:149], v[108:109], v[146:147]
  v_pk_fma_f32 v[152:153], v[148:149], v[148:149], v[152:153]
  v_pk_add_f32 v[150:151], v[110:111], v[146:147]
  v_pk_fma_f32 v[154:155], v[150:151], v[150:151], v[154:155]
  v_pk_add_f32 v[148:149], v[112:113], v[146:147]
  v_pk_fma_f32 v[152:153], v[148:149], v[148:149], v[152:153]
  v_pk_add_f32 v[150:151], v[114:115], v[146:147]
  v_pk_fma_f32 v[154:155], v[150:151], v[150:151], v[154:155]
  v_pk_add_f32 v[148:149], v[116:117], v[146:147]
  v_pk_fma_f32 v[152:153], v[148:149], v[148:149], v[152:153]
  v_pk_add_f32 v[150:151], v[118:119], v[146:147]
  v_pk_fma_f32 v[154:155], v[150:151], v[150:151], v[154:155]
  v_pk_add_f32 v[148:149], v[120:121], v[146:147]
  v_pk_fma_f32 v[152:153], v[148:149], v[148:149], v[152:153]
  v_pk_add_f32 v[150:151], v[122:123], v[146:147]
  v_pk_fma_f32 v[154:155], v[150:151], v[150:151], v[154:155]
  v_pk_add_f32 v[148:149], v[124:125], v[146:147]
  v_pk_fma_f32 v[152:153], v[148:149], v[148:149], v[152:153]
  v_pk_add_f32 v[150:151], v[126:127], v[146:147]
  v_pk_fma_f32 v[154:155], v[150:151], v[150:151], v[154:155]
  v_pk_add_f32 v[148:149], v[128:129], v[146:147]
  v_pk_fma_f32 v[152:153], v[148:149], v[148:149], v[152:153]
  v_pk_add_f32 v[150:151], v[130:131], v[146:147]
  v_pk_fma_f32 v[154:155], v[150:151], v[150:151], v[154:155]
  v_pk_add_f32 v[148:149], v[132:133], v[146:147]
  v_pk_fma_f32 v[152:153], v[148:149], v[148:149], v[152:153]
  v_pk_add_f32 v[150:151], v[134:135], v[146:147]
  v_pk_fma_f32 v[154:155], v[150:151], v[150:151], v[154:155]
  v_pk_add_f32 v[148:149], v[136:137], v[146:147]
  v_pk_fma_f32 v[152:153], v[148:149], v[148:149], v[152:153]
  v_pk_add_f32 v[150:151], v[138:139], v[146:147]
  v_pk_fma_f32 v[154:155], v[150:151], v[150:151], v[154:155]
  v_pk_add_f32 v[148:149], v[140:141], v[146:147]
  v_pk_fma_f32 v[152:153], v[148:149], v[148:149], v[152:153]
  v_pk_add_f32 v[150:151], v[142:143], v[146:147]
  v_pk_fma_f32 v[154:155], v[150:151], v[150:151], v[154:155]
  v_pk_add_f32 v[152:153], v[152:153], v[154:155]
  v_add_f32 v152, v152, v153
  s_nop 1
  v_add_f32_dpp v152, v152, v152 row_ror:8 row_mask:0xf bank_mask:0xf
  s_nop 1
  v_add_f32_dpp v152, v152, v152 row_ror:4 row_mask:0xf bank_mask:0xf
  v_mov_b32 v153, v152
  s_nop 1
  v_permlane16_swap_b32 v153, v152
  s_nop 1
  v_add_f32 v152, v152, v153
  v_mov_b32 v153, v152
  s_nop 1
  v_permlane32_swap_b32 v153, v152
  s_nop 1
  v_add_f32 v152, v152, v153
  v_mul_f32 v152, 0x3a800000, v152
  v_cvt_pk_bf16_f32 v148, v144, v152
  v_lshlrev_b32 v146, 16, v148
  v_and_b32 v152, s38, v148
  v_add_f32 v152, 0x3727c5ac, v152
  v_cvt_pk_bf16_f32 v152, v152, v152
  v_and_b32 v152, s38, v152
  v_sqrt_f32 v152, v152
  s_nop 0
  v_cvt_pk_bf16_f32 v152, v152, v152
  v_and_b32 v152, s38, v152
  v_rcp_f32 v152, v152
  v_sub_f32 v146, 0, v146
  v_mov_b32 v147, v146
  v_mov_b32 v153, v152
  v_pk_add_f32 v[148:149], v[80:81], v[146:147]
  v_cvt_pk_bf16_f32 v154, v148, v149
  v_lshlrev_b32 v148, 16, v154
  v_and_b32 v149, s38, v154
  v_pk_mul_f32 v[148:149], v[148:149], v[152:153]
  v_cvt_pk_bf16_f32 v48, v148, v149
  v_pk_add_f32 v[150:151], v[82:83], v[146:147]
  v_cvt_pk_bf16_f32 v154, v150, v151
  v_lshlrev_b32 v150, 16, v154
  v_and_b32 v151, s38, v154
  v_pk_mul_f32 v[150:151], v[150:151], v[152:153]
  v_cvt_pk_bf16_f32 v49, v150, v151
  v_pk_add_f32 v[148:149], v[84:85], v[146:147]
  v_cvt_pk_bf16_f32 v154, v148, v149
  v_lshlrev_b32 v148, 16, v154
  v_and_b32 v149, s38, v154
  v_pk_mul_f32 v[148:149], v[148:149], v[152:153]
  v_cvt_pk_bf16_f32 v50, v148, v149
  v_pk_add_f32 v[150:151], v[86:87], v[146:147]
  v_cvt_pk_bf16_f32 v154, v150, v151
  v_lshlrev_b32 v150, 16, v154
  v_and_b32 v151, s38, v154
  v_pk_mul_f32 v[150:151], v[150:151], v[152:153]
  v_cvt_pk_bf16_f32 v51, v150, v151
  buffer_store_dwordx4 v[48:51], v20, s[20:23], s32 offen sc1
  s_add_u32 s32, s32, 16384
  v_pk_add_f32 v[148:149], v[88:89], v[146:147]
  v_cvt_pk_bf16_f32 v154, v148, v149
  v_lshlrev_b32 v148, 16, v154
  v_and_b32 v149, s38, v154
  v_pk_mul_f32 v[148:149], v[148:149], v[152:153]
  v_cvt_pk_bf16_f32 v52, v148, v149
  v_pk_add_f32 v[150:151], v[90:91], v[146:147]
  v_cvt_pk_bf16_f32 v154, v150, v151
  v_lshlrev_b32 v150, 16, v154
  v_and_b32 v151, s38, v154
  v_pk_mul_f32 v[150:151], v[150:151], v[152:153]
  v_cvt_pk_bf16_f32 v53, v150, v151
  v_pk_add_f32 v[148:149], v[92:93], v[146:147]
  v_cvt_pk_bf16_f32 v154, v148, v149
  v_lshlrev_b32 v148, 16, v154
  v_and_b32 v149, s38, v154
  v_pk_mul_f32 v[148:149], v[148:149], v[152:153]
  v_cvt_pk_bf16_f32 v54, v148, v149
  v_pk_add_f32 v[150:151], v[94:95], v[146:147]
  v_cvt_pk_bf16_f32 v154, v150, v151
  v_lshlrev_b32 v150, 16, v154
  v_and_b32 v151, s38, v154
  v_pk_mul_f32 v[150:151], v[150:151], v[152:153]
  v_cvt_pk_bf16_f32 v55, v150, v151
  buffer_store_dwordx4 v[52:55], v20, s[20:23], s32 offen sc1
  s_add_u32 s32, s32, 16384
  v_pk_add_f32 v[148:149], v[96:97], v[146:147]
  v_cvt_pk_bf16_f32 v154, v148, v149
  v_lshlrev_b32 v148, 16, v154
  v_and_b32 v149, s38, v154
  v_pk_mul_f32 v[148:149], v[148:149], v[152:153]
  v_cvt_pk_bf16_f32 v56, v148, v149
  v_pk_add_f32 v[150:151], v[98:99], v[146:147]
  v_cvt_pk_bf16_f32 v154, v150, v151
  v_lshlrev_b32 v150, 16, v154
  v_and_b32 v151, s38, v154
  v_pk_mul_f32 v[150:151], v[150:151], v[152:153]
  v_cvt_pk_bf16_f32 v57, v150, v151
  v_pk_add_f32 v[148:149], v[100:101], v[146:147]
  v_cvt_pk_bf16_f32 v154, v148, v149
  v_lshlrev_b32 v148, 16, v154
  v_and_b32 v149, s38, v154
  v_pk_mul_f32 v[148:149], v[148:149], v[152:153]
  v_cvt_pk_bf16_f32 v58, v148, v149
  v_pk_add_f32 v[150:151], v[102:103], v[146:147]
  v_cvt_pk_bf16_f32 v154, v150, v151
  v_lshlrev_b32 v150, 16, v154
  v_and_b32 v151, s38, v154
  v_pk_mul_f32 v[150:151], v[150:151], v[152:153]
  v_cvt_pk_bf16_f32 v59, v150, v151
  buffer_store_dwordx4 v[56:59], v20, s[20:23], s32 offen sc1
  s_add_u32 s32, s32, 16384
  v_pk_add_f32 v[148:149], v[104:105], v[146:147]
  v_cvt_pk_bf16_f32 v154, v148, v149
  v_lshlrev_b32 v148, 16, v154
  v_and_b32 v149, s38, v154
  v_pk_mul_f32 v[148:149], v[148:149], v[152:153]
  v_cvt_pk_bf16_f32 v60, v148, v149
  v_pk_add_f32 v[150:151], v[106:107], v[146:147]
  v_cvt_pk_bf16_f32 v154, v150, v151
  v_lshlrev_b32 v150, 16, v154
  v_and_b32 v151, s38, v154
  v_pk_mul_f32 v[150:151], v[150:151], v[152:153]
  v_cvt_pk_bf16_f32 v61, v150, v151
  v_pk_add_f32 v[148:149], v[108:109], v[146:147]
  v_cvt_pk_bf16_f32 v154, v148, v149
  v_lshlrev_b32 v148, 16, v154
  v_and_b32 v149, s38, v154
  v_pk_mul_f32 v[148:149], v[148:149], v[152:153]
  v_cvt_pk_bf16_f32 v62, v148, v149
  v_pk_add_f32 v[150:151], v[110:111], v[146:147]
  v_cvt_pk_bf16_f32 v154, v150, v151
  v_lshlrev_b32 v150, 16, v154
  v_and_b32 v151, s38, v154
  v_pk_mul_f32 v[150:151], v[150:151], v[152:153]
  v_cvt_pk_bf16_f32 v63, v150, v151
  buffer_store_dwordx4 v[60:63], v20, s[20:23], s32 offen sc1
  s_add_u32 s32, s32, 16384
  v_pk_add_f32 v[148:149], v[112:113], v[146:147]
  v_cvt_pk_bf16_f32 v154, v148, v149
  v_lshlrev_b32 v148, 16, v154
  v_and_b32 v149, s38, v154
  v_pk_mul_f32 v[148:149], v[148:149], v[152:153]
  v_cvt_pk_bf16_f32 v64, v148, v149
  v_pk_add_f32 v[150:151], v[114:115], v[146:147]
  v_cvt_pk_bf16_f32 v154, v150, v151
  v_lshlrev_b32 v150, 16, v154
  v_and_b32 v151, s38, v154
  v_pk_mul_f32 v[150:151], v[150:151], v[152:153]
  v_cvt_pk_bf16_f32 v65, v150, v151
  v_pk_add_f32 v[148:149], v[116:117], v[146:147]
  v_cvt_pk_bf16_f32 v154, v148, v149
  v_lshlrev_b32 v148, 16, v154
  v_and_b32 v149, s38, v154
  v_pk_mul_f32 v[148:149], v[148:149], v[152:153]
  v_cvt_pk_bf16_f32 v66, v148, v149
  v_pk_add_f32 v[150:151], v[118:119], v[146:147]
  v_cvt_pk_bf16_f32 v154, v150, v151
  v_lshlrev_b32 v150, 16, v154
  v_and_b32 v151, s38, v154
  v_pk_mul_f32 v[150:151], v[150:151], v[152:153]
  v_cvt_pk_bf16_f32 v67, v150, v151
  buffer_store_dwordx4 v[64:67], v20, s[20:23], s32 offen sc1
  s_add_u32 s32, s32, 16384
  v_pk_add_f32 v[148:149], v[120:121], v[146:147]
  v_cvt_pk_bf16_f32 v154, v148, v149
  v_lshlrev_b32 v148, 16, v154
  v_and_b32 v149, s38, v154
  v_pk_mul_f32 v[148:149], v[148:149], v[152:153]
  v_cvt_pk_bf16_f32 v68, v148, v149
  v_pk_add_f32 v[150:151], v[122:123], v[146:147]
  v_cvt_pk_bf16_f32 v154, v150, v151
  v_lshlrev_b32 v150, 16, v154
  v_and_b32 v151, s38, v154
  v_pk_mul_f32 v[150:151], v[150:151], v[152:153]
  v_cvt_pk_bf16_f32 v69, v150, v151
  v_pk_add_f32 v[148:149], v[124:125], v[146:147]
  v_cvt_pk_bf16_f32 v154, v148, v149
  v_lshlrev_b32 v148, 16, v154
  v_and_b32 v149, s38, v154
  v_pk_mul_f32 v[148:149], v[148:149], v[152:153]
  v_cvt_pk_bf16_f32 v70, v148, v149
  v_pk_add_f32 v[150:151], v[126:127], v[146:147]
  v_cvt_pk_bf16_f32 v154, v150, v151
  v_lshlrev_b32 v150, 16, v154
  v_and_b32 v151, s38, v154
  v_pk_mul_f32 v[150:151], v[150:151], v[152:153]
  v_cvt_pk_bf16_f32 v71, v150, v151
  buffer_store_dwordx4 v[68:71], v20, s[20:23], s32 offen sc1
  s_add_u32 s32, s32, 16384
  v_pk_add_f32 v[148:149], v[128:129], v[146:147]
  v_cvt_pk_bf16_f32 v154, v148, v149
  v_lshlrev_b32 v148, 16, v154
  v_and_b32 v149, s38, v154
  v_pk_mul_f32 v[148:149], v[148:149], v[152:153]
  v_cvt_pk_bf16_f32 v72, v148, v149
  v_pk_add_f32 v[150:151], v[130:131], v[146:147]
  v_cvt_pk_bf16_f32 v154, v150, v151
  v_lshlrev_b32 v150, 16, v154
  v_and_b32 v151, s38, v154
  v_pk_mul_f32 v[150:151], v[150:151], v[152:153]
  v_cvt_pk_bf16_f32 v73, v150, v151
  v_pk_add_f32 v[148:149], v[132:133], v[146:147]
  v_cvt_pk_bf16_f32 v154, v148, v149
  v_lshlrev_b32 v148, 16, v154
  v_and_b32 v149, s38, v154
  v_pk_mul_f32 v[148:149], v[148:149], v[152:153]
  v_cvt_pk_bf16_f32 v74, v148, v149
  v_pk_add_f32 v[150:151], v[134:135], v[146:147]
  v_cvt_pk_bf16_f32 v154, v150, v151
  v_lshlrev_b32 v150, 16, v154
  v_and_b32 v151, s38, v154
  v_pk_mul_f32 v[150:151], v[150:151], v[152:153]
  v_cvt_pk_bf16_f32 v75, v150, v151
  buffer_store_dwordx4 v[72:75], v20, s[20:23], s32 offen sc1
  s_add_u32 s32, s32, 16384
  v_pk_add_f32 v[148:149], v[136:137], v[146:147]
  v_cvt_pk_bf16_f32 v154, v148, v149
  v_lshlrev_b32 v148, 16, v154
  v_and_b32 v149, s38, v154
  v_pk_mul_f32 v[148:149], v[148:149], v[152:153]
  v_cvt_pk_bf16_f32 v76, v148, v149
  v_pk_add_f32 v[150:151], v[138:139], v[146:147]
  v_cvt_pk_bf16_f32 v154, v150, v151
  v_lshlrev_b32 v150, 16, v154
  v_and_b32 v151, s38, v154
  v_pk_mul_f32 v[150:151], v[150:151], v[152:153]
  v_cvt_pk_bf16_f32 v77, v150, v151
  v_pk_add_f32 v[148:149], v[140:141], v[146:147]
  v_cvt_pk_bf16_f32 v154, v148, v149
  v_lshlrev_b32 v148, 16, v154
  v_and_b32 v149, s38, v154
  v_pk_mul_f32 v[148:149], v[148:149], v[152:153]
  v_cvt_pk_bf16_f32 v78, v148, v149
  v_pk_add_f32 v[150:151], v[142:143], v[146:147]
  v_cvt_pk_bf16_f32 v154, v150, v151
  v_lshlrev_b32 v150, 16, v154
  v_and_b32 v151, s38, v154
  v_pk_mul_f32 v[150:151], v[150:151], v[152:153]
  v_cvt_pk_bf16_f32 v79, v150, v151
  buffer_store_dwordx4 v[76:79], v20, s[20:23], s32 offen sc1
  s_add_u32 s32, s32, 16384
  s_lshl_b32 s3, s28, 3
  s_add_u32 s3, s3, s71
  s_lshl_b32 s32, s30, 3
  s_add_u32 s3, s3, s32
  v_lshlrev_b32 v24, 8, v0
  s_waitcnt vmcnt(8)
  v_cmp_ne_u64 vcc, 0, v[26:27]
  s_cmp_eq_u64 vcc, exec
  s_cbranch_scc1 L_polld8
  s_mov_b32 s63, 0x40000
L_poll7:
  buffer_load_dwordx2 v[26:27], off, s[64:67], 0 sc1
  s_waitcnt vmcnt(0)
  v_cmp_ne_u64 vcc, 0, v[26:27]
  s_cmp_eq_u64 vcc, exec
  s_cbranch_scc1 L_polld8
  s_sleep 1
  s_sub_u32 s63, s63, 1
  s_cmp_lg_u32 s63, 0
  s_cbranch_scc1 L_poll7
L_polld8:
  s_waitcnt vmcnt(0)
  s_mov_b64 exec, 0xffffffff
  buffer_store_dwordx2 v[26:27], v24, s[72:75], s3 offen sc1
  s_mov_b64 exec, -1
  s_branch L_join9
L_noln6:
  s_add_u32 m0, s37, 3072
  s_nop 0
  buffer_load_dwordx4 v3, s[12:15], s76 offen lds
  v_mov_b32 v48, 0
  v_mov_b32 v49, 0
  v_mov_b32 v50, 0
  v_mov_b32 v51, 0
  v_mov_b32 v52, 0
  v_mov_b32 v53, 0
  v_mov_b32 v54, 0
  v_mov_b32 v55, 0
  v_mov_b32 v56, 0
  v_mov_b32 v57, 0
  v_mov_b32 v58, 0
  v_mov_b32 v59, 0
  s_waitcnt vmcnt(18)
  s_add_u32 m0, s37, 4096
  s_nop 0
  buffer_load_dwordx4 v4, s[12:15], s76 offen lds
  v_mov_b32 v60, 0
  v_mov_b32 v61, 0
  v_mov_b32 v62, 0
  v_mov_b32 v63, 0
  v_mov_b32 v64, 0
  v_mov_b32 v65, 0
  v_mov_b32 v66, 0
  v_mov_b32 v67, 0
  v_mov_b32 v68, 0
  v_mov_b32 v69, 0
  v_mov_b32 v70, 0
  v_mov_b32 v71, 0
  s_waitcnt vmcnt(16)
  s_add_u32 m0, s37, 5120
  s_nop 0
  buffer_load_dwordx4 v5, s[12:15], s76 offen lds
  v_mov_b32 v72, 0
  v_mov_b32 v73, 0
  v_mov_b32 v74, 0
  v_mov_b32 v75, 0
  v_mov_b32 v76, 0
  v_mov_b32 v77, 0
  v_mov_b32 v78, 0
  v_mov_b32 v79, 0
  v_mov_b32 v80, 0
  v_mov_b32 v81, 0
  v_mov_b32 v82, 0
  v_mov_b32 v83, 0
  s_waitcnt vmcnt(14)
  s_add_u32 m0, s37, 16384
  s_nop 0
  buffer_load_dwordx4 v6, s[16:19], s77 offen lds
  v_mov_b32 v84, 0
  v_mov_b32 v85, 0
  v_mov_b32 v86, 0
  v_mov_b32 v87, 0
  v_mov_b32 v88, 0
  v_mov_b32 v89, 0
  v_mov_b32 v90, 0
  v_mov_b32 v91, 0
  v_mov_b32 v92, 0
  v_mov_b32 v93, 0
  v_mov_b32 v94, 0
  v_mov_b32 v95, 0
  s_waitcnt vmcnt(12)
  s_add_u32 m0, s37, 17408
  s_nop 0
  buffer_load_dwordx4 v7, s[16:19], s77 offen lds
  v_mov_b32 v96, 0
  v_mov_b32 v97, 0
  v_mov_b32 v98, 0
  v_mov_b32 v99, 0
  v_mov_b32 v100, 0
  v_mov_b32 v101, 0
  v_mov_b32 v102, 0
  v_mov_b32 v103, 0
  v_mov_b32 v104, 0
  v_mov_b32 v105, 0
  v_mov_b32 v106, 0
  v_mov_b32 v107, 0
  s_waitcnt vmcnt(10)
  s_add_u32 m0, s37, 18432
  s_nop 0
  buffer_load_dwordx4 v8, s[16:19], s77 offen lds
  v_mov_b32 v108, 0
  v_mov_b32 v109, 0
  v_mov_b32 v110, 0
  v_mov_b32 v111, 0
  v_mov_b32 v112, 0
  v_mov_b32 v113, 0
  v_mov_b32 v114, 0
  v_mov_b32 v115, 0
  v_mov_b32 v116, 0
  v_mov_b32 v117, 0
  v_mov_b32 v118, 0
  v_mov_b32 v119, 0
  s_waitcnt vmcnt(8)
  s_add_u32 m0, s37, 19456
  s_nop 0
  buffer_load_dwordx4 v9, s[16:19], s77 offen lds
  v_mov_b32 v120, 0
  v_mov_b32 v121, 0
  v_mov_b32 v122, 0
  v_mov_b32 v123, 0
  v_mov_b32 v124, 0
  v_mov_b32 v125, 0
  v_mov_b32 v126, 0
  v_mov_b32 v127, 0
  v_mov_b32 v128, 0
  v_mov_b32 v129, 0
  v_mov_b32 v130, 0
  v_mov_b32 v131, 0
  s_waitcnt vmcnt(8)
  s_add_u32 s76, s76, 98304
  s_add_u32 s77, s77, 114688
  s_add_u32 m0, s37, 6144
  s_nop 0
  buffer_load_dwordx4 v3, s[12:15], s76 offen lds
  v_mov_b32 v132, 0
  v_mov_b32 v133, 0
  v_mov_b32 v134, 0
  v_mov_b32 v135, 0
  v_mov_b32 v136, 0
  v_mov_b32 v137, 0
  v_mov_b32 v138, 0
  v_mov_b32 v139, 0
  v_mov_b32 v140, 0
  v_mov_b32 v141, 0
  v_mov_b32 v142, 0
  v_mov_b32 v143, 0
  s_waitcnt vmcnt(8)
  s_add_u32 m0, s37, 7168
  s_nop 0
  buffer_load_dwordx4 v4, s[12:15], s76 offen lds
  s_waitcnt vmcnt(8)
  s_add_u32 m0, s37, 8192
  s_nop 0
  buffer_load_dwordx4 v5, s[12:15], s76 offen lds
  buffer_load_dwordx2 v[26:27], off, s[64:67], 0 sc1
  s_waitcnt vmcnt(8)
  s_add_u32 m0, s37, 20480
  s_nop 0
  buffer_load_dwordx4 v6, s[16:19], s77 offen lds
  s_waitcnt vmcnt(8)
  s_add_u32 m0, s37, 21504
  s_nop 0
  buffer_load_dwordx4 v7, s[16:19], s77 offen lds
  s_waitcnt vmcnt(8)
  s_add_u32 m0, s37, 22528
  s_nop 0
  buffer_load_dwordx4 v8, s[16:19], s77 offen lds
  s_waitcnt vmcnt(8)
  s_add_u32 m0, s37, 23552
  s_nop 0
  buffer_load_dwordx4 v9, s[16:19], s77 offen lds
  v_lshlrev_b32 v144, 16, v32
  v_and_b32 v145, s38, v32
  v_lshlrev_b32 v146, 16, v33
  v_and_b32 v147, s38, v33
  v_mov_b32 v148, v144
  v_mov_b32 v149, v145
  v_mov_b32 v150, v146
  v_mov_b32 v151, v147
  v_mov_b32 v152, v144
  v_mov_b32 v153, v145
  v_mov_b32 v154, v146
  v_mov_b32 v155, v147
  v_mov_b32 v156, v144
  v_mov_b32 v157, v145
  v_mov_b32 v158, v146
  v_mov_b32 v159, v147
  s_waitcnt vmcnt(8)
  s_add_u32 s76, s76, 98304
  s_add_u32 s77, s77, 114688
  s_add_u32 m0, s37, 9216
  s_nop 0
  buffer_load_dwordx4 v3, s[12:15], s76 offen lds
  v_lshlrev_b32 v160, 16, v34
  v_and_b32 v161, s38, v34
  v_lshlrev_b32 v162, 16, v35
  v_and_b32 v163, s38, v35
  v_mov_b32 v164, v160
  v_mov_b32 v165, v161
  v_mov_b32 v166, v162
  v_mov_b32 v167, v163
  v_mov_b32 v168, v160
  v_mov_b32 v169, v161
  v_mov_b32 v170, v162
  v_mov_b32 v171, v163
  v_mov_b32 v172, v160
  v_mov_b32 v173, v161
  v_mov_b32 v174, v162
  v_mov_b32 v175, v163
  s_waitcnt vmcnt(8)
  s_add_u32 m0, s37, 10240
  s_nop 0
  buffer_load_dwordx4 v4, s[12:15], s76 offen lds
  v_lshlrev_b32 v176, 16, v36
  v_and_b32 v177, s38, v36
  v_lshlrev_b32 v178, 16, v37
  v_and_b32 v179, s38, v37
  v_mov_b32 v180, v176
  v_mov_b32 v181, v177
  v_mov_b32 v182, v178
  v_mov_b32 v183, v179
  v_mov_b32 v184, v176
  v_mov_b32 v185, v177
  v_mov_b32 v186, v178
  v_mov_b32 v187, v179
  v_mov_b32 v188, v176
  v_mov_b32 v189, v177
  v_mov_b32 v190, v178
  v_mov_b32 v191, v179
  s_waitcnt vmcnt(8)
  s_add_u32 m0, s37, 11264
  s_nop 0
  buffer_load_dwordx4 v5, s[12:15], s76 offen lds
  v_lshlrev_b32 v192, 16, v38
  v_and_b32 v193, s38, v38
  v_lshlrev_b32 v194, 16, v39
  v_and_b32 v195, s38, v39
  v_mov_b32 v196, v192
  v_mov_b32 v197, v193
  v_mov_b32 v198, v194
  v_mov_b32 v199, v195
  v_mov_b32 v200, v192
  v_mov_b32 v201, v193
  v_mov_b32 v202, v194
  v_mov_b32 v203, v195
  v_mov_b32 v204, v192
  v_mov_b32 v205, v193
  v_mov_b32 v206, v194
  v_mov_b32 v207, v195
  s_waitcnt vmcnt(8)
  s_add_u32 m0, s37, 24576
  s_nop 0
  buffer_load_dwordx4 v6, s[16:19], s77 offen lds
  v_lshlrev_b32 v208, 16, v40
  v_and_b32 v209, s38, v40
  v_lshlrev_b32 v210, 16, v41
  v_and_b32 v211, s38, v41
  v_mov_b32 v212, v208
  v_mov_b32 v213, v209
  v_mov_b32 v214, v210
  v_mov_b32 v215, v211
  v_mov_b32 v216, v208
  v_mov_b32 v217, v209
  v_mov_b32 v218, v210
  v_mov_b32 v219, v211
  v_mov_b32 v220, v208
  v_mov_b32 v221, v209
  v_mov_b32 v222, v210
  v_mov_b32 v223, v211
  s_waitcnt vmcnt(8)
  s_add_u32 m0, s37, 25600
  s_nop 0
  buffer_load_dwordx4 v7, s[16:19], s77 offen lds
  v_lshlrev_b32 v224, 16, v42
  v_and_b32 v225, s38, v42
  v_lshlrev_b32 v226, 16, v43
  v_and_b32 v227, s38, v43
  v_mov_b32 v228, v224
  v_mov_b32 v229, v225
  v_mov_b32 v230, v226
  v_mov_b32 v231, v227
  v_mov_b32 v232, v224
  v_mov_b32 v233, v225
  v_mov_b32 v234, v226
  v_mov_b32 v235, v227
  v_mov_b32 v236, v224
  v_mov_b32 v237, v225
  v_mov_b32 v238, v226
  v_mov_b32 v239, v227
  s_waitcnt vmcnt(8)
  s_add_u32 m0, s37, 26624
  s_nop 0
  buffer_load_dwordx4 v8, s[16:19], s77 offen lds
  v_lshlrev_b32 v240, 16, v44
  v_and_b32 v241, s38, v44
  v_lshlrev_b32 v242, 16, v45
  v_and_b32 v243, s38, v45
  v_mov_b32 v244, v240
  v_mov_b32 v245, v241
  v_mov_b32 v246, v242
  v_mov_b32 v247, v243
  v_mov_b32 v248, v240
  v_mov_b32 v249, v241
  v_mov_b32 v250, v242
  v_mov_b32 v251, v243
  v_mov_b32 v252, v240
  v_mov_b32 v253, v241
  v_mov_b32 v254, v242
  v_mov_b32 v255, v243
  s_waitcnt vmcnt(8)
  s_add_u32 m0, s37, 27648
  s_nop 0
  buffer_load_dwordx4 v9, s[16:19], s77 offen lds
  s_waitcnt vmcnt(8)
  v_cmp_ne_u64 vcc, 0, v[26:27]
  s_cmp_eq_u64 vcc, exec
  s_cbranch_scc1 L_polld12
  s_mov_b32 s63, 0x40000
L_poll11:
  buffer_load_dwordx2 v[26:27], off, s[64:67], 0 sc1
  s_waitcnt vmcnt(0)
  v_cmp_ne_u64 vcc, 0, v[26:27]
  s_cmp_eq_u64 vcc, exec
  s_cbranch_scc1 L_polld12
  s_sleep 1
  s_sub_u32 s63, s63, 1
  s_cmp_lg_u32 s63, 0
  s_cbranch_scc1 L_poll11
L_polld12:
  s_branch L_join10
L_join9:
  v_mov_b32 v48, 0
  v_mov_b32 v49, 0
  v_mov_b32 v50, 0
  v_mov_b32 v51, 0
  v_mov_b32 v52, 0
  v_mov_b32 v53, 0
  v_mov_b32 v54, 0
  v_mov_b32 v55, 0
  v_mov_b32 v56, 0
  v_mov_b32 v57, 0
  v_mov_b32 v58, 0
  v_mov_b32 v59, 0
  v_mov_b32 v60, 0
  v_mov_b32 v61, 0
  v_mov_b32 v62, 0
  v_mov_b32 v63, 0
  v_mov_b32 v64, 0
  v_mov_b32 v65, 0
  v_mov_b32 v66, 0
  v_mov_b32 v67, 0
  v_mov_b32 v68, 0
  v_mov_b32 v69, 0
  v_mov_b32 v70, 0
  v_mov_b32 v71, 0
  v_mov_b32 v72, 0
  v_mov_b32 v73, 0
  v_mov_b32 v74, 0
  v_mov_b32 v75, 0
  v_mov_b32 v76, 0
  v_mov_b32 v77, 0
  v_mov_b32 v78, 0
  v_mov_b32 v79, 0
  v_mov_b32 v80, 0
  v_mov_b32 v81, 0
  v_mov_b32 v82, 0
  v_mov_b32 v83, 0
  v_mov_b32 v84, 0
  v_mov_b32 v85, 0
  v_mov_b32 v86, 0
  v_mov_b32 v87, 0
  v_mov_b32 v88, 0
  v_mov_b32 v89, 0
  v_mov_b32 v90, 0
  v_mov_b32 v91, 0
  v_mov_b32 v92, 0
  v_mov_b32 v93, 0
  v_mov_b32 v94, 0
  v_mov_b32 v95, 0
  v_mov_b32 v96, 0
  v_mov_b32 v97, 0
  v_mov_b32 v98, 0
  v_mov_b32 v99, 0
  v_mov_b32 v100, 0
  v_mov_b32 v101, 0
  v_mov_b32 v102, 0
  v_mov_b32 v103, 0
  v_mov_b32 v104, 0
  v_mov_b32 v105, 0
  v_mov_b32 v106, 0
  v_mov_b32 v107, 0
  v_mov_b32 v108, 0
  v_mov_b32 v109, 0
  v_mov_b32 v110, 0
  v_mov_b32 v111, 0
  v_mov_b32 v112, 0
  v_mov_b32 v113, 0
  v_mov_b32 v114, 0
  v_mov_b32 v115, 0
  v_mov_b32 v116, 0
  v_mov_b32 v117, 0
  v_mov_b32 v118, 0
  v_mov_b32 v119, 0
  v_mov_b32 v120, 0
  v_mov_b32 v121, 0
  v_mov_b32 v122, 0
  v_mov_b32 v123, 0
  v_mov_b32 v124, 0
  v_mov_b32 v125, 0
  v_mov_b32 v126, 0
  v_mov_b32 v127, 0
  v_mov_b32 v128, 0
  v_mov_b32 v129, 0
  v_mov_b32 v130, 0
  v_mov_b32 v131, 0
  v_mov_b32 v132, 0
  v_mov_b32 v133, 0
  v_mov_b32 v134, 0
  v_mov_b32 v135, 0
  v_mov_b32 v136, 0
  v_mov_b32 v137, 0
  v_mov_b32 v138, 0
  v_mov_b32 v139, 0
  v_mov_b32 v140, 0
  v_mov_b32 v141, 0
  v_mov_b32 v142, 0
  v_mov_b32 v143, 0
  v_lshlrev_b32 v144, 16, v32
  v_and_b32 v145, s38, v32
  v_lshlrev_b32 v146, 16, v33
  v_and_b32 v147, s38, v33
  v_mov_b32 v148, v144
  v_mov_b32 v149, v145
  v_mov_b32 v150, v146
  v_mov_b32 v151, v147
  v_mov_b32 v152, v144
  v_mov_b32 v153, v145
  v_mov_b32 v154, v146
  v_mov_b32 v155, v147
  v_mov_b32 v156, v144
  v_mov_b32 v157, v145
  v_mov_b32 v158, v146
  v_mov_b32 v159, v147
  v_lshlrev_b32 v160, 16, v34
  v_and_b32 v161, s38, v34
  v_lshlrev_b32 v162, 16, v35
  v_and_b32 v163, s38, v35
  v_mov_b32 v164, v160
  v_mov_b32 v165, v161
  v_mov_b32 v166, v162
  v_mov_b32 v167, v163
  v_mov_b32 v168, v160
  v_mov_b32 v169, v161
  v_mov_b32 v170, v162
  v_mov_b32 v171, v163
  v_mov_b32 v172, v160
  v_mov_b32 v173, v161
  v_mov_b32 v174, v162
  v_mov_b32 v175, v163
  v_lshlrev_b32 v176, 16, v36
  v_and_b32 v177, s38, v36
  v_lshlrev_b32 v178, 16, v37
  v_and_b32 v179, s38, v37
  v_mov_b32 v180, v176
  v_mov_b32 v181, v177
  v_mov_b32 v182, v178
  v_mov_b32 v183, v179
  v_mov_b32 v184, v176
  v_mov_b32 v185, v177
  v_mov_b32 v186, v178
  v_mov_b32 v187, v179
  v_mov_b32 v188, v176
  v_mov_b32 v189, v177
  v_mov_b32 v190, v178
  v_mov_b32 v191, v179
  v_lshlrev_b32 v192, 16, v38
  v_and_b32 v193, s38, v38
  v_lshlrev_b32 v194, 16, v39
  v_and_b32 v195, s38, v39
  v_mov_b32 v196, v192
  v_mov_b32 v197, v193
  v_mov_b32 v198, v194
  v_mov_b32 v199, v195
  v_mov_b32 v200, v192
  v_mov_b32 v201, v193
  v_mov_b32 v202, v194
  v_mov_b32 v203, v195
  v_mov_b32 v204, v192
  v_mov_b32 v205, v193
  v_mov_b32 v206, v194
  v_mov_b32 v207, v195
  v_lshlrev_b32 v208, 16, v40
  v_and_b32 v209, s38, v40
  v_lshlrev_b32 v210, 16, v41
  v_and_b32 v211, s38, v41
  v_mov_b32 v212, v208
  v_mov_b32 v213, v209
  v_mov_b32 v214, v210
  v_mov_b32 v215, v211
  v_mov_b32 v216, v208
  v_mov_b32 v217, v209
  v_mov_b32 v218, v210
  v_mov_b32 v219, v211
  v_mov_b32 v220, v208
  v_mov_b32 v221, v209
  v_mov_b32 v222, v210
  v_mov_b32 v223, v211
  v_lshlrev_b32 v224, 16, v42
  v_and_b32 v225, s38, v42
  v_lshlrev_b32 v226, 16, v43
  v_and_b32 v227, s38, v43
  v_mov_b32 v228, v224
  v_mov_b32 v229, v225
  v_mov_b32 v230, v226
  v_mov_b32 v231, v227
  v_mov_b32 v232, v224
  v_mov_b32 v233, v225
  v_mov_b32 v234, v226
  v_mov_b32 v235, v227
  v_mov_b32 v236, v224
  v_mov_b32 v237, v225
  v_mov_b32 v238, v226
  v_mov_b32 v239, v227
  v_lshlrev_b32 v240, 16, v44
  v_and_b32 v241, s38, v44
  v_lshlrev_b32 v242, 16, v45
  v_and_b32 v243, s38, v45
  v_mov_b32 v244, v240
  v_mov_b32 v245, v241
  v_mov_b32 v246, v242
  v_mov_b32 v247, v243
  v_mov_b32 v248, v240
  v_mov_b32 v249, v241
  v_mov_b32 v250, v242
  v_mov_b32 v251, v243
  v_mov_b32 v252, v240
  v_mov_b32 v253, v241
  v_mov_b32 v254, v242
  v_mov_b32 v255, v243
L_join10:
  v_readfirstlane_b32 s46, v26
  v_readfirstlane_b32 s47, v27
  s_mul_i32 s76, s30, 16*6144
  s_mul_i32 s77, s30, 16*7168
  v_add_u32 v3, s76, v3
  v_add_u32 v4, s76, v4
  v_add_u32 v5, s76, v5
  v_add_u32 v6, s77, v6
  v_add_u32 v7, s77, v7
  v_add_u32 v8, s77, v8
  v_add_u32 v9, s77, v9
  v_lshlrev_b32 v16, 3, v17
  s_lshl_b32 s3, s2, 11
  s_lshl_b32 s32, s30, 9
  s_add_u32 s32, s32, s3
  s_mov_b32 s76, s32
  s_mov_b32 s77, s32
  s_mov_b32 s24, s52
  s_mov_b32 s25, s53
  s_mov_b32 s26, 7340032
  s_mov_b32 s27, 0x20000
  s_mov_b32 s4, s44
  s_mov_b32 s5, s45
  s_mov_b32 s6, 2097152
  s_mov_b32 s7, 0x20000
  v_lshlrev_b32 v16, 4, v17
  s_lshl_b32 s3, s2, 2
  s_add_u32 s3, s3, s30
  s_lshl_b32 s32, s3, 10
  s_mul_i32 s77, s3, 3072
  s_lshr_b32 s76, s3, 7
  s_add_u32 s76, s76, 1
  s_mul_i32 s76, s76, 393216
  s_add_u32 s76, s76, s77
  s_mov_b32 s24, s42
  s_mov_b32 s25, s43
  s_mov_b32 s26, 6291456
  s_mov_b32 s27, 0x20000
  v_and_b32 v23, 15, v17
  v_lshlrev_b32 v23, 3, v23
  s_lshl_b32 s3, s30, 7
  s_add_u32 s3, s3, s98
  s_mov_b32 s63, 0x40000
L_poll13:
  buffer_load_dwordx2 v[24:25], v23, s[72:75], s3 offen sc1
  s_waitcnt vmcnt(0)
  v_cmp_eq_u64 vcc, s[46:47], v[24:25]
  s_cmp_eq_u64 vcc, exec
  s_cbranch_scc1 L_polld14
  s_sleep 1
  s_sub_u32 s63, s63, 1
  s_cmp_lg_u32 s63, 0
  s_cbranch_scc1 L_poll13
L_polld14:
  buffer_load_dwordx4 a[0:3], v1, s[8:11], s31 offen offset:0 sc1
  buffer_load_dwordx4 a[4:7], v1, s[8:11], s31 offen offset:1024 sc1
  buffer_load_dwordx4 a[8:11], v1, s[8:11], s31 offen offset:2048 sc1
  buffer_load_dwordx4 a[12:15], v1, s[8:11], s31 offen offset:3072 sc1
  buffer_load_dwordx4 a[16:19], v2, s[8:11], s31 offen offset:0 sc1
  buffer_load_dwordx4 a[20:23], v2, s[8:11], s31 offen offset:1024 sc1
  buffer_load_dwordx4 a[24:27], v2, s[8:11], s31 offen offset:2048 sc1
  buffer_load_dwordx4 a[28:31], v2, s[8:11], s31 offen offset:3072 sc1
  s_add_u32 s31, s31, 16384
  s_and_b32 s31, s31, 0x1ffff
  buffer_load_dwordx4 a[32:35], v1, s[8:11], s31 offen offset:0 sc1
  buffer_load_dwordx4 a[36:39], v1, s[8:11], s31 offen offset:1024 sc1
  buffer_load_dwordx4 a[40:43], v1, s[8:11], s31 offen offset:2048 sc1
  buffer_load_dwordx4 a[44:47], v1, s[8:11], s31 offen offset:3072 sc1
  v_lshlrev_b32 v23, 3, v17
  s_barrier
  ds_read_b64_tr_b16 a[128:129], v10 offset:0
  ds_read_b64_tr_b16 a[130:131], v10 offset:768
  ds_read_b64_tr_b16 a[132:133], v12 offset:32
  ds_read_b64_tr_b16 a[134:135], v12 offset:800
  ds_read_b64_tr_b16 a[136:137], v10 offset:64
  ds_read_b64_tr_b16 a[138:139], v10 offset:832
  ds_read_b64_tr_b16 a[140:141], v12 offset:96
  ds_read_b64_tr_b16 a[142:143], v12 offset:864
  ds_read_b64_tr_b16 a[144:145], v10 offset:128
  ds_read_b64_tr_b16 a[146:147], v10 offset:896
  ds_read_b64_tr_b16 a[148:149], v12 offset:160
  ds_read_b64_tr_b16 a[150:151], v12 offset:928
  ds_read_b64_tr_b16 a[152:153], v14 offset:12288
  ds_read_b64_tr_b16 a[154:155], v14 offset:13312
  ds_read_b64_tr_b16 a[156:157], v14 offset:12320
  ds_read_b64_tr_b16 a[158:159], v14 offset:13344
  ds_read_b64_tr_b16 a[160:161], v14 offset:12352
  ds_read_b64_tr_b16 a[162:163], v14 offset:13376
  ds_read_b64_tr_b16 a[164:165], v14 offset:12384
  ds_read_b64_tr_b16 a[166:167], v14 offset:13408
  ds_read_b64_tr_b16 a[168:169], v14 offset:12416
  ds_read_b64_tr_b16 a[170:171], v14 offset:13440
  ds_read_b64_tr_b16 a[172:173], v14 offset:12448
  ds_read_b64_tr_b16 a[174:175], v14 offset:13472
  ds_read_b64_tr_b16 a[176:177], v14 offset:12480
  ds_read_b64_tr_b16 a[178:179], v14 offset:13504
  s_mov_b32 s37, 3
L_g1_loop:
  s_cmp_lg_u32 s37, 3
  s_cbranch_scc1 L_w21
  s_waitcnt vmcnt(8)
L_w21:
  s_waitcnt vmcnt(15) lgkmcnt(4)
  v_mfma_f32_16x16x32_bf16 v[48:51], a[128:131], a[0:3], v[48:51]
  v_mfma_f32_16x16x32_bf16 v[52:55], a[128:131], a[4:7], v[52:55]
  v_mfma_f32_16x16x32_bf16 v[56:59], a[128:131], a[8:11], v[56:59]
  v_mfma_f32_16x16x32_bf16 v[60:63], a[128:131], a[12:15], v[60:63]
  v_mfma_f32_16x16x32_bf16 v[76:79], a[132:135], a[12:15], v[76:79]
  ds_read_b64_tr_b16 a[128:129], v10 offset:6144
  v_mfma_f32_16x16x32_bf16 v[72:75], a[132:135], a[8:11], v[72:75]
  ds_read_b64_tr_b16 a[130:131], v10 offset:6912
  v_mfma_f32_16x16x32_bf16 v[68:71], a[132:135], a[4:7], v[68:71]
  buffer_load_dwordx4 a[48:51], v2, s[8:11], s31 offen offset:0 sc1
  v_mfma_f32_16x16x32_bf16 v[64:67], a[132:135], a[0:3], v[64:67]
  v_mfma_f32_16x16x32_bf16 v[80:83], a[136:139], a[0:3], v[80:83]
  ds_read_b64_tr_b16 a[132:133], v12 offset:6176
  v_mfma_f32_16x16x32_bf16 v[84:87], a[136:139], a[4:7], v[84:87]
  v_mfma_f32_16x16x32_bf16 v[88:91], a[136:139], a[8:11], v[88:91]
  ds_read_b64_tr_b16 a[134:135], v12 offset:6944
  v_mfma_f32_16x16x32_bf16 v[92:95], a[136:139], a[12:15], v[92:95]
  s_cmp_lg_u32 s37, 3
  s_cbranch_scc1 L_cu22
  s_add_u32 m0, s35, 57344
  s_nop 0
  buffer_load_dwordx4 v3, s[12:15], s33 offen lds
  s_add_u32 m0, s35, 58368
  s_nop 0
  buffer_load_dwordx4 v4, s[12:15], s33 offen lds
  s_add_u32 m0, s35, 59392
  s_nop 0
  buffer_load_dwordx4 v5, s[12:15], s33 offen lds
  s_add_u32 m0, s36, 57344
  s_nop 0
  buffer_load_dwordx4 v6, s[16:19], s34 offen lds
  s_add_u32 m0, s36, 58368
  s_nop 0
  buffer_load_dwordx4 v7, s[16:19], s34 offen lds
  s_add_u32 m0, s36, 59392
  s_nop 0
  buffer_load_dwordx4 v8, s[16:19], s34 offen lds
  s_add_u32 m0, s36, 60416
  s_nop 0
  buffer_load_dwordx4 v9, s[16:19], s34 offen lds
  s_add_u32 s33, s33, 786432
  s_cmp_ge_u32 s33, 6291456
  s_cselect_b32 s3, 6291456, 0
  s_sub_u32 s33, s33, s3
  s_add_u32 s34, s34, 917504
  s_cmp_ge_u32 s34, 7340032
  s_cselect_b32 s3, 7340032, 0
  s_sub_u32 s34, s34, s3
L_cu22:
  v_mfma_f32_16x16x32_bf16 v[108:111], a[140:143], a[12:15], v[108:111]
  ds_read_b64_tr_b16 a[136:137], v10 offset:6208
  v_mfma_f32_16x16x32_bf16 v[104:107], a[140:143], a[8:11], v[104:107]
  v_mfma_f32_16x16x32_bf16 v[100:103], a[140:143], a[4:7], v[100:103]
  ds_read_b64_tr_b16 a[138:139], v10 offset:6976
  v_mfma_f32_16x16x32_bf16 v[96:99], a[140:143], a[0:3], v[96:99]
  v_mfma_f32_16x16x32_bf16 v[112:115], a[0:3], a[144:147], v[112:115]
  ds_read_b64_tr_b16 a[140:141], v12 offset:6240
  v_mfma_f32_16x16x32_bf16 v[116:119], a[4:7], a[144:147], v[116:119]
  ds_read_b64_tr_b16 a[142:143], v12 offset:7008
  v_mfma_f32_16x16x32_bf16 v[120:123], a[8:11], a[144:147], v[120:123]
  buffer_load_dwordx4 a[52:55], v2, s[8:11], s31 offen offset:1024 sc1
  v_mfma_f32_16x16x32_bf16 v[124:127], a[12:15], a[144:147], v[124:127]
  v_mfma_f32_16x16x32_bf16 v[140:143], a[12:15], a[148:151], v[140:143]
  ds_read_b64_tr_b16 a[144:145], v10 offset:6272
  v_mfma_f32_16x16x32_bf16 v[136:139], a[8:11], a[148:151], v[136:139]
  v_mfma_f32_16x16x32_bf16 v[132:135], a[4:7], a[148:151], v[132:135]
  ds_read_b64_tr_b16 a[146:147], v10 offset:7040
  v_mfma_f32_16x16x32_bf16 v[128:131], a[0:3], a[148:151], v[128:131]
  v_mfma_f32_16x16x32_bf16 v[144:147], a[152:155], a[0:3], v[144:147]
  ds_read_b64_tr_b16 a[148:149], v12 offset:6304
  v_mfma_f32_16x16x32_bf16 v[148:151], a[152:155], a[4:7], v[148:151]
  v_mfma_f32_16x16x32_bf16 v[152:155], a[152:155], a[8:11], v[152:155]
  ds_read_b64_tr_b16 a[150:151], v12 offset:7072
  v_mfma_f32_16x16x32_bf16 v[156:159], a[152:155], a[12:15], v[156:159]
  s_waitcnt lgkmcnt(4)
  v_mfma_f32_16x16x32_bf16 v[172:175], a[156:159], a[12:15], v[172:175]
  ds_read_b64_tr_b16 a[152:153], v14 offset:20480
  v_mfma_f32_16x16x32_bf16 v[168:171], a[156:159], a[8:11], v[168:171]
  ds_read_b64_tr_b16 a[154:155], v14 offset:21504
  v_mfma_f32_16x16x32_bf16 v[164:167], a[156:159], a[4:7], v[164:167]
  buffer_load_dwordx4 a[56:59], v2, s[8:11], s31 offen offset:2048 sc1
  v_mfma_f32_16x16x32_bf16 v[160:163], a[156:159], a[0:3], v[160:163]
  v_mfma_f32_16x16x32_bf16 v[176:179], a[160:163], a[0:3], v[176:179]
  ds_read_b64_tr_b16 a[156:157], v14 offset:20512
  v_mfma_f32_16x16x32_bf16 v[180:183], a[160:163], a[4:7], v[180:183]
  v_mfma_f32_16x16x32_bf16 v[184:187], a[160:163], a[8:11], v[184:187]
  ds_read_b64_tr_b16 a[158:159], v14 offset:21536
  v_mfma_f32_16x16x32_bf16 v[188:191], a[160:163], a[12:15], v[188:191]
  s_cmp_lg_u32 s37, 3
  s_cbranch_scc1 L_cu23
  s_add_u32 m0, s35, 86016
  s_nop 0
  buffer_load_dwordx4 v3, s[12:15], s33 offen lds
  s_add_u32 m0, s35, 87040
  s_nop 0
  buffer_load_dwordx4 v4, s[12:15], s33 offen lds
  s_add_u32 m0, s35, 88064
  s_nop 0
  buffer_load_dwordx4 v5, s[12:15], s33 offen lds
  s_add_u32 m0, s36, 86016
  s_nop 0
  buffer_load_dwordx4 v6, s[16:19], s34 offen lds
  s_add_u32 m0, s36, 87040
  s_nop 0
  buffer_load_dwordx4 v7, s[16:19], s34 offen lds
  s_add_u32 m0, s36, 88064
  s_nop 0
  buffer_load_dwordx4 v8, s[16:19], s34 offen lds
  s_add_u32 m0, s36, 89088
  s_nop 0
  buffer_load_dwordx4 v9, s[16:19], s34 offen lds
  s_add_u32 s33, s33, 786432
  s_cmp_ge_u32 s33, 6291456
  s_cselect_b32 s3, 6291456, 0
  s_sub_u32 s33, s33, s3
  s_add_u32 s34, s34, 917504
  s_cmp_ge_u32 s34, 7340032
  s_cselect_b32 s3, 7340032, 0
  s_sub_u32 s34, s34, s3
L_cu23:
  v_mfma_f32_16x16x32_bf16 v[204:207], a[164:167], a[12:15], v[204:207]
  ds_read_b64_tr_b16 a[160:161], v14 offset:20544
  v_mfma_f32_16x16x32_bf16 v[200:203], a[164:167], a[8:11], v[200:203]
  v_mfma_f32_16x16x32_bf16 v[196:199], a[164:167], a[4:7], v[196:199]
  ds_read_b64_tr_b16 a[162:163], v14 offset:21568
  v_mfma_f32_16x16x32_bf16 v[192:195], a[164:167], a[0:3], v[192:195]
  v_mfma_f32_16x16x32_bf16 v[208:211], a[168:171], a[0:3], v[208:211]
  ds_read_b64_tr_b16 a[164:165], v14 offset:20576
  v_mfma_f32_16x16x32_bf16 v[212:215], a[168:171], a[4:7], v[212:215]
  ds_read_b64_tr_b16 a[166:167], v14 offset:21600
  v_mfma_f32_16x16x32_bf16 v[216:219], a[168:171], a[8:11], v[216:219]
  buffer_load_dwordx4 a[60:63], v2, s[8:11], s31 offen offset:3072 sc1
  v_mfma_f32_16x16x32_bf16 v[220:223], a[168:171], a[12:15], v[220:223]
  v_mfma_f32_16x16x32_bf16 v[236:239], a[172:175], a[12:15], v[236:239]
  ds_read_b64_tr_b16 a[168:169], v14 offset:20608
  v_mfma_f32_16x16x32_bf16 v[232:235], a[172:175], a[8:11], v[232:235]
  v_mfma_f32_16x16x32_bf16 v[228:231], a[172:175], a[4:7], v[228:231]
  ds_read_b64_tr_b16 a[170:171], v14 offset:21632
  v_mfma_f32_16x16x32_bf16 v[224:227], a[172:175], a[0:3], v[224:227]
  v_mfma_f32_16x16x32_bf16 v[240:243], a[176:179], a[0:3], v[240:243]
  ds_read_b64_tr_b16 a[172:173], v14 offset:20640
  v_mfma_f32_16x16x32_bf16 v[244:247], a[176:179], a[4:7], v[244:247]
  ds_read_b64_tr_b16 a[174:175], v14 offset:21664
  v_mfma_f32_16x16x32_bf16 v[248:251], a[176:179], a[8:11], v[248:251]
  s_add_u32 s31, s31, 16384
  v_mfma_f32_16x16x32_bf16 v[252:255], a[176:179], a[12:15], v[252:255]
  s_and_b32 s31, s31, 0x1ffff
  ds_read_b64_tr_b16 a[176:177], v14 offset:20672
  ds_read_b64_tr_b16 a[178:179], v14 offset:21696
  s_waitcnt vmcnt(15) lgkmcnt(4)
  v_mfma_f32_16x16x32_bf16 v[48:51], a[128:131], a[16:19], v[48:51]
  v_mfma_f32_16x16x32_bf16 v[52:55], a[128:131], a[20:23], v[52:55]
  v_mfma_f32_16x16x32_bf16 v[56:59], a[128:131], a[24:27], v[56:59]
  v_mfma_f32_16x16x32_bf16 v[60:63], a[128:131], a[28:31], v[60:63]
  v_mfma_f32_16x16x32_bf16 v[76:79], a[132:135], a[28:31], v[76:79]
  v_mfma_f32_16x16x32_bf16 v[72:75], a[132:135], a[24:27], v[72:75]
  v_mfma_f32_16x16x32_bf16 v[68:71], a[132:135], a[20:23], v[68:71]
  v_mfma_f32_16x16x32_bf16 v[64:67], a[132:135], a[16:19], v[64:67]
  s_waitcnt lgkmcnt(0)
  s_barrier
  v_mfma_f32_16x16x32_bf16 v[80:83], a[136:139], a[16:19], v[80:83]
  ds_read_b64_tr_b16 a[128:129], v10 offset:28672
  ds_read_b64_tr_b16 a[130:131], v10 offset:29440
  v_mfma_f32_16x16x32_bf16 v[84:87], a[136:139], a[20:23], v[84:87]
  ds_read_b64_tr_b16 a[132:133], v12 offset:28704
  v_mfma_f32_16x16x32_bf16 v[88:91], a[136:139], a[24:27], v[88:91]
  ds_read_b64_tr_b16 a[134:135], v12 offset:29472
  s_add_u32 m0, s35, 0
  v_mfma_f32_16x16x32_bf16 v[92:95], a[136:139], a[28:31], v[92:95]
  buffer_load_dwordx4 v3, s[12:15], s33 offen lds
  v_mfma_f32_16x16x32_bf16 v[108:111], a[140:143], a[28:31], v[108:111]
  ds_read_b64_tr_b16 a[136:137], v10 offset:28736
  v_mfma_f32_16x16x32_bf16 v[104:107], a[140:143], a[24:27], v[104:107]
  ds_read_b64_tr_b16 a[138:139], v10 offset:29504
  v_mfma_f32_16x16x32_bf16 v[100:103], a[140:143], a[20:23], v[100:103]
  s_add_u32 m0, s35, 1024
  v_mfma_f32_16x16x32_bf16 v[96:99], a[140:143], a[16:19], v[96:99]
  buffer_load_dwordx4 v4, s[12:15], s33 offen lds
  v_mfma_f32_16x16x32_bf16 v[112:115], a[16:19], a[144:147], v[112:115]
  ds_read_b64_tr_b16 a[140:141], v12 offset:28768
  v_mfma_f32_16x16x32_bf16 v[116:119], a[20:23], a[144:147], v[116:119]
  ds_read_b64_tr_b16 a[142:143], v12 offset:29536
  v_mfma_f32_16x16x32_bf16 v[120:123], a[24:27], a[144:147], v[120:123]
  s_add_u32 m0, s35, 2048
  v_mfma_f32_16x16x32_bf16 v[124:127], a[28:31], a[144:147], v[124:127]
  buffer_load_dwordx4 v5, s[12:15], s33 offen lds
  v_mfma_f32_16x16x32_bf16 v[140:143], a[28:31], a[148:151], v[140:143]
  ds_read_b64_tr_b16 a[144:145], v10 offset:28800
  v_mfma_f32_16x16x32_bf16 v[136:139], a[24:27], a[148:151], v[136:139]
  ds_read_b64_tr_b16 a[146:147], v10 offset:29568
  v_mfma_f32_16x16x32_bf16 v[132:135], a[20:23], a[148:151], v[132:135]
  s_add_u32 m0, s36, 0
  v_mfma_f32_16x16x32_bf16 v[128:131], a[16:19], a[148:151], v[128:131]
  buffer_load_dwordx4 v6, s[16:19], s34 offen lds
  v_mfma_f32_16x16x32_bf16 v[144:147], a[152:155], a[16:19], v[144:147]
  ds_read_b64_tr_b16 a[148:149], v12 offset:28832
  v_mfma_f32_16x16x32_bf16 v[148:151], a[152:155], a[20:23], v[148:151]
  ds_read_b64_tr_b16 a[150:151], v12 offset:29600
  v_mfma_f32_16x16x32_bf16 v[152:155], a[152:155], a[24:27], v[152:155]
  s_add_u32 m0, s36, 1024
  v_mfma_f32_16x16x32_bf16 v[156:159], a[152:155], a[28:31], v[156:159]
  buffer_load_dwordx4 v7, s[16:19], s34 offen lds
  v_mfma_f32_16x16x32_bf16 v[172:175], a[156:159], a[28:31], v[172:175]
  ds_read_b64_tr_b16 a[152:153], v14 offset:40960
  v_mfma_f32_16x16x32_bf16 v[168:171], a[156:159], a[24:27], v[168:171]
  ds_read_b64_tr_b16 a[154:155], v14 offset:41984
  v_mfma_f32_16x16x32_bf16 v[164:167], a[156:159], a[20:23], v[164:167]
  s_add_u32 m0, s36, 2048
  v_mfma_f32_16x16x32_bf16 v[160:163], a[156:159], a[16:19], v[160:163]
  buffer_load_dwordx4 v8, s[16:19], s34 offen lds
  v_mfma_f32_16x16x32_bf16 v[176:179], a[160:163], a[16:19], v[176:179]
  ds_read_b64_tr_b16 a[156:157], v14 offset:40992
  v_mfma_f32_16x16x32_bf16 v[180:183], a[160:163], a[20:23], v[180:183]
  ds_read_b64_tr_b16 a[158:159], v14 offset:42016
  v_mfma_f32_16x16x32_bf16 v[184:187], a[160:163], a[24:27], v[184:187]
  s_add_u32 m0, s36, 3072
  v_mfma_f32_16x16x32_bf16 v[188:191], a[160:163], a[28:31], v[188:191]
  buffer_load_dwordx4 v9, s[16:19], s34 offen lds
  v_mfma_f32_16x16x32_bf16 v[204:207], a[164:167], a[28:31], v[204:207]
  ds_read_b64_tr_b16 a[160:161], v14 offset:41024
  ds_read_b64_tr_b16 a[162:163], v14 offset:42048
  v_mfma_f32_16x16x32_bf16 v[200:203], a[164:167], a[24:27], v[200:203]
  buffer_load_dwordx4 a[64:67], v1, s[8:11], s31 offen offset:0 sc1
  s_add_u32 s33, s33, 786432
  v_mfma_f32_16x16x32_bf16 v[196:199], a[164:167], a[20:23], v[196:199]
  s_cmp_ge_u32 s33, 6291456
  s_cselect_b32 s3, 6291456, 0
  v_mfma_f32_16x16x32_bf16 v[192:195], a[164:167], a[16:19], v[192:195]
  s_sub_u32 s33, s33, s3
  v_mfma_f32_16x16x32_bf16 v[208:211], a[168:171], a[16:19], v[208:211]
  ds_read_b64_tr_b16 a[164:165], v14 offset:41056
  ds_read_b64_tr_b16 a[166:167], v14 offset:42080
  v_mfma_f32_16x16x32_bf16 v[212:215], a[168:171], a[20:23], v[212:215]
  buffer_load_dwordx4 a[68:71], v1, s[8:11], s31 offen offset:1024 sc1
  s_add_u32 s34, s34, 917504
  v_mfma_f32_16x16x32_bf16 v[216:219], a[168:171], a[24:27], v[216:219]
  s_cmp_ge_u32 s34, 7340032
  s_cselect_b32 s3, 7340032, 0
  v_mfma_f32_16x16x32_bf16 v[220:223], a[168:171], a[28:31], v[220:223]
  s_sub_u32 s34, s34, s3
  v_mfma_f32_16x16x32_bf16 v[236:239], a[172:175], a[28:31], v[236:239]
  ds_read_b64_tr_b16 a[168:169], v14 offset:41088
  v_mfma_f32_16x16x32_bf16 v[232:235], a[172:175], a[24:27], v[232:235]
  ds_read_b64_tr_b16 a[170:171], v14 offset:42112
  v_mfma_f32_16x16x32_bf16 v[228:231], a[172:175], a[20:23], v[228:231]
  buffer_load_dwordx4 a[72:75], v1, s[8:11], s31 offen offset:2048 sc1
  v_mfma_f32_16x16x32_bf16 v[224:227], a[172:175], a[16:19], v[224:227]
  v_mfma_f32_16x16x32_bf16 v[240:243], a[176:179], a[16:19], v[240:243]
  ds_read_b64_tr_b16 a[172:173], v14 offset:41120
  v_mfma_f32_16x16x32_bf16 v[244:247], a[176:179], a[20:23], v[244:247]
  ds_read_b64_tr_b16 a[174:175], v14 offset:42144
  v_mfma_f32_16x16x32_bf16 v[248:251], a[176:179], a[24:27], v[248:251]
  buffer_load_dwordx4 a[76:79], v1, s[8:11], s31 offen offset:3072 sc1
  v_mfma_f32_16x16x32_bf16 v[252:255], a[176:179], a[28:31], v[252:255]
  ds_read_b64_tr_b16 a[176:177], v14 offset:41152
  ds_read_b64_tr_b16 a[178:179], v14 offset:42176
  s_waitcnt vmcnt(15) lgkmcnt(4)
  v_mfma_f32_16x16x32_bf16 v[48:51], a[128:131], a[32:35], v[48:51]
  v_mfma_f32_16x16x32_bf16 v[52:55], a[128:131], a[36:39], v[52:55]
  v_mfma_f32_16x16x32_bf16 v[56:59], a[128:131], a[40:43], v[56:59]
  v_mfma_f32_16x16x32_bf16 v[60:63], a[128:131], a[44:47], v[60:63]
  v_mfma_f32_16x16x32_bf16 v[76:79], a[132:135], a[44:47], v[76:79]
  ds_read_b64_tr_b16 a[128:129], v10 offset:34816
  v_mfma_f32_16x16x32_bf16 v[72:75], a[132:135], a[40:43], v[72:75]
  ds_read_b64_tr_b16 a[130:131], v10 offset:35584
  v_mfma_f32_16x16x32_bf16 v[68:71], a[132:135], a[36:39], v[68:71]
  buffer_load_dwordx4 a[80:83], v2, s[8:11], s31 offen offset:0 sc1
  v_mfma_f32_16x16x32_bf16 v[64:67], a[132:135], a[32:35], v[64:67]
  v_mfma_f32_16x16x32_bf16 v[80:83], a[136:139], a[32:35], v[80:83]
  ds_read_b64_tr_b16 a[132:133], v12 offset:34848
  v_mfma_f32_16x16x32_bf16 v[84:87], a[136:139], a[36:39], v[84:87]
  v_mfma_f32_16x16x32_bf16 v[88:91], a[136:139], a[40:43], v[88:91]
  ds_read_b64_tr_b16 a[134:135], v12 offset:35616
  v_mfma_f32_16x16x32_bf16 v[92:95], a[136:139], a[44:47], v[92:95]
  v_mfma_f32_16x16x32_bf16 v[108:111], a[140:143], a[44:47], v[108:111]
  ds_read_b64_tr_b16 a[136:137], v10 offset:34880
  v_mfma_f32_16x16x32_bf16 v[104:107], a[140:143], a[40:43], v[104:107]
  v_mfma_f32_16x16x32_bf16 v[100:103], a[140:143], a[36:39], v[100:103]
  ds_read_b64_tr_b16 a[138:139], v10 offset:35648
  v_mfma_f32_16x16x32_bf16 v[96:99], a[140:143], a[32:35], v[96:99]
  v_mfma_f32_16x16x32_bf16 v[112:115], a[32:35], a[144:147], v[112:115]
  ds_read_b64_tr_b16 a[140:141], v12 offset:34912
  v_mfma_f32_16x16x32_bf16 v[116:119], a[36:39], a[144:147], v[116:119]
  ds_read_b64_tr_b16 a[142:143], v12 offset:35680
  v_mfma_f32_16x16x32_bf16 v[120:123], a[40:43], a[144:147], v[120:123]
  buffer_load_dwordx4 a[84:87], v2, s[8:11], s31 offen offset:1024 sc1
  v_mfma_f32_16x16x32_bf16 v[124:127], a[44:47], a[144:147], v[124:127]
  v_mfma_f32_16x16x32_bf16 v[140:143], a[44:47], a[148:151], v[140:143]
  ds_read_b64_tr_b16 a[144:145], v10 offset:34944
  v_mfma_f32_16x16x32_bf16 v[136:139], a[40:43], a[148:151], v[136:139]
  v_mfma_f32_16x16x32_bf16 v[132:135], a[36:39], a[148:151], v[132:135]
  ds_read_b64_tr_b16 a[146:147], v10 offset:35712
  v_mfma_f32_16x16x32_bf16 v[128:131], a[32:35], a[148:151], v[128:131]
  v_mfma_f32_16x16x32_bf16 v[144:147], a[152:155], a[32:35], v[144:147]
  ds_read_b64_tr_b16 a[148:149], v12 offset:34976
  v_mfma_f32_16x16x32_bf16 v[148:151], a[152:155], a[36:39], v[148:151]
  v_mfma_f32_16x16x32_bf16 v[152:155], a[152:155], a[40:43], v[152:155]
  ds_read_b64_tr_b16 a[150:151], v12 offset:35744
  v_mfma_f32_16x16x32_bf16 v[156:159], a[152:155], a[44:47], v[156:159]
  s_waitcnt lgkmcnt(4)
  v_mfma_f32_16x16x32_bf16 v[172:175], a[156:159], a[44:47], v[172:175]
  ds_read_b64_tr_b16 a[152:153], v14 offset:49152
  v_mfma_f32_16x16x32_bf16 v[168:171], a[156:159], a[40:43], v[168:171]
  ds_read_b64_tr_b16 a[154:155], v14 offset:50176
  v_mfma_f32_16x16x32_bf16 v[164:167], a[156:159], a[36:39], v[164:167]
  buffer_load_dwordx4 a[88:91], v2, s[8:11], s31 offen offset:2048 sc1
  v_mfma_f32_16x16x32_bf16 v[160:163], a[156:159], a[32:35], v[160:163]
  v_mfma_f32_16x16x32_bf16 v[176:179], a[160:163], a[32:35], v[176:179]
  ds_read_b64_tr_b16 a[156:157], v14 offset:49184
  v_mfma_f32_16x16x32_bf16 v[180:183], a[160:163], a[36:39], v[180:183]
  v_mfma_f32_16x16x32_bf16 v[184:187], a[160:163], a[40:43], v[184:187]
  ds_read_b64_tr_b16 a[158:159], v14 offset:50208
  v_mfma_f32_16x16x32_bf16 v[188:191], a[160:163], a[44:47], v[188:191]
  v_mfma_f32_16x16x32_bf16 v[204:207], a[164:167], a[44:47], v[204:207]
  ds_read_b64_tr_b16 a[160:161], v14 offset:49216
  v_mfma_f32_16x16x32_bf16 v[200:203], a[164:167], a[40:43], v[200:203]
  v_mfma_f32_16x16x32_bf16 v[196:199], a[164:167], a[36:39], v[196:199]
  ds_read_b64_tr_b16 a[162:163], v14 offset:50240
  v_mfma_f32_16x16x32_bf16 v[192:195], a[164:167], a[32:35], v[192:195]
  v_mfma_f32_16x16x32_bf16 v[208:211], a[168:171], a[32:35], v[208:211]
  ds_read_b64_tr_b16 a[164:165], v14 offset:49248
  v_mfma_f32_16x16x32_bf16 v[212:215], a[168:171], a[36:39], v[212:215]
  ds_read_b64_tr_b16 a[166:167], v14 offset:50272
  v_mfma_f32_16x16x32_bf16 v[216:219], a[168:171], a[40:43], v[216:219]
  buffer_load_dwordx4 a[92:95], v2, s[8:11], s31 offen offset:3072 sc1
  v_mfma_f32_16x16x32_bf16 v[220:223], a[168:171], a[44:47], v[220:223]
  v_mfma_f32_16x16x32_bf16 v[236:239], a[172:175], a[44:47], v[236:239]
  ds_read_b64_tr_b16 a[168:169], v14 offset:49280
  v_mfma_f32_16x16x32_bf16 v[232:235], a[172:175], a[40:43], v[232:235]
  v_mfma_f32_16x16x32_bf16 v[228:231], a[172:175], a[36:39], v[228:231]
  ds_read_b64_tr_b16 a[170:171], v14 offset:50304
  v_mfma_f32_16x16x32_bf16 v[224:227], a[172:175], a[32:35], v[224:227]
  v_mfma_f32_16x16x32_bf16 v[240:243], a[176:179], a[32:35], v[240:243]
  ds_read_b64_tr_b16 a[172:173], v14 offset:49312
  v_mfma_f32_16x16x32_bf16 v[244:247], a[176:179], a[36:39], v[244:247]
  ds_read_b64_tr_b16 a[174:175], v14 offset:50336
  v_mfma_f32_16x16x32_bf16 v[248:251], a[176:179], a[40:43], v[248:251]
  s_add_u32 s31, s31, 16384
  v_mfma_f32_16x16x32_bf16 v[252:255], a[176:179], a[44:47], v[252:255]
  s_and_b32 s31, s31, 0x1ffff
  ds_read_b64_tr_b16 a[176:177], v14 offset:49344
  ds_read_b64_tr_b16 a[178:179], v14 offset:50368
  s_waitcnt vmcnt(15) lgkmcnt(4)
  v_mfma_f32_16x16x32_bf16 v[48:51], a[128:131], a[48:51], v[48:51]
  v_mfma_f32_16x16x32_bf16 v[52:55], a[128:131], a[52:55], v[52:55]
  v_mfma_f32_16x16x32_bf16 v[56:59], a[128:131], a[56:59], v[56:59]
  v_mfma_f32_16x16x32_bf16 v[60:63], a[128:131], a[60:63], v[60:63]
  v_mfma_f32_16x16x32_bf16 v[76:79], a[132:135], a[60:63], v[76:79]
  v_mfma_f32_16x16x32_bf16 v[72:75], a[132:135], a[56:59], v[72:75]
  v_mfma_f32_16x16x32_bf16 v[68:71], a[132:135], a[52:55], v[68:71]
  v_mfma_f32_16x16x32_bf16 v[64:67], a[132:135], a[48:51], v[64:67]
  s_waitcnt lgkmcnt(0)
  s_barrier
  v_mfma_f32_16x16x32_bf16 v[80:83], a[136:139], a[48:51], v[80:83]
  ds_read_b64_tr_b16 a[128:129], v11 offset:0
  ds_read_b64_tr_b16 a[130:131], v11 offset:768
  v_mfma_f32_16x16x32_bf16 v[84:87], a[136:139], a[52:55], v[84:87]
  ds_read_b64_tr_b16 a[132:133], v13 offset:32
  v_mfma_f32_16x16x32_bf16 v[88:91], a[136:139], a[56:59], v[88:91]
  ds_read_b64_tr_b16 a[134:135], v13 offset:800
  s_add_u32 m0, s35, 28672
  v_mfma_f32_16x16x32_bf16 v[92:95], a[136:139], a[60:63], v[92:95]
  buffer_load_dwordx4 v3, s[12:15], s33 offen lds
  v_mfma_f32_16x16x32_bf16 v[108:111], a[140:143], a[60:63], v[108:111]
  ds_read_b64_tr_b16 a[136:137], v11 offset:64
  v_mfma_f32_16x16x32_bf16 v[104:107], a[140:143], a[56:59], v[104:107]
  ds_read_b64_tr_b16 a[138:139], v11 offset:832
  v_mfma_f32_16x16x32_bf16 v[100:103], a[140:143], a[52:55], v[100:103]
  s_add_u32 m0, s35, 29696
  v_mfma_f32_16x16x32_bf16 v[96:99], a[140:143], a[48:51], v[96:99]
  buffer_load_dwordx4 v4, s[12:15], s33 offen lds
  v_mfma_f32_16x16x32_bf16 v[112:115], a[48:51], a[144:147], v[112:115]
  ds_read_b64_tr_b16 a[140:141], v13 offset:96
  v_mfma_f32_16x16x32_bf16 v[116:119], a[52:55], a[144:147], v[116:119]
  ds_read_b64_tr_b16 a[142:143], v13 offset:864
  v_mfma_f32_16x16x32_bf16 v[120:123], a[56:59], a[144:147], v[120:123]
  s_add_u32 m0, s35, 30720
  v_mfma_f32_16x16x32_bf16 v[124:127], a[60:63], a[144:147], v[124:127]
  buffer_load_dwordx4 v5, s[12:15], s33 offen lds
  v_mfma_f32_16x16x32_bf16 v[140:143], a[60:63], a[148:151], v[140:143]
  ds_read_b64_tr_b16 a[144:145], v11 offset:128
  v_mfma_f32_16x16x32_bf16 v[136:139], a[56:59], a[148:151], v[136:139]
  ds_read_b64_tr_b16 a[146:147], v11 offset:896
  v_mfma_f32_16x16x32_bf16 v[132:135], a[52:55], a[148:151], v[132:135]
  s_add_u32 m0, s36, 28672
  v_mfma_f32_16x16x32_bf16 v[128:131], a[48:51], a[148:151], v[128:131]
  buffer_load_dwordx4 v6, s[16:19], s34 offen lds
  v_mfma_f32_16x16x32_bf16 v[144:147], a[152:155], a[48:51], v[144:147]
  ds_read_b64_tr_b16 a[148:149], v13 offset:160
  v_mfma_f32_16x16x32_bf16 v[148:151], a[152:155], a[52:55], v[148:151]
  ds_read_b64_tr_b16 a[150:151], v13 offset:928
  v_mfma_f32_16x16x32_bf16 v[152:155], a[152:155], a[56:59], v[152:155]
  s_add_u32 m0, s36, 29696
  v_mfma_f32_16x16x32_bf16 v[156:159], a[152:155], a[60:63], v[156:159]
  buffer_load_dwordx4 v7, s[16:19], s34 offen lds
  v_mfma_f32_16x16x32_bf16 v[172:175], a[156:159], a[60:63], v[172:175]
  ds_read_b64_tr_b16 a[152:153], v15 offset:12288
  v_mfma_f32_16x16x32_bf16 v[168:171], a[156:159], a[56:59], v[168:171]
  ds_read_b64_tr_b16 a[154:155], v15 offset:13312
  v_mfma_f32_16x16x32_bf16 v[164:167], a[156:159], a[52:55], v[164:167]
  s_add_u32 m0, s36, 30720
  v_mfma_f32_16x16x32_bf16 v[160:163], a[156:159], a[48:51], v[160:163]
  buffer_load_dwordx4 v8, s[16:19], s34 offen lds
  v_mfma_f32_16x16x32_bf16 v[176:179], a[160:163], a[48:51], v[176:179]
  ds_read_b64_tr_b16 a[156:157], v15 offset:12320
  v_mfma_f32_16x16x32_bf16 v[180:183], a[160:163], a[52:55], v[180:183]
  ds_read_b64_tr_b16 a[158:159], v15 offset:13344
  v_mfma_f32_16x16x32_bf16 v[184:187], a[160:163], a[56:59], v[184:187]
  s_add_u32 m0, s36, 31744
  v_mfma_f32_16x16x32_bf16 v[188:191], a[160:163], a[60:63], v[188:191]
  buffer_load_dwordx4 v9, s[16:19], s34 offen lds
  v_mfma_f32_16x16x32_bf16 v[204:207], a[164:167], a[60:63], v[204:207]
  ds_read_b64_tr_b16 a[160:161], v15 offset:12352
  ds_read_b64_tr_b16 a[162:163], v15 offset:13376
  v_mfma_f32_16x16x32_bf16 v[200:203], a[164:167], a[56:59], v[200:203]
  buffer_load_dwordx4 a[96:99], v1, s[8:11], s31 offen offset:0 sc1
  s_add_u32 s33, s33, 786432
  v_mfma_f32_16x16x32_bf16 v[196:199], a[164:167], a[52:55], v[196:199]
  s_cmp_ge_u32 s33, 6291456
  s_cselect_b32 s3, 6291456, 0
  v_mfma_f32_16x16x32_bf16 v[192:195], a[164:167], a[48:51], v[192:195]
  s_sub_u32 s33, s33, s3
  v_mfma_f32_16x16x32_bf16 v[208:211], a[168:171], a[48:51], v[208:211]
  ds_read_b64_tr_b16 a[164:165], v15 offset:12384
  ds_read_b64_tr_b16 a[166:167], v15 offset:13408
  v_mfma_f32_16x16x32_bf16 v[212:215], a[168:171], a[52:55], v[212:215]
  buffer_load_dwordx4 a[100:103], v1, s[8:11], s31 offen offset:1024 sc1
  s_add_u32 s34, s34, 917504
  v_mfma_f32_16x16x32_bf16 v[216:219], a[168:171], a[56:59], v[216:219]
  s_cmp_ge_u32 s34, 7340032
  s_cselect_b32 s3, 7340032, 0
  v_mfma_f32_16x16x32_bf16 v[220:223], a[168:171], a[60:63], v[220:223]
  s_sub_u32 s34, s34, s3
  v_mfma_f32_16x16x32_bf16 v[236:239], a[172:175], a[60:63], v[236:239]
  ds_read_b64_tr_b16 a[168:169], v15 offset:12416
  v_mfma_f32_16x16x32_bf16 v[232:235], a[172:175], a[56:59], v[232:235]
  ds_read_b64_tr_b16 a[170:171], v15 offset:13440
  v_mfma_f32_16x16x32_bf16 v[228:231], a[172:175], a[52:55], v[228:231]
  buffer_load_dwordx4 a[104:107], v1, s[8:11], s31 offen offset:2048 sc1
  v_mfma_f32_16x16x32_bf16 v[224:227], a[172:175], a[48:51], v[224:227]
  v_mfma_f32_16x16x32_bf16 v[240:243], a[176:179], a[48:51], v[240:243]
  ds_read_b64_tr_b16 a[172:173], v15 offset:12448
  v_mfma_f32_16x16x32_bf16 v[244:247], a[176:179], a[52:55], v[244:247]
  ds_read_b64_tr_b16 a[174:175], v15 offset:13472
  v_mfma_f32_16x16x32_bf16 v[248:251], a[176:179], a[56:59], v[248:251]
  buffer_load_dwordx4 a[108:111], v1, s[8:11], s31 offen offset:3072 sc1
  v_mfma_f32_16x16x32_bf16 v[252:255], a[176:179], a[60:63], v[252:255]
  ds_read_b64_tr_b16 a[176:177], v15 offset:12480
  ds_read_b64_tr_b16 a[178:179], v15 offset:13504
  s_waitcnt vmcnt(15) lgkmcnt(4)
  v_mfma_f32_16x16x32_bf16 v[48:51], a[128:131], a[64:67], v[48:51]
  v_mfma_f32_16x16x32_bf16 v[52:55], a[128:131], a[68:71], v[52:55]
  v_mfma_f32_16x16x32_bf16 v[56:59], a[128:131], a[72:75], v[56:59]
  v_mfma_f32_16x16x32_bf16 v[60:63], a[128:131], a[76:79], v[60:63]
  v_mfma_f32_16x16x32_bf16 v[76:79], a[132:135], a[76:79], v[76:79]
  ds_read_b64_tr_b16 a[128:129], v11 offset:6144
  v_mfma_f32_16x16x32_bf16 v[72:75], a[132:135], a[72:75], v[72:75]
  ds_read_b64_tr_b16 a[130:131], v11 offset:6912
  v_mfma_f32_16x16x32_bf16 v[68:71], a[132:135], a[68:71], v[68:71]
  buffer_load_dwordx4 a[112:115], v2, s[8:11], s31 offen offset:0 sc1
  v_mfma_f32_16x16x32_bf16 v[64:67], a[132:135], a[64:67], v[64:67]
  v_mfma_f32_16x16x32_bf16 v[80:83], a[136:139], a[64:67], v[80:83]
  ds_read_b64_tr_b16 a[132:133], v13 offset:6176
  v_mfma_f32_16x16x32_bf16 v[84:87], a[136:139], a[68:71], v[84:87]
  v_mfma_f32_16x16x32_bf16 v[88:91], a[136:139], a[72:75], v[88:91]
  ds_read_b64_tr_b16 a[134:135], v13 offset:6944
  v_mfma_f32_16x16x32_bf16 v[92:95], a[136:139], a[76:79], v[92:95]
  v_mfma_f32_16x16x32_bf16 v[108:111], a[140:143], a[76:79], v[108:111]
  ds_read_b64_tr_b16 a[136:137], v11 offset:6208
  v_mfma_f32_16x16x32_bf16 v[104:107], a[140:143], a[72:75], v[104:107]
  v_mfma_f32_16x16x32_bf16 v[100:103], a[140:143], a[68:71], v[100:103]
  ds_read_b64_tr_b16 a[138:139], v11 offset:6976
  v_mfma_f32_16x16x32_bf16 v[96:99], a[140:143], a[64:67], v[96:99]
  v_mfma_f32_16x16x32_bf16 v[112:115], a[64:67], a[144:147], v[112:115]
  ds_read_b64_tr_b16 a[140:141], v13 offset:6240
  v_mfma_f32_16x16x32_bf16 v[116:119], a[68:71], a[144:147], v[116:119]
  ds_read_b64_tr_b16 a[142:143], v13 offset:7008
  v_mfma_f32_16x16x32_bf16 v[120:123], a[72:75], a[144:147], v[120:123]
  buffer_load_dwordx4 a[116:119], v2, s[8:11], s31 offen offset:1024 sc1
  v_mfma_f32_16x16x32_bf16 v[124:127], a[76:79], a[144:147], v[124:127]
  v_mfma_f32_16x16x32_bf16 v[140:143], a[76:79], a[148:151], v[140:143]
  ds_read_b64_tr_b16 a[144:145], v11 offset:6272
  v_mfma_f32_16x16x32_bf16 v[136:139], a[72:75], a[148:151], v[136:139]
  v_mfma_f32_16x16x32_bf16 v[132:135], a[68:71], a[148:151], v[132:135]
  ds_read_b64_tr_b16 a[146:147], v11 offset:7040
  v_mfma_f32_16x16x32_bf16 v[128:131], a[64:67], a[148:151], v[128:131]
  v_mfma_f32_16x16x32_bf16 v[144:147], a[152:155], a[64:67], v[144:147]
  ds_read_b64_tr_b16 a[148:149], v13 offset:6304
  v_mfma_f32_16x16x32_bf16 v[148:151], a[152:155], a[68:71], v[148:151]
  v_mfma_f32_16x16x32_bf16 v[152:155], a[152:155], a[72:75], v[152:155]
  ds_read_b64_tr_b16 a[150:151], v13 offset:7072
  v_mfma_f32_16x16x32_bf16 v[156:159], a[152:155], a[76:79], v[156:159]
  s_waitcnt lgkmcnt(4)
  v_mfma_f32_16x16x32_bf16 v[172:175], a[156:159], a[76:79], v[172:175]
  ds_read_b64_tr_b16 a[152:153], v15 offset:20480
  v_mfma_f32_16x16x32_bf16 v[168:171], a[156:159], a[72:75], v[168:171]
  ds_read_b64_tr_b16 a[154:155], v15 offset:21504
  v_mfma_f32_16x16x32_bf16 v[164:167], a[156:159], a[68:71], v[164:167]
  buffer_load_dwordx4 a[120:123], v2, s[8:11], s31 offen offset:2048 sc1
  v_mfma_f32_16x16x32_bf16 v[160:163], a[156:159], a[64:67], v[160:163]
  v_mfma_f32_16x16x32_bf16 v[176:179], a[160:163], a[64:67], v[176:179]
  ds_read_b64_tr_b16 a[156:157], v15 offset:20512
  v_mfma_f32_16x16x32_bf16 v[180:183], a[160:163], a[68:71], v[180:183]
  v_mfma_f32_16x16x32_bf16 v[184:187], a[160:163], a[72:75], v[184:187]
  ds_read_b64_tr_b16 a[158:159], v15 offset:21536
  v_mfma_f32_16x16x32_bf16 v[188:191], a[160:163], a[76:79], v[188:191]
  v_mfma_f32_16x16x32_bf16 v[204:207], a[164:167], a[76:79], v[204:207]
  ds_read_b64_tr_b16 a[160:161], v15 offset:20544
  v_mfma_f32_16x16x32_bf16 v[200:203], a[164:167], a[72:75], v[200:203]
  v_mfma_f32_16x16x32_bf16 v[196:199], a[164:167], a[68:71], v[196:199]
  ds_read_b64_tr_b16 a[162:163], v15 offset:21568
  v_mfma_f32_16x16x32_bf16 v[192:195], a[164:167], a[64:67], v[192:195]
  v_mfma_f32_16x16x32_bf16 v[208:211], a[168:171], a[64:67], v[208:211]
  ds_read_b64_tr_b16 a[164:165], v15 offset:20576
  v_mfma_f32_16x16x32_bf16 v[212:215], a[168:171], a[68:71], v[212:215]
  ds_read_b64_tr_b16 a[166:167], v15 offset:21600
  v_mfma_f32_16x16x32_bf16 v[216:219], a[168:171], a[72:75], v[216:219]
  buffer_load_dwordx4 a[124:127], v2, s[8:11], s31 offen offset:3072 sc1
  v_mfma_f32_16x16x32_bf16 v[220:223], a[168:171], a[76:79], v[220:223]
  v_mfma_f32_16x16x32_bf16 v[236:239], a[172:175], a[76:79], v[236:239]
  ds_read_b64_tr_b16 a[168:169], v15 offset:20608
  v_mfma_f32_16x16x32_bf16 v[232:235], a[172:175], a[72:75], v[232:235]
  v_mfma_f32_16x16x32_bf16 v[228:231], a[172:175], a[68:71], v[228:231]
  ds_read_b64_tr_b16 a[170:171], v15 offset:21632
  v_mfma_f32_16x16x32_bf16 v[224:227], a[172:175], a[64:67], v[224:227]
  v_mfma_f32_16x16x32_bf16 v[240:243], a[176:179], a[64:67], v[240:243]
  ds_read_b64_tr_b16 a[172:173], v15 offset:20640
  ds_read_b64_tr_b16 a[174:175], v15 offset:21664
  v_mfma_f32_16x16x32_bf16 v[244:247], a[176:179], a[68:71], v[244:247]
  s_add_u32 s31, s31, 16384
  s_and_b32 s31, s31, 0x1ffff
  v_mfma_f32_16x16x32_bf16 v[248:251], a[176:179], a[72:75], v[248:251]
  s_cmp_eq_u32 s37, 2
  s_cselect_b32 s3, 8192, 0
  v_mfma_f32_16x16x32_bf16 v[252:255], a[176:179], a[76:79], v[252:255]
  s_add_u32 s31, s31, s3
  ds_read_b64_tr_b16 a[176:177], v15 offset:20672
  ds_read_b64_tr_b16 a[178:179], v15 offset:21696
  s_waitcnt vmcnt(15) lgkmcnt(4)
  v_mfma_f32_16x16x32_bf16 v[48:51], a[128:131], a[80:83], v[48:51]
  v_mfma_f32_16x16x32_bf16 v[52:55], a[128:131], a[84:87], v[52:55]
  v_mfma_f32_16x16x32_bf16 v[56:59], a[128:131], a[88:91], v[56:59]
  v_mfma_f32_16x16x32_bf16 v[60:63], a[128:131], a[92:95], v[60:63]
  v_mfma_f32_16x16x32_bf16 v[76:79], a[132:135], a[92:95], v[76:79]
  v_mfma_f32_16x16x32_bf16 v[72:75], a[132:135], a[88:91], v[72:75]
  v_mfma_f32_16x16x32_bf16 v[68:71], a[132:135], a[84:87], v[68:71]
  v_mfma_f32_16x16x32_bf16 v[64:67], a[132:135], a[80:83], v[64:67]
  s_waitcnt lgkmcnt(0)
  s_barrier
  v_mfma_f32_16x16x32_bf16 v[80:83], a[136:139], a[80:83], v[80:83]
  ds_read_b64_tr_b16 a[128:129], v11 offset:28672
  ds_read_b64_tr_b16 a[130:131], v11 offset:29440
  v_mfma_f32_16x16x32_bf16 v[84:87], a[136:139], a[84:87], v[84:87]
  ds_read_b64_tr_b16 a[132:133], v13 offset:28704
  v_mfma_f32_16x16x32_bf16 v[88:91], a[136:139], a[88:91], v[88:91]
  ds_read_b64_tr_b16 a[134:135], v13 offset:29472
  s_add_u32 m0, s35, 57344
  v_mfma_f32_16x16x32_bf16 v[92:95], a[136:139], a[92:95], v[92:95]
  buffer_load_dwordx4 v3, s[12:15], s33 offen lds
  v_mfma_f32_16x16x32_bf16 v[108:111], a[140:143], a[92:95], v[108:111]
  ds_read_b64_tr_b16 a[136:137], v11 offset:28736
  v_mfma_f32_16x16x32_bf16 v[104:107], a[140:143], a[88:91], v[104:107]
  ds_read_b64_tr_b16 a[138:139], v11 offset:29504
  v_mfma_f32_16x16x32_bf16 v[100:103], a[140:143], a[84:87], v[100:103]
  s_add_u32 m0, s35, 58368
  v_mfma_f32_16x16x32_bf16 v[96:99], a[140:143], a[80:83], v[96:99]
  buffer_load_dwordx4 v4, s[12:15], s33 offen lds
  v_mfma_f32_16x16x32_bf16 v[112:115], a[80:83], a[144:147], v[112:115]
  ds_read_b64_tr_b16 a[140:141], v13 offset:28768
  v_mfma_f32_16x16x32_bf16 v[116:119], a[84:87], a[144:147], v[116:119]
  ds_read_b64_tr_b16 a[142:143], v13 offset:29536
  v_mfma_f32_16x16x32_bf16 v[120:123], a[88:91], a[144:147], v[120:123]
  s_add_u32 m0, s35, 59392
  v_mfma_f32_16x16x32_bf16 v[124:127], a[92:95], a[144:147], v[124:127]
  buffer_load_dwordx4 v5, s[12:15], s33 offen lds
  v_mfma_f32_16x16x32_bf16 v[140:143], a[92:95], a[148:151], v[140:143]
  ds_read_b64_tr_b16 a[144:145], v11 offset:28800
  v_mfma_f32_16x16x32_bf16 v[136:139], a[88:91], a[148:151], v[136:139]
  ds_read_b64_tr_b16 a[146:147], v11 offset:29568
  v_mfma_f32_16x16x32_bf16 v[132:135], a[84:87], a[148:151], v[132:135]
  s_add_u32 m0, s36, 57344
  v_mfma_f32_16x16x32_bf16 v[128:131], a[80:83], a[148:151], v[128:131]
  buffer_load_dwordx4 v6, s[16:19], s34 offen lds
  v_mfma_f32_16x16x32_bf16 v[144:147], a[152:155], a[80:83], v[144:147]
  ds_read_b64_tr_b16 a[148:149], v13 offset:28832
  v_mfma_f32_16x16x32_bf16 v[148:151], a[152:155], a[84:87], v[148:151]
  ds_read_b64_tr_b16 a[150:151], v13 offset:29600
  v_mfma_f32_16x16x32_bf16 v[152:155], a[152:155], a[88:91], v[152:155]
  s_add_u32 m0, s36, 58368
  v_mfma_f32_16x16x32_bf16 v[156:159], a[152:155], a[92:95], v[156:159]
  buffer_load_dwordx4 v7, s[16:19], s34 offen lds
  v_mfma_f32_16x16x32_bf16 v[172:175], a[156:159], a[92:95], v[172:175]
  ds_read_b64_tr_b16 a[152:153], v15 offset:40960
  v_mfma_f32_16x16x32_bf16 v[168:171], a[156:159], a[88:91], v[168:171]
  ds_read_b64_tr_b16 a[154:155], v15 offset:41984
  v_mfma_f32_16x16x32_bf16 v[164:167], a[156:159], a[84:87], v[164:167]
  s_add_u32 m0, s36, 59392
  v_mfma_f32_16x16x32_bf16 v[160:163], a[156:159], a[80:83], v[160:163]
  buffer_load_dwordx4 v8, s[16:19], s34 offen lds
  v_mfma_f32_16x16x32_bf16 v[176:179], a[160:163], a[80:83], v[176:179]
  ds_read_b64_tr_b16 a[156:157], v15 offset:40992
  v_mfma_f32_16x16x32_bf16 v[180:183], a[160:163], a[84:87], v[180:183]
  ds_read_b64_tr_b16 a[158:159], v15 offset:42016
  v_mfma_f32_16x16x32_bf16 v[184:187], a[160:163], a[88:91], v[184:187]
  s_add_u32 m0, s36, 60416
  v_mfma_f32_16x16x32_bf16 v[188:191], a[160:163], a[92:95], v[188:191]
  buffer_load_dwordx4 v9, s[16:19], s34 offen lds
  v_mfma_f32_16x16x32_bf16 v[204:207], a[164:167], a[92:95], v[204:207]
  ds_read_b64_tr_b16 a[160:161], v15 offset:41024
  ds_read_b64_tr_b16 a[162:163], v15 offset:42048
  v_mfma_f32_16x16x32_bf16 v[200:203], a[164:167], a[88:91], v[200:203]
  buffer_load_dwordx4 a[0:3], v1, s[8:11], s31 offen offset:0 sc1
  s_add_u32 s33, s33, 786432
  v_mfma_f32_16x16x32_bf16 v[196:199], a[164:167], a[84:87], v[196:199]
  s_cmp_ge_u32 s33, 6291456
  s_cselect_b32 s3, 6291456, 0
  v_mfma_f32_16x16x32_bf16 v[192:195], a[164:167], a[80:83], v[192:195]
  s_sub_u32 s33, s33, s3
  v_mfma_f32_16x16x32_bf16 v[208:211], a[168:171], a[80:83], v[208:211]
  ds_read_b64_tr_b16 a[164:165], v15 offset:41056
  ds_read_b64_tr_b16 a[166:167], v15 offset:42080
  v_mfma_f32_16x16x32_bf16 v[212:215], a[168:171], a[84:87], v[212:215]
  buffer_load_dwordx4 a[4:7], v1, s[8:11], s31 offen offset:1024 sc1
  s_add_u32 s34, s34, 917504
  v_mfma_f32_16x16x32_bf16 v[216:219], a[168:171], a[88:91], v[216:219]
  s_cmp_ge_u32 s34, 7340032
  s_cselect_b32 s3, 7340032, 0
  v_mfma_f32_16x16x32_bf16 v[220:223], a[168:171], a[92:95], v[220:223]
  s_sub_u32 s34, s34, s3
  v_mfma_f32_16x16x32_bf16 v[236:239], a[172:175], a[92:95], v[236:239]
  ds_read_b64_tr_b16 a[168:169], v15 offset:41088
  ds_read_b64_tr_b16 a[170:171], v15 offset:42112
  v_mfma_f32_16x16x32_bf16 v[232:235], a[172:175], a[88:91], v[232:235]
  buffer_load_dwordx4 a[8:11], v1, s[8:11], s31 offen offset:2048 sc1
  v_mfma_f32_16x16x32_bf16 v[228:231], a[172:175], a[84:87], v[228:231]
  buffer_load_dwordx4 a[180:183], v16, s[24:27], s76 offen offset:0
  v_mfma_f32_16x16x32_bf16 v[224:227], a[172:175], a[80:83], v[224:227]
  buffer_load_dwordx4 a[184:187], v16, s[24:27], s76 offen offset:1024
  v_mfma_f32_16x16x32_bf16 v[240:243], a[176:179], a[80:83], v[240:243]
  ds_read_b64_tr_b16 a[172:173], v15 offset:41120
  ds_read_b64_tr_b16 a[174:175], v15 offset:42144
  buffer_load_dwordx4 a[188:191], v16, s[24:27], s76 offen offset:2048
  v_mfma_f32_16x16x32_bf16 v[244:247], a[176:179], a[84:87], v[244:247]
  s_mov_b32 s24, s52
  s_mov_b32 s25, s53
  v_mfma_f32_16x16x32_bf16 v[248:251], a[176:179], a[88:91], v[248:251]
  s_mov_b32 s26, 7340032
  s_mov_b32 s76, s77
  v_mfma_f32_16x16x32_bf16 v[252:255], a[176:179], a[92:95], v[252:255]
  s_add_u32 s77, s77, 0x300000
  buffer_load_dwordx4 a[12:15], v1, s[8:11], s31 offen offset:3072 sc1
  ds_read_b64_tr_b16 a[176:177], v15 offset:41152
  ds_read_b64_tr_b16 a[178:179], v15 offset:42176
  s_waitcnt vmcnt(18) lgkmcnt(4)
  v_mfma_f32_16x16x32_bf16 v[48:51], a[128:131], a[96:99], v[48:51]
  v_mfma_f32_16x16x32_bf16 v[52:55], a[128:131], a[100:103], v[52:55]
  v_mfma_f32_16x16x32_bf16 v[56:59], a[128:131], a[104:107], v[56:59]
  v_mfma_f32_16x16x32_bf16 v[60:63], a[128:131], a[108:111], v[60:63]
  v_mfma_f32_16x16x32_bf16 v[76:79], a[132:135], a[108:111], v[76:79]
  ds_read_b64_tr_b16 a[128:129], v11 offset:34816
  v_mfma_f32_16x16x32_bf16 v[72:75], a[132:135], a[104:107], v[72:75]
  ds_read_b64_tr_b16 a[130:131], v11 offset:35584
  v_mfma_f32_16x16x32_bf16 v[68:71], a[132:135], a[100:103], v[68:71]
  buffer_load_dwordx4 a[16:19], v2, s[8:11], s31 offen offset:0 sc1
  v_mfma_f32_16x16x32_bf16 v[64:67], a[132:135], a[96:99], v[64:67]
  v_mfma_f32_16x16x32_bf16 v[80:83], a[136:139], a[96:99], v[80:83]
  ds_read_b64_tr_b16 a[132:133], v13 offset:34848
  v_mfma_f32_16x16x32_bf16 v[84:87], a[136:139], a[100:103], v[84:87]
  v_mfma_f32_16x16x32_bf16 v[88:91], a[136:139], a[104:107], v[88:91]
  ds_read_b64_tr_b16 a[134:135], v13 offset:35616
  v_mfma_f32_16x16x32_bf16 v[92:95], a[136:139], a[108:111], v[92:95]
  v_mfma_f32_16x16x32_bf16 v[108:111], a[140:143], a[108:111], v[108:111]
  ds_read_b64_tr_b16 a[136:137], v11 offset:34880
  v_mfma_f32_16x16x32_bf16 v[104:107], a[140:143], a[104:107], v[104:107]
  v_mfma_f32_16x16x32_bf16 v[100:103], a[140:143], a[100:103], v[100:103]
  ds_read_b64_tr_b16 a[138:139], v11 offset:35648
  v_mfma_f32_16x16x32_bf16 v[96:99], a[140:143], a[96:99], v[96:99]
  v_mfma_f32_16x16x32_bf16 v[112:115], a[96:99], a[144:147], v[112:115]
  ds_read_b64_tr_b16 a[140:141], v13 offset:34912
  v_mfma_f32_16x16x32_bf16 v[116:119], a[100:103], a[144:147], v[116:119]
  ds_read_b64_tr_b16 a[142:143], v13 offset:35680
  v_mfma_f32_16x16x32_bf16 v[120:123], a[104:107], a[144:147], v[120:123]
  buffer_load_dwordx4 a[20:23], v2, s[8:11], s31 offen offset:1024 sc1
  v_mfma_f32_16x16x32_bf16 v[124:127], a[108:111], a[144:147], v[124:127]
  v_mfma_f32_16x16x32_bf16 v[140:143], a[108:111], a[148:151], v[140:143]
  ds_read_b64_tr_b16 a[144:145], v11 offset:34944
  v_mfma_f32_16x16x32_bf16 v[136:139], a[104:107], a[148:151], v[136:139]
  v_mfma_f32_16x16x32_bf16 v[132:135], a[100:103], a[148:151], v[132:135]
  ds_read_b64_tr_b16 a[146:147], v11 offset:35712
  v_mfma_f32_16x16x32_bf16 v[128:131], a[96:99], a[148:151], v[128:131]
  v_mfma_f32_16x16x32_bf16 v[144:147], a[152:155], a[96:99], v[144:147]
  ds_read_b64_tr_b16 a[148:149], v13 offset:34976
  v_mfma_f32_16x16x32_bf16 v[148:151], a[152:155], a[100:103], v[148:151]
  v_mfma_f32_16x16x32_bf16 v[152:155], a[152:155], a[104:107], v[152:155]
  ds_read_b64_tr_b16 a[150:151], v13 offset:35744
  v_mfma_f32_16x16x32_bf16 v[156:159], a[152:155], a[108:111], v[156:159]
  s_waitcnt lgkmcnt(4)
  v_mfma_f32_16x16x32_bf16 v[172:175], a[156:159], a[108:111], v[172:175]
  ds_read_b64_tr_b16 a[152:153], v15 offset:49152
  v_mfma_f32_16x16x32_bf16 v[168:171], a[156:159], a[104:107], v[168:171]
  ds_read_b64_tr_b16 a[154:155], v15 offset:50176
  v_mfma_f32_16x16x32_bf16 v[164:167], a[156:159], a[100:103], v[164:167]
  buffer_load_dwordx4 a[24:27], v2, s[8:11], s31 offen offset:2048 sc1
  v_mfma_f32_16x16x32_bf16 v[160:163], a[156:159], a[96:99], v[160:163]
  v_mfma_f32_16x16x32_bf16 v[176:179], a[160:163], a[96:99], v[176:179]
  ds_read_b64_tr_b16 a[156:157], v15 offset:49184
  v_mfma_f32_16x16x32_bf16 v[180:183], a[160:163], a[100:103], v[180:183]
  v_mfma_f32_16x16x32_bf16 v[184:187], a[160:163], a[104:107], v[184:187]
  ds_read_b64_tr_b16 a[158:159], v15 offset:50208
  v_mfma_f32_16x16x32_bf16 v[188:191], a[160:163], a[108:111], v[188:191]
  v_mfma_f32_16x16x32_bf16 v[204:207], a[164:167], a[108:111], v[204:207]
  ds_read_b64_tr_b16 a[160:161], v15 offset:49216
  v_mfma_f32_16x16x32_bf16 v[200:203], a[164:167], a[104:107], v[200:203]
  v_mfma_f32_16x16x32_bf16 v[196:199], a[164:167], a[100:103], v[196:199]
  ds_read_b64_tr_b16 a[162:163], v15 offset:50240
  v_mfma_f32_16x16x32_bf16 v[192:195], a[164:167], a[96:99], v[192:195]
  v_mfma_f32_16x16x32_bf16 v[208:211], a[168:171], a[96:99], v[208:211]
  ds_read_b64_tr_b16 a[164:165], v15 offset:49248
  v_mfma_f32_16x16x32_bf16 v[212:215], a[168:171], a[100:103], v[212:215]
  ds_read_b64_tr_b16 a[166:167], v15 offset:50272
  v_mfma_f32_16x16x32_bf16 v[216:219], a[168:171], a[104:107], v[216:219]
  buffer_load_dwordx4 a[28:31], v2, s[8:11], s31 offen offset:3072 sc1
  v_mfma_f32_16x16x32_bf16 v[220:223], a[168:171], a[108:111], v[220:223]
  v_mfma_f32_16x16x32_bf16 v[236:239], a[172:175], a[108:111], v[236:239]
  ds_read_b64_tr_b16 a[168:169], v15 offset:49280
  v_mfma_f32_16x16x32_bf16 v[232:235], a[172:175], a[104:107], v[232:235]
  v_mfma_f32_16x16x32_bf16 v[228:231], a[172:175], a[100:103], v[228:231]
  ds_read_b64_tr_b16 a[170:171], v15 offset:50304
  v_mfma_f32_16x16x32_bf16 v[224:227], a[172:175], a[96:99], v[224:227]
  v_mfma_f32_16x16x32_bf16 v[240:243], a[176:179], a[96:99], v[240:243]
  ds_read_b64_tr_b16 a[172:173], v15 offset:49312
  v_mfma_f32_16x16x32_bf16 v[244:247], a[176:179], a[100:103], v[244:247]
  ds_read_b64_tr_b16 a[174:175], v15 offset:50336
  v_mfma_f32_16x16x32_bf16 v[248:251], a[176:179], a[104:107], v[248:251]
  s_add_u32 s31, s31, 16384
  v_mfma_f32_16x16x32_bf16 v[252:255], a[176:179], a[108:111], v[252:255]
  s_and_b32 s31, s31, 0x1ffff
  ds_read_b64_tr_b16 a[176:177], v15 offset:49344
  ds_read_b64_tr_b16 a[178:179], v15 offset:50368
  s_waitcnt vmcnt(18) lgkmcnt(4)
  v_mfma_f32_16x16x32_bf16 v[48:51], a[128:131], a[112:115], v[48:51]
  v_mfma_f32_16x16x32_bf16 v[52:55], a[128:131], a[116:119], v[52:55]
  v_mfma_f32_16x16x32_bf16 v[56:59], a[128:131], a[120:123], v[56:59]
  v_mfma_f32_16x16x32_bf16 v[60:63], a[128:131], a[124:127], v[60:63]
  v_mfma_f32_16x16x32_bf16 v[76:79], a[132:135], a[124:127], v[76:79]
  v_mfma_f32_16x16x32_bf16 v[72:75], a[132:135], a[120:123], v[72:75]
  v_mfma_f32_16x16x32_bf16 v[68:71], a[132:135], a[116:119], v[68:71]
  v_mfma_f32_16x16x32_bf16 v[64:67], a[132:135], a[112:115], v[64:67]
  s_waitcnt lgkmcnt(0)
  s_barrier
  v_mfma_f32_16x16x32_bf16 v[80:83], a[136:139], a[112:115], v[80:83]
  ds_read_b64_tr_b16 a[128:129], v10 offset:0
  ds_read_b64_tr_b16 a[130:131], v10 offset:768
  v_mfma_f32_16x16x32_bf16 v[84:87], a[136:139], a[116:119], v[84:87]
  ds_read_b64_tr_b16 a[132:133], v12 offset:32
  v_mfma_f32_16x16x32_bf16 v[88:91], a[136:139], a[120:123], v[88:91]
  ds_read_b64_tr_b16 a[134:135], v12 offset:800
  s_add_u32 m0, s35, 86016
  v_mfma_f32_16x16x32_bf16 v[92:95], a[136:139], a[124:127], v[92:95]
  buffer_load_dwordx4 v3, s[12:15], s33 offen lds
  v_mfma_f32_16x16x32_bf16 v[108:111], a[140:143], a[124:127], v[108:111]
  ds_read_b64_tr_b16 a[136:137], v10 offset:64
  v_mfma_f32_16x16x32_bf16 v[104:107], a[140:143], a[120:123], v[104:107]
  ds_read_b64_tr_b16 a[138:139], v10 offset:832
  v_mfma_f32_16x16x32_bf16 v[100:103], a[140:143], a[116:119], v[100:103]
  s_add_u32 m0, s35, 87040
  v_mfma_f32_16x16x32_bf16 v[96:99], a[140:143], a[112:115], v[96:99]
  buffer_load_dwordx4 v4, s[12:15], s33 offen lds
  v_mfma_f32_16x16x32_bf16 v[112:115], a[112:115], a[144:147], v[112:115]
  ds_read_b64_tr_b16 a[140:141], v12 offset:96
  v_mfma_f32_16x16x32_bf16 v[116:119], a[116:119], a[144:147], v[116:119]
  ds_read_b64_tr_b16 a[142:143], v12 offset:864
  v_mfma_f32_16x16x32_bf16 v[120:123], a[120:123], a[144:147], v[120:123]
  s_add_u32 m0, s35, 88064
  v_mfma_f32_16x16x32_bf16 v[124:127], a[124:127], a[144:147], v[124:127]
  buffer_load_dwordx4 v5, s[12:15], s33 offen lds
  v_mfma_f32_16x16x32_bf16 v[140:143], a[124:127], a[148:151], v[140:143]
  ds_read_b64_tr_b16 a[144:145], v10 offset:128
  v_mfma_f32_16x16x32_bf16 v[136:139], a[120:123], a[148:151], v[136:139]
  ds_read_b64_tr_b16 a[146:147], v10 offset:896
  v_mfma_f32_16x16x32_bf16 v[132:135], a[116:119], a[148:151], v[132:135]
  s_add_u32 m0, s36, 86016
  v_mfma_f32_16x16x32_bf16 v[128:131], a[112:115], a[148:151], v[128:131]
  buffer_load_dwordx4 v6, s[16:19], s34 offen lds
  v_mfma_f32_16x16x32_bf16 v[144:147], a[152:155], a[112:115], v[144:147]
  ds_read_b64_tr_b16 a[148:149], v12 offset:160
  v_mfma_f32_16x16x32_bf16 v[148:151], a[152:155], a[116:119], v[148:151]
  ds_read_b64_tr_b16 a[150:151], v12 offset:928
  v_mfma_f32_16x16x32_bf16 v[152:155], a[152:155], a[120:123], v[152:155]
  s_add_u32 m0, s36, 87040
  v_mfma_f32_16x16x32_bf16 v[156:159], a[152:155], a[124:127], v[156:159]
  buffer_load_dwordx4 v7, s[16:19], s34 offen lds
  v_mfma_f32_16x16x32_bf16 v[172:175], a[156:159], a[124:127], v[172:175]
  ds_read_b64_tr_b16 a[152:153], v14 offset:12288
  v_mfma_f32_16x16x32_bf16 v[168:171], a[156:159], a[120:123], v[168:171]
  ds_read_b64_tr_b16 a[154:155], v14 offset:13312
  v_mfma_f32_16x16x32_bf16 v[164:167], a[156:159], a[116:119], v[164:167]
  s_add_u32 m0, s36, 88064
  v_mfma_f32_16x16x32_bf16 v[160:163], a[156:159], a[112:115], v[160:163]
  buffer_load_dwordx4 v8, s[16:19], s34 offen lds
  v_mfma_f32_16x16x32_bf16 v[176:179], a[160:163], a[112:115], v[176:179]
  ds_read_b64_tr_b16 a[156:157], v14 offset:12320
  v_mfma_f32_16x16x32_bf16 v[180:183], a[160:163], a[116:119], v[180:183]
  ds_read_b64_tr_b16 a[158:159], v14 offset:13344
  v_mfma_f32_16x16x32_bf16 v[184:187], a[160:163], a[120:123], v[184:187]
  s_add_u32 m0, s36, 89088
  v_mfma_f32_16x16x32_bf16 v[188:191], a[160:163], a[124:127], v[188:191]
  buffer_load_dwordx4 v9, s[16:19], s34 offen lds
  v_mfma_f32_16x16x32_bf16 v[204:207], a[164:167], a[124:127], v[204:207]
  ds_read_b64_tr_b16 a[160:161], v14 offset:12352
  ds_read_b64_tr_b16 a[162:163], v14 offset:13376
  buffer_load_dwordx4 a[32:35], v1, s[8:11], s31 offen offset:0 sc1
  v_mfma_f32_16x16x32_bf16 v[200:203], a[164:167], a[120:123], v[200:203]
  s_add_u32 s33, s33, 786432
  s_cmp_ge_u32 s33, 6291456
  v_mfma_f32_16x16x32_bf16 v[196:199], a[164:167], a[116:119], v[196:199]
  s_cselect_b32 s3, 6291456, 0
  s_sub_u32 s33, s33, s3
  s_cmp_eq_u32 s37, 3
  v_mfma_f32_16x16x32_bf16 v[192:195], a[164:167], a[112:115], v[192:195]
  s_cselect_b32 s3, 393216, 0
  s_add_u32 s33, s33, s3
  v_mfma_f32_16x16x32_bf16 v[208:211], a[168:171], a[112:115], v[208:211]
  ds_read_b64_tr_b16 a[164:165], v14 offset:12384
  ds_read_b64_tr_b16 a[166:167], v14 offset:13408
  buffer_load_dwordx4 a[36:39], v1, s[8:11], s31 offen offset:1024 sc1
  v_mfma_f32_16x16x32_bf16 v[212:215], a[168:171], a[116:119], v[212:215]
  s_add_u32 s34, s34, 917504
  s_cmp_ge_u32 s34, 7340032
  v_mfma_f32_16x16x32_bf16 v[216:219], a[168:171], a[120:123], v[216:219]
  s_cselect_b32 s3, 7340032, 0
  s_sub_u32 s34, s34, s3
  s_cmp_eq_u32 s37, 3
  v_mfma_f32_16x16x32_bf16 v[220:223], a[168:171], a[124:127], v[220:223]
  s_cselect_b32 s3, 458752, 0
  s_add_u32 s34, s34, s3
  v_mfma_f32_16x16x32_bf16 v[236:239], a[172:175], a[124:127], v[236:239]
  ds_read_b64_tr_b16 a[168:169], v14 offset:12416
  v_mfma_f32_16x16x32_bf16 v[232:235], a[172:175], a[120:123], v[232:235]
  ds_read_b64_tr_b16 a[170:171], v14 offset:13440
  v_mfma_f32_16x16x32_bf16 v[228:231], a[172:175], a[116:119], v[228:231]
  buffer_load_dwordx4 a[40:43], v1, s[8:11], s31 offen offset:2048 sc1
  v_mfma_f32_16x16x32_bf16 v[224:227], a[172:175], a[112:115], v[224:227]
  v_mfma_f32_16x16x32_bf16 v[240:243], a[176:179], a[112:115], v[240:243]
  ds_read_b64_tr_b16 a[172:173], v14 offset:12448
  v_mfma_f32_16x16x32_bf16 v[244:247], a[176:179], a[116:119], v[244:247]
  ds_read_b64_tr_b16 a[174:175], v14 offset:13472
  v_mfma_f32_16x16x32_bf16 v[248:251], a[176:179], a[120:123], v[248:251]
  buffer_load_dwordx4 a[44:47], v1, s[8:11], s31 offen offset:3072 sc1
  v_mfma_f32_16x16x32_bf16 v[252:255], a[176:179], a[124:127], v[252:255]
  s_sub_u32 s37, s37, 1
  s_cmp_lg_u32 s37, 0
  ds_read_b64_tr_b16 a[176:177], v14 offset:12480
  ds_read_b64_tr_b16 a[178:179], v14 offset:13504
  s_cbranch_scc1 L_g1_loop
  s_waitcnt vmcnt(15) lgkmcnt(4)
  v_mfma_f32_16x16x32_bf16 v[48:51], a[128:131], a[0:3], v[48:51]
  v_mfma_f32_16x16x32_bf16 v[52:55], a[128:131], a[4:7], v[52:55]
  v_mfma_f32_16x16x32_bf16 v[56:59], a[128:131], a[8:11], v[56:59]
  v_mfma_f32_16x16x32_bf16 v[60:63], a[128:131], a[12:15], v[60:63]
  v_mfma_f32_16x16x32_bf16 v[76:79], a[132:135], a[12:15], v[76:79]
  ds_read_b64_tr_b16 a[128:129], v10 offset:6144
  ds_read_b64_tr_b16 a[130:131], v10 offset:6912
  v_mfma_f32_16x16x32_bf16 v[72:75], a[132:135], a[8:11], v[72:75]
  buffer_load_dwordx4 a[48:51], v2, s[8:11], s31 offen offset:0 sc1
  v_mfma_f32_16x16x32_bf16 v[68:71], a[132:135], a[4:7], v[68:71]
  v_lshrrev_b32 v22, 4, v17
  v_mfma_f32_16x16x32_bf16 v[64:67], a[132:135], a[0:3], v[64:67]
  v_bfe_u32 v23, v17, 1, 3
  v_mfma_f32_16x16x32_bf16 v[80:83], a[136:139], a[0:3], v[80:83]
  ds_read_b64_tr_b16 a[132:133], v12 offset:6176
  v_mfma_f32_16x16x32_bf16 v[84:87], a[136:139], a[4:7], v[84:87]
  ds_read_b64_tr_b16 a[134:135], v12 offset:6944
  v_mfma_f32_16x16x32_bf16 v[88:91], a[136:139], a[8:11], v[88:91]
  v_xor_b32 v23, v23, v22
  v_mfma_f32_16x16x32_bf16 v[92:95], a[136:139], a[12:15], v[92:95]
  v_and_b32 v24, 1, v17
  v_mfma_f32_16x16x32_bf16 v[108:111], a[140:143], a[12:15], v[108:111]
  ds_read_b64_tr_b16 a[136:137], v10 offset:6208
  v_mfma_f32_16x16x32_bf16 v[104:107], a[140:143], a[8:11], v[104:107]
  ds_read_b64_tr_b16 a[138:139], v10 offset:6976
  v_mfma_f32_16x16x32_bf16 v[100:103], a[140:143], a[4:7], v[100:103]
  v_lshlrev_b32 v25, 11, v22
  v_mfma_f32_16x16x32_bf16 v[96:99], a[140:143], a[0:3], v[96:99]
  v_lshl_add_u32 v25, v24, 4, v25
  v_mfma_f32_16x16x32_bf16 v[112:115], a[0:3], a[144:147], v[112:115]
  ds_read_b64_tr_b16 a[140:141], v12 offset:6240
  ds_read_b64_tr_b16 a[142:143], v12 offset:7008
  v_mfma_f32_16x16x32_bf16 v[116:119], a[4:7], a[144:147], v[116:119]
  buffer_load_dwordx4 a[52:55], v2, s[8:11], s31 offen offset:1024 sc1
  v_mfma_f32_16x16x32_bf16 v[120:123], a[8:11], a[144:147], v[120:123]
  s_lshl_b32 s3, s30, 15
  v_mfma_f32_16x16x32_bf16 v[124:127], a[12:15], a[144:147], v[124:127]
  s_lshr_b32 s39, s69, 1
  v_mfma_f32_16x16x32_bf16 v[140:143], a[12:15], a[148:151], v[140:143]
  ds_read_b64_tr_b16 a[144:145], v10 offset:6272
  v_mfma_f32_16x16x32_bf16 v[136:139], a[8:11], a[148:151], v[136:139]
  ds_read_b64_tr_b16 a[146:147], v10 offset:7040
  v_mfma_f32_16x16x32_bf16 v[132:135], a[4:7], a[148:151], v[132:135]
  s_lshl_b32 s39, s39, 8
  v_mfma_f32_16x16x32_bf16 v[128:131], a[0:3], a[148:151], v[128:131]
  s_add_u32 s3, s3, s39
  v_mfma_f32_16x16x32_bf16 v[144:147], a[152:155], a[0:3], v[144:147]
  ds_read_b64_tr_b16 a[148:149], v12 offset:6304
  v_mfma_f32_16x16x32_bf16 v[148:151], a[152:155], a[4:7], v[148:151]
  ds_read_b64_tr_b16 a[150:151], v12 offset:7072
  v_mfma_f32_16x16x32_bf16 v[152:155], a[152:155], a[8:11], v[152:155]
  v_add_u32 v25, s3, v25
  v_mfma_f32_16x16x32_bf16 v[156:159], a[152:155], a[12:15], v[156:159]
  v_lshl_add_u32 v18, v23, 5, v25
  s_waitcnt lgkmcnt(4)
  v_mfma_f32_16x16x32_bf16 v[172:175], a[156:159], a[12:15], v[172:175]
  ds_read_b64_tr_b16 a[152:153], v14 offset:20480
  ds_read_b64_tr_b16 a[154:155], v14 offset:21504
  v_mfma_f32_16x16x32_bf16 v[168:171], a[156:159], a[8:11], v[168:171]
  buffer_load_dwordx4 a[56:59], v2, s[8:11], s31 offen offset:2048 sc1
  v_mfma_f32_16x16x32_bf16 v[164:167], a[156:159], a[4:7], v[164:167]
  v_xor_b32 v23, 4, v23
  v_mfma_f32_16x16x32_bf16 v[160:163], a[156:159], a[0:3], v[160:163]
  v_lshl_add_u32 v20, v23, 5, v25
  v_mfma_f32_16x16x32_bf16 v[176:179], a[160:163], a[0:3], v[176:179]
  ds_read_b64_tr_b16 a[156:157], v14 offset:20512
  v_mfma_f32_16x16x32_bf16 v[180:183], a[160:163], a[4:7], v[180:183]
  ds_read_b64_tr_b16 a[158:159], v14 offset:21536
  v_mfma_f32_16x16x32_bf16 v[184:187], a[160:163], a[8:11], v[184:187]
  v_add_u32 v20, 16384, v20
  v_mfma_f32_16x16x32_bf16 v[188:191], a[160:163], a[12:15], v[188:191]
  v_add_u32 v19, 8192, v18
  v_mfma_f32_16x16x32_bf16 v[204:207], a[164:167], a[12:15], v[204:207]
  ds_read_b64_tr_b16 a[160:161], v14 offset:20544
  v_mfma_f32_16x16x32_bf16 v[200:203], a[164:167], a[8:11], v[200:203]
  ds_read_b64_tr_b16 a[162:163], v14 offset:21568
  v_mfma_f32_16x16x32_bf16 v[196:199], a[164:167], a[4:7], v[196:199]
  v_add_u32 v21, 8192, v20
  v_mfma_f32_16x16x32_bf16 v[192:195], a[164:167], a[0:3], v[192:195]
  s_lshl_b32 s39, s30, 12
  v_mfma_f32_16x16x32_bf16 v[208:211], a[168:171], a[0:3], v[208:211]
  ds_read_b64_tr_b16 a[164:165], v14 offset:20576
  ds_read_b64_tr_b16 a[166:167], v14 offset:21600
  v_mfma_f32_16x16x32_bf16 v[212:215], a[168:171], a[4:7], v[212:215]
  buffer_load_dwordx4 a[60:63], v2, s[8:11], s31 offen offset:3072 sc1
  v_mfma_f32_16x16x32_bf16 v[216:219], a[168:171], a[8:11], v[216:219]
  s_and_b32 s50, s69, 1
  v_mfma_f32_16x16x32_bf16 v[220:223], a[168:171], a[12:15], v[220:223]
  s_mul_i32 s3, s50, 3670016
  v_mfma_f32_16x16x32_bf16 v[236:239], a[172:175], a[12:15], v[236:239]
  ds_read_b64_tr_b16 a[168:169], v14 offset:20608
  v_mfma_f32_16x16x32_bf16 v[232:235], a[172:175], a[8:11], v[232:235]
  ds_read_b64_tr_b16 a[170:171], v14 offset:21632
  v_mfma_f32_16x16x32_bf16 v[228:231], a[172:175], a[4:7], v[228:231]
  s_add_u32 s4, s52, s3
  v_mfma_f32_16x16x32_bf16 v[224:227], a[172:175], a[0:3], v[224:227]
  s_addc_u32 s5, s53, 0
  v_mfma_f32_16x16x32_bf16 v[240:243], a[176:179], a[0:3], v[240:243]
  ds_read_b64_tr_b16 a[172:173], v14 offset:20640
  ds_read_b64_tr_b16 a[174:175], v14 offset:21664
  v_mfma_f32_16x16x32_bf16 v[244:247], a[176:179], a[4:7], v[244:247]
  s_add_u32 s31, s31, 16384
  v_mfma_f32_16x16x32_bf16 v[248:251], a[176:179], a[8:11], v[248:251]
  s_and_b32 s31, s31, 0x1ffff
  s_mov_b32 s6, 3670016
  v_mfma_f32_16x16x32_bf16 v[252:255], a[176:179], a[12:15], v[252:255]
  s_mov_b32 s7, 0x20000
  ds_read_b64_tr_b16 a[176:177], v14 offset:20672
  ds_read_b64_tr_b16 a[178:179], v14 offset:21696
  s_waitcnt vmcnt(15) lgkmcnt(4)
  v_mfma_f32_16x16x32_bf16 v[48:51], a[128:131], a[16:19], v[48:51]
  v_mfma_f32_16x16x32_bf16 v[52:55], a[128:131], a[20:23], v[52:55]
  v_mfma_f32_16x16x32_bf16 v[56:59], a[128:131], a[24:27], v[56:59]
  v_mfma_f32_16x16x32_bf16 v[60:63], a[128:131], a[28:31], v[60:63]
  v_mfma_f32_16x16x32_bf16 v[76:79], a[132:135], a[28:31], v[76:79]
  v_mfma_f32_16x16x32_bf16 v[72:75], a[132:135], a[24:27], v[72:75]
  v_mfma_f32_16x16x32_bf16 v[68:71], a[132:135], a[20:23], v[68:71]
  v_mfma_f32_16x16x32_bf16 v[64:67], a[132:135], a[16:19], v[64:67]
  s_waitcnt lgkmcnt(0)
  s_barrier
  v_mfma_f32_16x16x32_bf16 v[80:83], a[136:139], a[16:19], v[80:83]
  ds_read_b64_tr_b16 a[128:129], v10 offset:28672
  ds_read_b64_tr_b16 a[130:131], v10 offset:29440
  v_mfma_f32_16x16x32_bf16 v[84:87], a[136:139], a[20:23], v[84:87]
  ds_read_b64_tr_b16 a[132:133], v12 offset:28704
  v_mfma_f32_16x16x32_bf16 v[88:91], a[136:139], a[24:27], v[88:91]
  ds_read_b64_tr_b16 a[134:135], v12 offset:29472
  s_add_u32 s33, s32, 0x600000
  v_mfma_f32_16x16x32_bf16 v[92:95], a[136:139], a[28:31], v[92:95]
  buffer_load_dwordx4 a[180:183], v16, s[24:27], s33 offen
  v_mfma_f32_16x16x32_bf16 v[108:111], a[140:143], a[28:31], v[108:111]
  ds_read_b64_tr_b16 a[136:137], v10 offset:28736
  ds_read_b64_tr_b16 a[138:139], v10 offset:29504
  v_mfma_f32_16x16x32_bf16 v[104:107], a[140:143], a[24:27], v[104:107]
  s_mov_b32 s24, s44
  v_mfma_f32_16x16x32_bf16 v[100:103], a[140:143], a[20:23], v[100:103]
  s_mov_b32 s25, s45
  s_mov_b32 s26, 0x200000
  v_mfma_f32_16x16x32_bf16 v[96:99], a[140:143], a[16:19], v[96:99]
  s_lshl_b32 s32, s32, 1
  v_mfma_f32_16x16x32_bf16 v[112:115], a[16:19], a[144:147], v[112:115]
  ds_read_b64_tr_b16 a[140:141], v12 offset:28768
  v_mfma_f32_16x16x32_bf16 v[116:119], a[20:23], a[144:147], v[116:119]
  ds_read_b64_tr_b16 a[142:143], v12 offset:29536
  v_mfma_f32_16x16x32_bf16 v[120:123], a[24:27], a[144:147], v[120:123]
  buffer_load_dwordx4 a[184:187], v16, s[24:27], s32 offen
  v_mfma_f32_16x16x32_bf16 v[124:127], a[28:31], a[144:147], v[124:127]
  v_mfma_f32_16x16x32_bf16 v[140:143], a[28:31], a[148:151], v[140:143]
  ds_read_b64_tr_b16 a[144:145], v10 offset:28800
  v_mfma_f32_16x16x32_bf16 v[136:139], a[24:27], a[148:151], v[136:139]
  ds_read_b64_tr_b16 a[146:147], v10 offset:29568
  v_mfma_f32_16x16x32_bf16 v[132:135], a[20:23], a[148:151], v[132:135]
  buffer_load_dwordx4 a[188:191], v16, s[24:27], s32 offen offset:1024
  v_mfma_f32_16x16x32_bf16 v[128:131], a[16:19], a[148:151], v[128:131]
  v_mfma_f32_16x16x32_bf16 v[144:147], a[152:155], a[16:19], v[144:147]
  ds_read_b64_tr_b16 a[148:149], v12 offset:28832
  v_mfma_f32_16x16x32_bf16 v[148:151], a[152:155], a[20:23], v[148:151]
  v_mfma_f32_16x16x32_bf16 v[152:155], a[152:155], a[24:27], v[152:155]
  ds_read_b64_tr_b16 a[150:151], v12 offset:29600
  v_mfma_f32_16x16x32_bf16 v[156:159], a[152:155], a[28:31], v[156:159]
  v_mfma_f32_16x16x32_bf16 v[172:175], a[156:159], a[28:31], v[172:175]
  ds_read_b64_tr_b16 a[152:153], v14 offset:40960
  v_mfma_f32_16x16x32_bf16 v[168:171], a[156:159], a[24:27], v[168:171]
  v_mfma_f32_16x16x32_bf16 v[164:167], a[156:159], a[20:23], v[164:167]
  ds_read_b64_tr_b16 a[154:155], v14 offset:41984
  v_mfma_f32_16x16x32_bf16 v[160:163], a[156:159], a[16:19], v[160:163]
  v_mfma_f32_16x16x32_bf16 v[176:179], a[160:163], a[16:19], v[176:179]
  ds_read_b64_tr_b16 a[156:157], v14 offset:40992
  v_mfma_f32_16x16x32_bf16 v[180:183], a[160:163], a[20:23], v[180:183]
  v_mfma_f32_16x16x32_bf16 v[184:187], a[160:163], a[24:27], v[184:187]
  ds_read_b64_tr_b16 a[158:159], v14 offset:42016
  v_mfma_f32_16x16x32_bf16 v[188:191], a[160:163], a[28:31], v[188:191]
  v_mfma_f32_16x16x32_bf16 v[204:207], a[164:167], a[28:31], v[204:207]
  ds_read_b64_tr_b16 a[160:161], v14 offset:41024
  v_mfma_f32_16x16x32_bf16 v[200:203], a[164:167], a[24:27], v[200:203]
  ds_read_b64_tr_b16 a[162:163], v14 offset:42048
  v_mfma_f32_16x16x32_bf16 v[196:199], a[164:167], a[20:23], v[196:199]
  buffer_load_dwordx4 a[64:67], v1, s[8:11], s31 offen offset:0 sc1
  v_mfma_f32_16x16x32_bf16 v[192:195], a[164:167], a[16:19], v[192:195]
  v_mfma_f32_16x16x32_bf16 v[208:211], a[168:171], a[16:19], v[208:211]
  ds_read_b64_tr_b16 a[164:165], v14 offset:41056
  v_mfma_f32_16x16x32_bf16 v[212:215], a[168:171], a[20:23], v[212:215]
  ds_read_b64_tr_b16 a[166:167], v14 offset:42080
  v_mfma_f32_16x16x32_bf16 v[216:219], a[168:171], a[24:27], v[216:219]
  buffer_load_dwordx4 a[68:71], v1, s[8:11], s31 offen offset:1024 sc1
  v_mfma_f32_16x16x32_bf16 v[220:223], a[168:171], a[28:31], v[220:223]
  v_mfma_f32_16x16x32_bf16 v[236:239], a[172:175], a[28:31], v[236:239]
  ds_read_b64_tr_b16 a[168:169], v14 offset:41088
  v_mfma_f32_16x16x32_bf16 v[232:235], a[172:175], a[24:27], v[232:235]
  ds_read_b64_tr_b16 a[170:171], v14 offset:42112
  v_mfma_f32_16x16x32_bf16 v[228:231], a[172:175], a[20:23], v[228:231]
  buffer_load_dwordx4 a[72:75], v1, s[8:11], s31 offen offset:2048 sc1
  v_mfma_f32_16x16x32_bf16 v[224:227], a[172:175], a[16:19], v[224:227]
  v_mfma_f32_16x16x32_bf16 v[240:243], a[176:179], a[16:19], v[240:243]
  ds_read_b64_tr_b16 a[172:173], v14 offset:41120
  v_mfma_f32_16x16x32_bf16 v[244:247], a[176:179], a[20:23], v[244:247]
  ds_read_b64_tr_b16 a[174:175], v14 offset:42144
  v_mfma_f32_16x16x32_bf16 v[248:251], a[176:179], a[24:27], v[248:251]
  buffer_load_dwordx4 a[76:79], v1, s[8:11], s31 offen offset:3072 sc1
  v_mfma_f32_16x16x32_bf16 v[252:255], a[176:179], a[28:31], v[252:255]
  ds_read_b64_tr_b16 a[176:177], v14 offset:41152
  ds_read_b64_tr_b16 a[178:179], v14 offset:42176
  s_waitcnt vmcnt(11) lgkmcnt(4)
  v_mfma_f32_16x16x32_bf16 v[48:51], a[128:131], a[32:35], v[48:51]
  v_mfma_f32_16x16x32_bf16 v[52:55], a[128:131], a[36:39], v[52:55]
  v_mfma_f32_16x16x32_bf16 v[56:59], a[128:131], a[40:43], v[56:59]
  v_mfma_f32_16x16x32_bf16 v[60:63], a[128:131], a[44:47], v[60:63]
  v_mfma_f32_16x16x32_bf16 v[76:79], a[132:135], a[44:47], v[76:79]
  ds_read_b64_tr_b16 a[128:129], v10 offset:34816
  v_mfma_f32_16x16x32_bf16 v[72:75], a[132:135], a[40:43], v[72:75]
  ds_read_b64_tr_b16 a[130:131], v10 offset:35584
  v_mfma_f32_16x16x32_bf16 v[68:71], a[132:135], a[36:39], v[68:71]
  buffer_load_dwordx4 a[80:83], v2, s[8:11], s31 offen offset:0 sc1
  v_mfma_f32_16x16x32_bf16 v[64:67], a[132:135], a[32:35], v[64:67]
  s_lshl_b32 s3, s50, 20
  v_mfma_f32_16x16x32_bf16 v[80:83], a[136:139], a[32:35], v[80:83]
  ds_read_b64_tr_b16 a[132:133], v12 offset:34848
  v_mfma_f32_16x16x32_bf16 v[84:87], a[136:139], a[36:39], v[84:87]
  ds_read_b64_tr_b16 a[134:135], v12 offset:35616
  v_mfma_f32_16x16x32_bf16 v[88:91], a[136:139], a[40:43], v[88:91]
  s_add_u32 s44, s44, s3
  v_mfma_f32_16x16x32_bf16 v[92:95], a[136:139], a[44:47], v[92:95]
  s_addc_u32 s45, s45, 0
  v_mfma_f32_16x16x32_bf16 v[108:111], a[140:143], a[44:47], v[108:111]
  ds_read_b64_tr_b16 a[136:137], v10 offset:34880
  v_mfma_f32_16x16x32_bf16 v[104:107], a[140:143], a[40:43], v[104:107]
  ds_read_b64_tr_b16 a[138:139], v10 offset:35648
  v_mfma_f32_16x16x32_bf16 v[100:103], a[140:143], a[36:39], v[100:103]
  s_mul_i32 s76, s68, 7
  v_mfma_f32_16x16x32_bf16 v[96:99], a[140:143], a[32:35], v[96:99]
  s_lshr_b32 s76, s76, 2
  v_mfma_f32_16x16x32_bf16 v[112:115], a[32:35], a[144:147], v[112:115]
  ds_read_b64_tr_b16 a[140:141], v12 offset:34912
  ds_read_b64_tr_b16 a[142:143], v12 offset:35680
  v_mfma_f32_16x16x32_bf16 v[116:119], a[36:39], a[144:147], v[116:119]
  buffer_load_dwordx4 a[84:87], v2, s[8:11], s31 offen offset:1024 sc1
  v_mfma_f32_16x16x32_bf16 v[120:123], a[40:43], a[144:147], v[120:123]
  s_lshl_b32 s38, s76, 17
  v_mfma_f32_16x16x32_bf16 v[124:127], a[44:47], a[144:147], v[124:127]
  s_mov_b32 s77, 0
  v_mfma_f32_16x16x32_bf16 v[140:143], a[44:47], a[148:151], v[140:143]
  ds_read_b64_tr_b16 a[144:145], v10 offset:34944
  v_mfma_f32_16x16x32_bf16 v[136:139], a[40:43], a[148:151], v[136:139]
  v_mfma_f32_16x16x32_bf16 v[132:135], a[36:39], a[148:151], v[132:135]
  ds_read_b64_tr_b16 a[146:147], v10 offset:35712
  v_mfma_f32_16x16x32_bf16 v[128:131], a[32:35], a[148:151], v[128:131]
  v_mfma_f32_16x16x32_bf16 v[144:147], a[152:155], a[32:35], v[144:147]
  ds_read_b64_tr_b16 a[148:149], v12 offset:34976
  v_mfma_f32_16x16x32_bf16 v[148:151], a[152:155], a[36:39], v[148:151]
  v_mfma_f32_16x16x32_bf16 v[152:155], a[152:155], a[40:43], v[152:155]
  ds_read_b64_tr_b16 a[150:151], v12 offset:35744
  v_mfma_f32_16x16x32_bf16 v[156:159], a[152:155], a[44:47], v[156:159]
  s_waitcnt lgkmcnt(4)
  v_mfma_f32_16x16x32_bf16 v[172:175], a[156:159], a[44:47], v[172:175]
  ds_read_b64_tr_b16 a[152:153], v14 offset:49152
  v_mfma_f32_16x16x32_bf16 v[168:171], a[156:159], a[40:43], v[168:171]
  ds_read_b64_tr_b16 a[154:155], v14 offset:50176
  v_mfma_f32_16x16x32_bf16 v[164:167], a[156:159], a[36:39], v[164:167]
  buffer_load_dwordx4 a[88:91], v2, s[8:11], s31 offen offset:2048 sc1
  v_mfma_f32_16x16x32_bf16 v[160:163], a[156:159], a[32:35], v[160:163]
  v_mfma_f32_16x16x32_bf16 v[176:179], a[160:163], a[32:35], v[176:179]
  ds_read_b64_tr_b16 a[156:157], v14 offset:49184
  v_mfma_f32_16x16x32_bf16 v[180:183], a[160:163], a[36:39], v[180:183]
  v_mfma_f32_16x16x32_bf16 v[184:187], a[160:163], a[40:43], v[184:187]
  ds_read_b64_tr_b16 a[158:159], v14 offset:50208
  v_mfma_f32_16x16x32_bf16 v[188:191], a[160:163], a[44:47], v[188:191]
  v_mfma_f32_16x16x32_bf16 v[204:207], a[164:167], a[44:47], v[204:207]
  ds_read_b64_tr_b16 a[160:161], v14 offset:49216
  v_mfma_f32_16x16x32_bf16 v[200:203], a[164:167], a[40:43], v[200:203]
  v_mfma_f32_16x16x32_bf16 v[196:199], a[164:167], a[36:39], v[196:199]
  ds_read_b64_tr_b16 a[162:163], v14 offset:50240
  v_mfma_f32_16x16x32_bf16 v[192:195], a[164:167], a[32:35], v[192:195]
  v_mfma_f32_16x16x32_bf16 v[208:211], a[168:171], a[32:35], v[208:211]
  ds_read_b64_tr_b16 a[164:165], v14 offset:49248
  v_mfma_f32_16x16x32_bf16 v[212:215], a[168:171], a[36:39], v[212:215]
  ds_read_b64_tr_b16 a[166:167], v14 offset:50272
  v_mfma_f32_16x16x32_bf16 v[216:219], a[168:171], a[40:43], v[216:219]
  buffer_load_dwordx4 a[92:95], v2, s[8:11], s31 offen offset:3072 sc1
  v_mfma_f32_16x16x32_bf16 v[220:223], a[168:171], a[44:47], v[220:223]
  v_mfma_f32_16x16x32_bf16 v[236:239], a[172:175], a[44:47], v[236:239]
  ds_read_b64_tr_b16 a[168:169], v14 offset:49280
  v_mfma_f32_16x16x32_bf16 v[232:235], a[172:175], a[40:43], v[232:235]
  v_mfma_f32_16x16x32_bf16 v[228:231], a[172:175], a[36:39], v[228:231]
  ds_read_b64_tr_b16 a[170:171], v14 offset:50304
  v_mfma_f32_16x16x32_bf16 v[224:227], a[172:175], a[32:35], v[224:227]
  v_mfma_f32_16x16x32_bf16 v[240:243], a[176:179], a[32:35], v[240:243]
  ds_read_b64_tr_b16 a[172:173], v14 offset:49312
  v_mfma_f32_16x16x32_bf16 v[244:247], a[176:179], a[36:39], v[244:247]
  ds_read_b64_tr_b16 a[174:175], v14 offset:50336
  v_mfma_f32_16x16x32_bf16 v[248:251], a[176:179], a[40:43], v[248:251]
  s_add_u32 s31, s31, 16384
  v_mfma_f32_16x16x32_bf16 v[252:255], a[176:179], a[44:47], v[252:255]
  s_and_b32 s31, s31, 0x1ffff
  ds_read_b64_tr_b16 a[176:177], v14 offset:49344
  ds_read_b64_tr_b16 a[178:179], v14 offset:50368
  s_waitcnt vmcnt(11) lgkmcnt(4)
  v_mfma_f32_16x16x32_bf16 v[48:51], a[128:131], a[48:51], v[48:51]
  v_mfma_f32_16x16x32_bf16 v[52:55], a[128:131], a[52:55], v[52:55]
  v_mfma_f32_16x16x32_bf16 v[56:59], a[128:131], a[56:59], v[56:59]
  v_mfma_f32_16x16x32_bf16 v[60:63], a[128:131], a[60:63], v[60:63]
  v_mfma_f32_16x16x32_bf16 v[76:79], a[132:135], a[60:63], v[76:79]
  v_mfma_f32_16x16x32_bf16 v[72:75], a[132:135], a[56:59], v[72:75]
  v_mfma_f32_16x16x32_bf16 v[68:71], a[132:135], a[52:55], v[68:71]
  v_mfma_f32_16x16x32_bf16 v[64:67], a[132:135], a[48:51], v[64:67]
  s_waitcnt lgkmcnt(0)
  s_barrier
  v_mfma_f32_16x16x32_bf16 v[80:83], a[136:139], a[48:51], v[80:83]
  ds_read_b64_tr_b16 a[128:129], v11 offset:0
  v_mfma_f32_16x16x32_bf16 v[84:87], a[136:139], a[52:55], v[84:87]
  ds_read_b64_tr_b16 a[130:131], v11 offset:768
  v_mfma_f32_16x16x32_bf16 v[88:91], a[136:139], a[56:59], v[88:91]
  ds_read_b64_tr_b16 a[132:133], v13 offset:32
  v_mfma_f32_16x16x32_bf16 v[92:95], a[136:139], a[60:63], v[92:95]
  ds_read_b64_tr_b16 a[134:135], v13 offset:800
  v_mfma_f32_16x16x32_bf16 v[108:111], a[140:143], a[60:63], v[108:111]
  ds_read_b64_tr_b16 a[136:137], v11 offset:64
  v_mfma_f32_16x16x32_bf16 v[104:107], a[140:143], a[56:59], v[104:107]
  v_mfma_f32_16x16x32_bf16 v[100:103], a[140:143], a[52:55], v[100:103]
  ds_read_b64_tr_b16 a[138:139], v11 offset:832
  v_mfma_f32_16x16x32_bf16 v[96:99], a[140:143], a[48:51], v[96:99]
  v_mfma_f32_16x16x32_bf16 v[112:115], a[48:51], a[144:147], v[112:115]
  ds_read_b64_tr_b16 a[140:141], v13 offset:96
  v_mfma_f32_16x16x32_bf16 v[116:119], a[52:55], a[144:147], v[116:119]
  v_mfma_f32_16x16x32_bf16 v[120:123], a[56:59], a[144:147], v[120:123]
  ds_read_b64_tr_b16 a[142:143], v13 offset:864
  v_mfma_f32_16x16x32_bf16 v[124:127], a[60:63], a[144:147], v[124:127]
  v_mfma_f32_16x16x32_bf16 v[140:143], a[60:63], a[148:151], v[140:143]
  ds_read_b64_tr_b16 a[144:145], v11 offset:128
  v_mfma_f32_16x16x32_bf16 v[136:139], a[56:59], a[148:151], v[136:139]
  v_mfma_f32_16x16x32_bf16 v[132:135], a[52:55], a[148:151], v[132:135]
  ds_read_b64_tr_b16 a[146:147], v11 offset:896
  v_mfma_f32_16x16x32_bf16 v[128:131], a[48:51], a[148:151], v[128:131]
  v_mfma_f32_16x16x32_bf16 v[144:147], a[152:155], a[48:51], v[144:147]
  ds_read_b64_tr_b16 a[148:149], v13 offset:160
  v_mfma_f32_16x16x32_bf16 v[148:151], a[152:155], a[52:55], v[148:151]
  v_mfma_f32_16x16x32_bf16 v[152:155], a[152:155], a[56:59], v[152:155]
  ds_read_b64_tr_b16 a[150:151], v13 offset:928
  v_mfma_f32_16x16x32_bf16 v[156:159], a[152:155], a[60:63], v[156:159]
  v_mfma_f32_16x16x32_bf16 v[172:175], a[156:159], a[60:63], v[172:175]
  ds_read_b64_tr_b16 a[152:153], v15 offset:12288
  v_mfma_f32_16x16x32_bf16 v[168:171], a[156:159], a[56:59], v[168:171]
  v_mfma_f32_16x16x32_bf16 v[164:167], a[156:159], a[52:55], v[164:167]
  ds_read_b64_tr_b16 a[154:155], v15 offset:13312
  v_mfma_f32_16x16x32_bf16 v[160:163], a[156:159], a[48:51], v[160:163]
  v_mfma_f32_16x16x32_bf16 v[176:179], a[160:163], a[48:51], v[176:179]
  ds_read_b64_tr_b16 a[156:157], v15 offset:12320
  v_mfma_f32_16x16x32_bf16 v[180:183], a[160:163], a[52:55], v[180:183]
  v_mfma_f32_16x16x32_bf16 v[184:187], a[160:163], a[56:59], v[184:187]
  ds_read_b64_tr_b16 a[158:159], v15 offset:13344
  v_mfma_f32_16x16x32_bf16 v[188:191], a[160:163], a[60:63], v[188:191]
  v_mfma_f32_16x16x32_bf16 v[204:207], a[164:167], a[60:63], v[204:207]
  ds_read_b64_tr_b16 a[160:161], v15 offset:12352
  v_mfma_f32_16x16x32_bf16 v[200:203], a[164:167], a[56:59], v[200:203]
  ds_read_b64_tr_b16 a[162:163], v15 offset:13376
  v_mfma_f32_16x16x32_bf16 v[196:199], a[164:167], a[52:55], v[196:199]
  buffer_load_dwordx4 a[96:99], v1, s[8:11], s31 offen offset:0 sc1
  v_mfma_f32_16x16x32_bf16 v[192:195], a[164:167], a[48:51], v[192:195]
  v_mfma_f32_16x16x32_bf16 v[208:211], a[168:171], a[48:51], v[208:211]
  ds_read_b64_tr_b16 a[164:165], v15 offset:12384
  v_mfma_f32_16x16x32_bf16 v[212:215], a[168:171], a[52:55], v[212:215]
  ds_read_b64_tr_b16 a[166:167], v15 offset:13408
  v_mfma_f32_16x16x32_bf16 v[216:219], a[168:171], a[56:59], v[216:219]
  buffer_load_dwordx4 a[100:103], v1, s[8:11], s31 offen offset:1024 sc1
  v_mfma_f32_16x16x32_bf16 v[220:223], a[168:171], a[60:63], v[220:223]
  v_mfma_f32_16x16x32_bf16 v[236:239], a[172:175], a[60:63], v[236:239]
  ds_read_b64_tr_b16 a[168:169], v15 offset:12416
  v_mfma_f32_16x16x32_bf16 v[232:235], a[172:175], a[56:59], v[232:235]
  ds_read_b64_tr_b16 a[170:171], v15 offset:13440
  v_mfma_f32_16x16x32_bf16 v[228:231], a[172:175], a[52:55], v[228:231]
  buffer_load_dwordx4 a[104:107], v1, s[8:11], s31 offen offset:2048 sc1
  v_mfma_f32_16x16x32_bf16 v[224:227], a[172:175], a[48:51], v[224:227]
  v_mfma_f32_16x16x32_bf16 v[240:243], a[176:179], a[48:51], v[240:243]
  ds_read_b64_tr_b16 a[172:173], v15 offset:12448
  v_mfma_f32_16x16x32_bf16 v[244:247], a[176:179], a[52:55], v[244:247]
  ds_read_b64_tr_b16 a[174:175], v15 offset:13472
  v_mfma_f32_16x16x32_bf16 v[248:251], a[176:179], a[56:59], v[248:251]
  buffer_load_dwordx4 a[108:111], v1, s[8:11], s31 offen offset:3072 sc1
  v_mfma_f32_16x16x32_bf16 v[252:255], a[176:179], a[60:63], v[252:255]
  ds_read_b64_tr_b16 a[176:177], v15 offset:12480
  ds_read_b64_tr_b16 a[178:179], v15 offset:13504
  s_waitcnt vmcnt(8) lgkmcnt(4)
  v_mfma_f32_16x16x32_bf16 v[48:51], a[128:131], a[64:67], v[48:51]
  v_mfma_f32_16x16x32_bf16 v[52:55], a[128:131], a[68:71], v[52:55]
  v_mfma_f32_16x16x32_bf16 v[56:59], a[128:131], a[72:75], v[56:59]
  v_mfma_f32_16x16x32_bf16 v[60:63], a[128:131], a[76:79], v[60:63]
  v_mfma_f32_16x16x32_bf16 v[76:79], a[132:135], a[76:79], v[76:79]
  ds_read_b64_tr_b16 a[128:129], v11 offset:6144
  v_mfma_f32_16x16x32_bf16 v[72:75], a[132:135], a[72:75], v[72:75]
  ds_read_b64_tr_b16 a[130:131], v11 offset:6912
  v_mfma_f32_16x16x32_bf16 v[68:71], a[132:135], a[68:71], v[68:71]
  buffer_load_dwordx4 a[112:115], v2, s[8:11], s31 offen offset:0 sc1
  v_mfma_f32_16x16x32_bf16 v[64:67], a[132:135], a[64:67], v[64:67]
  v_mfma_f32_16x16x32_bf16 v[80:83], a[136:139], a[64:67], v[80:83]
  ds_read_b64_tr_b16 a[132:133], v13 offset:6176
  v_mfma_f32_16x16x32_bf16 v[84:87], a[136:139], a[68:71], v[84:87]
  v_mfma_f32_16x16x32_bf16 v[88:91], a[136:139], a[72:75], v[88:91]
  ds_read_b64_tr_b16 a[134:135], v13 offset:6944
  v_mfma_f32_16x16x32_bf16 v[92:95], a[136:139], a[76:79], v[92:95]
  v_mfma_f32_16x16x32_bf16 v[108:111], a[140:143], a[76:79], v[108:111]
  ds_read_b64_tr_b16 a[136:137], v11 offset:6208
  v_mfma_f32_16x16x32_bf16 v[104:107], a[140:143], a[72:75], v[104:107]
  v_mfma_f32_16x16x32_bf16 v[100:103], a[140:143], a[68:71], v[100:103]
  ds_read_b64_tr_b16 a[138:139], v11 offset:6976
  v_mfma_f32_16x16x32_bf16 v[96:99], a[140:143], a[64:67], v[96:99]
  v_mfma_f32_16x16x32_bf16 v[112:115], a[64:67], a[144:147], v[112:115]
  ds_read_b64_tr_b16 a[140:141], v13 offset:6240
  v_mfma_f32_16x16x32_bf16 v[116:119], a[68:71], a[144:147], v[116:119]
  ds_read_b64_tr_b16 a[142:143], v13 offset:7008
  v_mfma_f32_16x16x32_bf16 v[120:123], a[72:75], a[144:147], v[120:123]
  buffer_load_dwordx4 a[116:119], v2, s[8:11], s31 offen offset:1024 sc1
  v_mfma_f32_16x16x32_bf16 v[124:127], a[76:79], a[144:147], v[124:127]
  v_mfma_f32_16x16x32_bf16 v[140:143], a[76:79], a[148:151], v[140:143]
  ds_read_b64_tr_b16 a[144:145], v11 offset:6272
  v_mfma_f32_16x16x32_bf16 v[136:139], a[72:75], a[148:151], v[136:139]
  v_mfma_f32_16x16x32_bf16 v[132:135], a[68:71], a[148:151], v[132:135]
  ds_read_b64_tr_b16 a[146:147], v11 offset:7040
  v_mfma_f32_16x16x32_bf16 v[128:131], a[64:67], a[148:151], v[128:131]
  v_mfma_f32_16x16x32_bf16 v[144:147], a[152:155], a[64:67], v[144:147]
  ds_read_b64_tr_b16 a[148:149], v13 offset:6304
  v_mfma_f32_16x16x32_bf16 v[148:151], a[152:155], a[68:71], v[148:151]
  v_mfma_f32_16x16x32_bf16 v[152:155], a[152:155], a[72:75], v[152:155]
  ds_read_b64_tr_b16 a[150:151], v13 offset:7072
  v_mfma_f32_16x16x32_bf16 v[156:159], a[152:155], a[76:79], v[156:159]
  s_waitcnt lgkmcnt(4)
  v_mfma_f32_16x16x32_bf16 v[172:175], a[156:159], a[76:79], v[172:175]
  ds_read_b64_tr_b16 a[152:153], v15 offset:20480
  v_mfma_f32_16x16x32_bf16 v[168:171], a[156:159], a[72:75], v[168:171]
  ds_read_b64_tr_b16 a[154:155], v15 offset:21504
  v_mfma_f32_16x16x32_bf16 v[164:167], a[156:159], a[68:71], v[164:167]
  buffer_load_dwordx4 a[120:123], v2, s[8:11], s31 offen offset:2048 sc1
  v_mfma_f32_16x16x32_bf16 v[160:163], a[156:159], a[64:67], v[160:163]
  v_mfma_f32_16x16x32_bf16 v[176:179], a[160:163], a[64:67], v[176:179]
  ds_read_b64_tr_b16 a[156:157], v15 offset:20512
  v_mfma_f32_16x16x32_bf16 v[180:183], a[160:163], a[68:71], v[180:183]
  v_mfma_f32_16x16x32_bf16 v[184:187], a[160:163], a[72:75], v[184:187]
  ds_read_b64_tr_b16 a[158:159], v15 offset:21536
  v_mfma_f32_16x16x32_bf16 v[188:191], a[160:163], a[76:79], v[188:191]
  v_mfma_f32_16x16x32_bf16 v[204:207], a[164:167], a[76:79], v[204:207]
  ds_read_b64_tr_b16 a[160:161], v15 offset:20544
  v_mfma_f32_16x16x32_bf16 v[200:203], a[164:167], a[72:75], v[200:203]
  v_mfma_f32_16x16x32_bf16 v[196:199], a[164:167], a[68:71], v[196:199]
  ds_read_b64_tr_b16 a[162:163], v15 offset:21568
  v_mfma_f32_16x16x32_bf16 v[192:195], a[164:167], a[64:67], v[192:195]
  v_mfma_f32_16x16x32_bf16 v[208:211], a[168:171], a[64:67], v[208:211]
  ds_read_b64_tr_b16 a[164:165], v15 offset:20576
  v_mfma_f32_16x16x32_bf16 v[212:215], a[168:171], a[68:71], v[212:215]
  ds_read_b64_tr_b16 a[166:167], v15 offset:21600
  v_mfma_f32_16x16x32_bf16 v[216:219], a[168:171], a[72:75], v[216:219]
  buffer_load_dwordx4 a[124:127], v2, s[8:11], s31 offen offset:3072 sc1
  v_mfma_f32_16x16x32_bf16 v[220:223], a[168:171], a[76:79], v[220:223]
  v_mfma_f32_16x16x32_bf16 v[236:239], a[172:175], a[76:79], v[236:239]
  ds_read_b64_tr_b16 a[168:169], v15 offset:20608
  v_mfma_f32_16x16x32_bf16 v[232:235], a[172:175], a[72:75], v[232:235]
  v_mfma_f32_16x16x32_bf16 v[228:231], a[172:175], a[68:71], v[228:231]
  ds_read_b64_tr_b16 a[170:171], v15 offset:21632
  v_mfma_f32_16x16x32_bf16 v[224:227], a[172:175], a[64:67], v[224:227]
  v_mfma_f32_16x16x32_bf16 v[240:243], a[176:179], a[64:67], v[240:243]
  ds_read_b64_tr_b16 a[172:173], v15 offset:20640
  v_mfma_f32_16x16x32_bf16 v[244:247], a[176:179], a[68:71], v[244:247]
  ds_read_b64_tr_b16 a[174:175], v15 offset:21664
  v_mfma_f32_16x16x32_bf16 v[248:251], a[176:179], a[72:75], v[248:251]
  s_add_u32 s31, s31, 16384
  v_mfma_f32_16x16x32_bf16 v[252:255], a[176:179], a[76:79], v[252:255]
  s_and_b32 s31, s31, 0x1ffff
  ds_read_b64_tr_b16 a[176:177], v15 offset:20672
  ds_read_b64_tr_b16 a[178:179], v15 offset:21696
  s_waitcnt vmcnt(8) lgkmcnt(4)
  v_mfma_f32_16x16x32_bf16 v[48:51], a[128:131], a[80:83], v[48:51]
  v_mfma_f32_16x16x32_bf16 v[52:55], a[128:131], a[84:87], v[52:55]
  v_mfma_f32_16x16x32_bf16 v[56:59], a[128:131], a[88:91], v[56:59]
  v_mfma_f32_16x16x32_bf16 v[60:63], a[128:131], a[92:95], v[60:63]
  v_mfma_f32_16x16x32_bf16 v[76:79], a[132:135], a[92:95], v[76:79]
  v_mfma_f32_16x16x32_bf16 v[72:75], a[132:135], a[88:91], v[72:75]
  v_mfma_f32_16x16x32_bf16 v[68:71], a[132:135], a[84:87], v[68:71]
  v_mfma_f32_16x16x32_bf16 v[64:67], a[132:135], a[80:83], v[64:67]
  s_waitcnt lgkmcnt(0)
  s_barrier
  v_mfma_f32_16x16x32_bf16 v[80:83], a[136:139], a[80:83], v[80:83]
  ds_read_b64_tr_b16 a[128:129], v11 offset:28672
  v_mfma_f32_16x16x32_bf16 v[84:87], a[136:139], a[84:87], v[84:87]
  ds_read_b64_tr_b16 a[130:131], v11 offset:29440
  v_mfma_f32_16x16x32_bf16 v[88:91], a[136:139], a[88:91], v[88:91]
  ds_read_b64_tr_b16 a[132:133], v13 offset:28704
  v_mfma_f32_16x16x32_bf16 v[92:95], a[136:139], a[92:95], v[92:95]
  ds_read_b64_tr_b16 a[134:135], v13 offset:29472
  v_mfma_f32_16x16x32_bf16 v[108:111], a[140:143], a[92:95], v[108:111]
  ds_read_b64_tr_b16 a[136:137], v11 offset:28736
  v_mfma_f32_16x16x32_bf16 v[104:107], a[140:143], a[88:91], v[104:107]
  ds_read_b64_tr_b16 a[138:139], v11 offset:29504
  v_mfma_f32_16x16x32_bf16 v[100:103], a[140:143], a[84:87], v[100:103]
  s_add_u32 m0, s39, 0
  v_mfma_f32_16x16x32_bf16 v[96:99], a[140:143], a[80:83], v[96:99]
  buffer_load_dwordx4 v18, s[4:7], s38 offen lds
  v_mfma_f32_16x16x32_bf16 v[112:115], a[80:83], a[144:147], v[112:115]
  ds_read_b64_tr_b16 a[140:141], v13 offset:28768
  v_mfma_f32_16x16x32_bf16 v[116:119], a[84:87], a[144:147], v[116:119]
  ds_read_b64_tr_b16 a[142:143], v13 offset:29536
  v_mfma_f32_16x16x32_bf16 v[120:123], a[88:91], a[144:147], v[120:123]
  s_add_u32 m0, s39, 1024
  v_mfma_f32_16x16x32_bf16 v[124:127], a[92:95], a[144:147], v[124:127]
  buffer_load_dwordx4 v19, s[4:7], s38 offen lds
  v_mfma_f32_16x16x32_bf16 v[140:143], a[92:95], a[148:151], v[140:143]
  ds_read_b64_tr_b16 a[144:145], v11 offset:28800
  v_mfma_f32_16x16x32_bf16 v[136:139], a[88:91], a[148:151], v[136:139]
  ds_read_b64_tr_b16 a[146:147], v11 offset:29568
  v_mfma_f32_16x16x32_bf16 v[132:135], a[84:87], a[148:151], v[132:135]
  s_add_u32 m0, s39, 2048
  v_mfma_f32_16x16x32_bf16 v[128:131], a[80:83], a[148:151], v[128:131]
  buffer_load_dwordx4 v20, s[4:7], s38 offen lds
  v_mfma_f32_16x16x32_bf16 v[144:147], a[152:155], a[80:83], v[144:147]
  ds_read_b64_tr_b16 a[148:149], v13 offset:28832
  v_mfma_f32_16x16x32_bf16 v[148:151], a[152:155], a[84:87], v[148:151]
  ds_read_b64_tr_b16 a[150:151], v13 offset:29600
  v_mfma_f32_16x16x32_bf16 v[152:155], a[152:155], a[88:91], v[152:155]
  s_add_u32 m0, s39, 3072
  v_mfma_f32_16x16x32_bf16 v[156:159], a[152:155], a[92:95], v[156:159]
  buffer_load_dwordx4 v21, s[4:7], s38 offen lds
  v_mfma_f32_16x16x32_bf16 v[172:175], a[156:159], a[92:95], v[172:175]
  ds_read_b64_tr_b16 a[152:153], v15 offset:40960
  ds_read_b64_tr_b16 a[154:155], v15 offset:41984
  s_add_u32 s38, s38, 131072
  v_mfma_f32_16x16x32_bf16 v[168:171], a[156:159], a[88:91], v[168:171]
  s_cmp_eq_u32 s38, 3670016
  s_cselect_b32 s38, 0, s38
  s_add_u32 s77, s77, 1
  v_mfma_f32_16x16x32_bf16 v[164:167], a[156:159], a[84:87], v[164:167]
  s_cmp_eq_u32 s77, 28
  s_cselect_b32 s4, s44, s4
  s_cselect_b32 s5, s45, s5
  v_mfma_f32_16x16x32_bf16 v[160:163], a[156:159], a[80:83], v[160:163]
  s_cselect_b32 s6, 0x100000, s6
  s_cselect_b32 s38, 0, s38
  v_mfma_f32_16x16x32_bf16 v[176:179], a[160:163], a[80:83], v[176:179]
  ds_read_b64_tr_b16 a[156:157], v15 offset:40992
  v_mfma_f32_16x16x32_bf16 v[180:183], a[160:163], a[84:87], v[180:183]
  ds_read_b64_tr_b16 a[158:159], v15 offset:42016
  v_mfma_f32_16x16x32_bf16 v[184:187], a[160:163], a[88:91], v[184:187]
  s_add_u32 m0, s39, 16384
  v_mfma_f32_16x16x32_bf16 v[188:191], a[160:163], a[92:95], v[188:191]
  buffer_load_dwordx4 v18, s[4:7], s38 offen lds
  v_mfma_f32_16x16x32_bf16 v[204:207], a[164:167], a[92:95], v[204:207]
  ds_read_b64_tr_b16 a[160:161], v15 offset:41024
  v_mfma_f32_16x16x32_bf16 v[200:203], a[164:167], a[88:91], v[200:203]
  ds_read_b64_tr_b16 a[162:163], v15 offset:42048
  v_mfma_f32_16x16x32_bf16 v[196:199], a[164:167], a[84:87], v[196:199]
  s_add_u32 m0, s39, 17408
  v_mfma_f32_16x16x32_bf16 v[192:195], a[164:167], a[80:83], v[192:195]
  buffer_load_dwordx4 v19, s[4:7], s38 offen lds
  v_mfma_f32_16x16x32_bf16 v[208:211], a[168:171], a[80:83], v[208:211]
  ds_read_b64_tr_b16 a[164:165], v15 offset:41056
  v_mfma_f32_16x16x32_bf16 v[212:215], a[168:171], a[84:87], v[212:215]
  ds_read_b64_tr_b16 a[166:167], v15 offset:42080
  v_mfma_f32_16x16x32_bf16 v[216:219], a[168:171], a[88:91], v[216:219]
  s_add_u32 m0, s39, 18432
  v_mfma_f32_16x16x32_bf16 v[220:223], a[168:171], a[92:95], v[220:223]
  buffer_load_dwordx4 v20, s[4:7], s38 offen lds
  v_mfma_f32_16x16x32_bf16 v[236:239], a[172:175], a[92:95], v[236:239]
  ds_read_b64_tr_b16 a[168:169], v15 offset:41088
  v_mfma_f32_16x16x32_bf16 v[232:235], a[172:175], a[88:91], v[232:235]
  ds_read_b64_tr_b16 a[170:171], v15 offset:42112
  v_mfma_f32_16x16x32_bf16 v[228:231], a[172:175], a[84:87], v[228:231]
  s_add_u32 m0, s39, 19456
  v_mfma_f32_16x16x32_bf16 v[224:227], a[172:175], a[80:83], v[224:227]
  buffer_load_dwordx4 v21, s[4:7], s38 offen lds
  v_mfma_f32_16x16x32_bf16 v[240:243], a[176:179], a[80:83], v[240:243]
  ds_read_b64_tr_b16 a[172:173], v15 offset:41120
  ds_read_b64_tr_b16 a[174:175], v15 offset:42144
  s_add_u32 s38, s38, 131072
  v_mfma_f32_16x16x32_bf16 v[244:247], a[176:179], a[84:87], v[244:247]
  s_cmp_eq_u32 s38, 3670016
  s_cselect_b32 s38, 0, s38
  s_add_u32 s77, s77, 1
  v_mfma_f32_16x16x32_bf16 v[248:251], a[176:179], a[88:91], v[248:251]
  s_cmp_eq_u32 s77, 28
  s_cselect_b32 s4, s44, s4
  s_cselect_b32 s5, s45, s5
  v_mfma_f32_16x16x32_bf16 v[252:255], a[176:179], a[92:95], v[252:255]
  s_cselect_b32 s6, 0x100000, s6
  s_cselect_b32 s38, 0, s38
  ds_read_b64_tr_b16 a[176:177], v15 offset:41152
  ds_read_b64_tr_b16 a[178:179], v15 offset:42176
  s_waitcnt vmcnt(12) lgkmcnt(4)
  v_mfma_f32_16x16x32_bf16 v[48:51], a[128:131], a[96:99], v[48:51]
  v_mfma_f32_16x16x32_bf16 v[52:55], a[128:131], a[100:103], v[52:55]
  v_mfma_f32_16x16x32_bf16 v[56:59], a[128:131], a[104:107], v[56:59]
  v_mfma_f32_16x16x32_bf16 v[60:63], a[128:131], a[108:111], v[60:63]
  v_mfma_f32_16x16x32_bf16 v[76:79], a[132:135], a[108:111], v[76:79]
  ds_read_b64_tr_b16 a[128:129], v11 offset:34816
  ds_read_b64_tr_b16 a[130:131], v11 offset:35584
  v_mfma_f32_16x16x32_bf16 v[72:75], a[132:135], a[104:107], v[72:75]
  s_lshl_b32 s3, s28, 7
  v_mfma_f32_16x16x32_bf16 v[68:71], a[132:135], a[100:103], v[68:71]
  s_lshl_b32 s35, s29, 4
  v_mfma_f32_16x16x32_bf16 v[64:67], a[132:135], a[96:99], v[64:67]
  s_add_u32 s3, s3, s35
  v_mfma_f32_16x16x32_bf16 v[80:83], a[136:139], a[96:99], v[80:83]
  ds_read_b64_tr_b16 a[132:133], v13 offset:34848
  ds_read_b64_tr_b16 a[134:135], v13 offset:35616
  v_mfma_f32_16x16x32_bf16 v[84:87], a[136:139], a[100:103], v[84:87]
  s_lshl_b32 s35, s30, 2
  v_mfma_f32_16x16x32_bf16 v[88:91], a[136:139], a[104:107], v[88:91]
  s_add_u32 s3, s3, s35
  v_mfma_f32_16x16x32_bf16 v[92:95], a[136:139], a[108:111], v[92:95]
  s_lshl_b32 s3, s3, 10
  v_mfma_f32_16x16x32_bf16 v[108:111], a[140:143], a[108:111], v[108:111]
  ds_read_b64_tr_b16 a[136:137], v11 offset:34880
  ds_read_b64_tr_b16 a[138:139], v11 offset:35648
  v_mfma_f32_16x16x32_bf16 v[104:107], a[140:143], a[104:107], v[104:107]
  s_add_u32 s31, s3, 8388608
  v_mfma_f32_16x16x32_bf16 v[100:103], a[140:143], a[100:103], v[100:103]
  s_add_u32 s32, s3, 12582912
  v_mfma_f32_16x16x32_bf16 v[96:99], a[140:143], a[96:99], v[96:99]
  v_lshlrev_b32 v1, 4, v17
  v_mfma_f32_16x16x32_bf16 v[112:115], a[96:99], a[144:147], v[112:115]
  ds_read_b64_tr_b16 a[140:141], v13 offset:34912
  ds_read_b64_tr_b16 a[142:143], v13 offset:35680
  v_mfma_f32_16x16x32_bf16 v[116:119], a[100:103], a[144:147], v[116:119]
  v_add_u32 v2, 0x1000, v1
  v_mfma_f32_16x16x32_bf16 v[120:123], a[104:107], a[144:147], v[120:123]
  s_lshl_b32 s3, s30, 12
  v_mfma_f32_16x16x32_bf16 v[124:127], a[108:111], a[144:147], v[124:127]
  s_add_u32 s3, s3, 65536
  v_mfma_f32_16x16x32_bf16 v[140:143], a[108:111], a[148:151], v[140:143]
  ds_read_b64_tr_b16 a[144:145], v11 offset:34944
  ds_read_b64_tr_b16 a[146:147], v11 offset:35712
  v_mfma_f32_16x16x32_bf16 v[136:139], a[104:107], a[148:151], v[136:139]
  v_add_u32 v3, s3, v1
  v_mfma_f32_16x16x32_bf16 v[132:135], a[100:103], a[148:151], v[132:135]
  s_lshl_b32 s3, s29, 3
  v_mfma_f32_16x16x32_bf16 v[128:131], a[96:99], a[148:151], v[128:131]
  s_lshl_b32 s35, s30, 1
  v_mfma_f32_16x16x32_bf16 v[144:147], a[152:155], a[96:99], v[144:147]
  ds_read_b64_tr_b16 a[148:149], v13 offset:34976
  ds_read_b64_tr_b16 a[150:151], v13 offset:35744
  v_mfma_f32_16x16x32_bf16 v[148:151], a[152:155], a[100:103], v[148:151]
  s_add_u32 s3, s3, s35
  v_mfma_f32_16x16x32_bf16 v[152:155], a[152:155], a[104:107], v[152:155]
  s_mul_i32 s3, s3, 294912
  v_mfma_f32_16x16x32_bf16 v[156:159], a[152:155], a[108:111], v[156:159]
  s_add_u32 s3, s3, 16777216
  s_waitcnt lgkmcnt(4)
  v_mfma_f32_16x16x32_bf16 v[172:175], a[156:159], a[108:111], v[172:175]
  ds_read_b64_tr_b16 a[152:153], v15 offset:49152
  ds_read_b64_tr_b16 a[154:155], v15 offset:50176
  v_mfma_f32_16x16x32_bf16 v[168:171], a[156:159], a[104:107], v[168:171]
  s_add_u32 s33, s28, 112
  v_mfma_f32_16x16x32_bf16 v[164:167], a[156:159], a[100:103], v[164:167]
  s_lshl_b32 s33, s33, 11
  v_mfma_f32_16x16x32_bf16 v[160:163], a[156:159], a[96:99], v[160:163]
  s_add_u32 s33, s33, s3
  v_mfma_f32_16x16x32_bf16 v[176:179], a[160:163], a[96:99], v[176:179]
  ds_read_b64_tr_b16 a[156:157], v15 offset:49184
  ds_read_b64_tr_b16 a[158:159], v15 offset:50208
  v_mfma_f32_16x16x32_bf16 v[180:183], a[160:163], a[100:103], v[180:183]
  s_add_u32 s34, s33, 294912
  v_mfma_f32_16x16x32_bf16 v[184:187], a[160:163], a[104:107], v[184:187]
  s_lshr_b32 s35, s28, 1
  v_mfma_f32_16x16x32_bf16 v[188:191], a[160:163], a[108:111], v[188:191]
  s_mul_i32 s35, s35, 7*2048
  v_mfma_f32_16x16x32_bf16 v[204:207], a[164:167], a[108:111], v[204:207]
  ds_read_b64_tr_b16 a[160:161], v15 offset:49216
  ds_read_b64_tr_b16 a[162:163], v15 offset:50240
  v_mfma_f32_16x16x32_bf16 v[200:203], a[164:167], a[104:107], v[200:203]
  s_add_u32 s3, s3, s35
  v_mfma_f32_16x16x32_bf16 v[196:199], a[164:167], a[100:103], v[196:199]
  s_lshl_b32 s35, s62, 13
  v_mfma_f32_16x16x32_bf16 v[192:195], a[164:167], a[96:99], v[192:195]
  s_add_u32 s16, s3, s35
  v_mfma_f32_16x16x32_bf16 v[208:211], a[168:171], a[96:99], v[208:211]
  ds_read_b64_tr_b16 a[164:165], v15 offset:49248
  ds_read_b64_tr_b16 a[166:167], v15 offset:50272
  v_mfma_f32_16x16x32_bf16 v[212:215], a[168:171], a[100:103], v[212:215]
  s_add_u32 s17, s16, 294912
  v_mfma_f32_16x16x32_bf16 v[216:219], a[168:171], a[104:107], v[216:219]
  s_lshl_b32 s35, s62, 9
  v_mfma_f32_16x16x32_bf16 v[220:223], a[168:171], a[108:111], v[220:223]
  s_add_u32 s35, s35, 3*2048
  v_mfma_f32_16x16x32_bf16 v[236:239], a[172:175], a[108:111], v[236:239]
  ds_read_b64_tr_b16 a[168:169], v15 offset:49280
  v_mfma_f32_16x16x32_bf16 v[232:235], a[172:175], a[104:107], v[232:235]
  ds_read_b64_tr_b16 a[170:171], v15 offset:50304
  v_mfma_f32_16x16x32_bf16 v[228:231], a[172:175], a[100:103], v[228:231]
  s_add_u32 s18, s3, s35
  v_mfma_f32_16x16x32_bf16 v[224:227], a[172:175], a[96:99], v[224:227]
  s_add_u32 s19, s18, 294912
  v_mfma_f32_16x16x32_bf16 v[240:243], a[176:179], a[96:99], v[240:243]
  ds_read_b64_tr_b16 a[172:173], v15 offset:49312
  v_mfma_f32_16x16x32_bf16 v[244:247], a[176:179], a[100:103], v[244:247]
  v_mfma_f32_16x16x32_bf16 v[248:251], a[176:179], a[104:107], v[248:251]
  ds_read_b64_tr_b16 a[174:175], v15 offset:50336
  v_mfma_f32_16x16x32_bf16 v[252:255], a[176:179], a[108:111], v[252:255]
  ds_read_b64_tr_b16 a[176:177], v15 offset:49344
  ds_read_b64_tr_b16 a[178:179], v15 offset:50368
  s_waitcnt vmcnt(8) lgkmcnt(4)
  v_mfma_f32_16x16x32_bf16 v[80:83], a[136:139], a[112:115], v[80:83]
  v_mfma_f32_16x16x32_bf16 v[84:87], a[136:139], a[116:119], v[84:87]
  v_mfma_f32_16x16x32_bf16 v[88:91], a[136:139], a[120:123], v[88:91]
  v_mfma_f32_16x16x32_bf16 v[92:95], a[136:139], a[124:127], v[92:95]
  v_mfma_f32_16x16x32_bf16 v[108:111], a[140:143], a[124:127], v[108:111]
  v_mfma_f32_16x16x32_bf16 v[104:107], a[140:143], a[120:123], v[104:107]
  v_mfma_f32_16x16x32_bf16 v[100:103], a[140:143], a[116:119], v[100:103]
  v_mfma_f32_16x16x32_bf16 v[96:99], a[140:143], a[112:115], v[96:99]
  s_waitcnt lgkmcnt(0)
  s_barrier
  v_mfma_f32_16x16x32_bf16 v[112:115], a[112:115], a[144:147], v[112:115]
  s_add_u32 m0, s39, 32768
  v_mfma_f32_16x16x32_bf16 v[116:119], a[116:119], a[144:147], v[116:119]
  buffer_load_dwordx4 v18, s[4:7], s38 offen lds
  v_mfma_f32_16x16x32_bf16 v[120:123], a[120:123], a[144:147], v[120:123]
  s_add_u32 m0, s39, 33792
  v_mfma_f32_16x16x32_bf16 v[124:127], a[124:127], a[144:147], v[124:127]
  buffer_load_dwordx4 v19, s[4:7], s38 offen lds
  v_mfma_f32_16x16x32_bf16 v[140:143], a[124:127], a[148:151], v[140:143]
  s_add_u32 m0, s39, 34816
  v_mfma_f32_16x16x32_bf16 v[136:139], a[120:123], a[148:151], v[136:139]
  buffer_load_dwordx4 v20, s[4:7], s38 offen lds
  v_mfma_f32_16x16x32_bf16 v[132:135], a[116:119], a[148:151], v[132:135]
  s_add_u32 m0, s39, 35840
  v_mfma_f32_16x16x32_bf16 v[128:131], a[112:115], a[148:151], v[128:131]
  buffer_load_dwordx4 v21, s[4:7], s38 offen lds
  v_mfma_f32_16x16x32_bf16 v[48:51], a[128:131], a[112:115], v[48:51]
  v_cvt_pk_bf16_f32 v4, v80, v81
  v_cvt_pk_bf16_f32 v5, v82, v83
  v_mfma_f32_16x16x32_bf16 v[52:55], a[128:131], a[116:119], v[52:55]
  v_cvt_pk_bf16_f32 v6, v96, v97
  v_cvt_pk_bf16_f32 v7, v98, v99
  v_mfma_f32_16x16x32_bf16 v[56:59], a[128:131], a[120:123], v[56:59]
  buffer_store_dwordx4 v[4:7], v1, s[20:23], s31 offen offset:0 sc1
  ds_write_b128 v3, v[4:7] offset:16384
  v_mfma_f32_16x16x32_bf16 v[60:63], a[128:131], a[124:127], v[60:63]
  v_cvt_pk_bf16_f32 v8, v84, v85
  v_cvt_pk_bf16_f32 v9, v86, v87
  v_mfma_f32_16x16x32_bf16 v[76:79], a[132:135], a[124:127], v[76:79]
  v_cvt_pk_bf16_f32 v10, v100, v101
  v_cvt_pk_bf16_f32 v11, v102, v103
  v_mfma_f32_16x16x32_bf16 v[72:75], a[132:135], a[120:123], v[72:75]
  buffer_store_dwordx4 v[8:11], v1, s[20:23], s31 offen offset:1024 sc1
  ds_write_b128 v3, v[8:11] offset:17408
  v_mfma_f32_16x16x32_bf16 v[68:71], a[132:135], a[116:119], v[68:71]
  v_cvt_pk_bf16_f32 v12, v88, v89
  v_cvt_pk_bf16_f32 v13, v90, v91
  v_mfma_f32_16x16x32_bf16 v[64:67], a[132:135], a[112:115], v[64:67]
  v_cvt_pk_bf16_f32 v14, v104, v105
  v_cvt_pk_bf16_f32 v15, v106, v107
  v_mfma_f32_16x16x32_bf16 v[208:211], a[168:171], a[112:115], v[208:211]
  buffer_store_dwordx4 v[12:15], v1, s[20:23], s31 offen offset:2048 sc1
  ds_write_b128 v3, v[12:15] offset:18432
  v_mfma_f32_16x16x32_bf16 v[212:215], a[168:171], a[116:119], v[212:215]
  v_cvt_pk_bf16_f32 v28, v92, v93
  v_cvt_pk_bf16_f32 v29, v94, v95
  v_mfma_f32_16x16x32_bf16 v[216:219], a[168:171], a[120:123], v[216:219]
  v_cvt_pk_bf16_f32 v30, v108, v109
  v_cvt_pk_bf16_f32 v31, v110, v111
  v_mfma_f32_16x16x32_bf16 v[220:223], a[168:171], a[124:127], v[220:223]
  buffer_store_dwordx4 v[28:31], v1, s[20:23], s31 offen offset:3072 sc1
  ds_write_b128 v3, v[28:31] offset:19456
  v_mfma_f32_16x16x32_bf16 v[236:239], a[172:175], a[124:127], v[236:239]
  v_cvt_pk_bf16_f32 v4, v112, v113
  v_cvt_pk_bf16_f32 v5, v114, v115
  v_mfma_f32_16x16x32_bf16 v[232:235], a[172:175], a[120:123], v[232:235]
  v_cvt_pk_bf16_f32 v6, v116, v117
  v_cvt_pk_bf16_f32 v7, v118, v119
  v_mfma_f32_16x16x32_bf16 v[228:231], a[172:175], a[116:119], v[228:231]
  buffer_store_dwordx4 v[4:7], v1, s[20:23], s32 offen offset:0 sc1
  ds_write_b128 v3, v[4:7] offset:49152
  v_mfma_f32_16x16x32_bf16 v[224:227], a[172:175], a[112:115], v[224:227]
  v_cvt_pk_bf16_f32 v8, v128, v129
  v_cvt_pk_bf16_f32 v9, v130, v131
  v_mfma_f32_16x16x32_bf16 v[144:147], a[152:155], a[112:115], v[144:147]
  v_cvt_pk_bf16_f32 v10, v132, v133
  v_cvt_pk_bf16_f32 v11, v134, v135
  v_mfma_f32_16x16x32_bf16 v[148:151], a[152:155], a[116:119], v[148:151]
  buffer_store_dwordx4 v[8:11], v1, s[20:23], s32 offen offset:1024 sc1
  ds_write_b128 v3, v[8:11] offset:50176
  v_mfma_f32_16x16x32_bf16 v[152:155], a[152:155], a[120:123], v[152:155]
  v_cvt_pk_bf16_f32 v12, v120, v121
  v_cvt_pk_bf16_f32 v13, v122, v123
  v_mfma_f32_16x16x32_bf16 v[156:159], a[152:155], a[124:127], v[156:159]
  v_cvt_pk_bf16_f32 v14, v124, v125
  v_cvt_pk_bf16_f32 v15, v126, v127
  v_mfma_f32_16x16x32_bf16 v[172:175], a[156:159], a[124:127], v[172:175]
  buffer_store_dwordx4 v[12:15], v1, s[20:23], s32 offen offset:2048 sc1
  ds_write_b128 v3, v[12:15] offset:51200
  v_mfma_f32_16x16x32_bf16 v[168:171], a[156:159], a[120:123], v[168:171]
  v_cvt_pk_bf16_f32 v28, v136, v137
  v_cvt_pk_bf16_f32 v29, v138, v139
  v_mfma_f32_16x16x32_bf16 v[164:167], a[156:159], a[116:119], v[164:167]
  v_cvt_pk_bf16_f32 v30, v140, v141
  v_cvt_pk_bf16_f32 v31, v142, v143
  v_mfma_f32_16x16x32_bf16 v[160:163], a[156:159], a[112:115], v[160:163]
  buffer_store_dwordx4 v[28:31], v1, s[20:23], s32 offen offset:3072 sc1
  ds_write_b128 v3, v[28:31] offset:52224
  v_mfma_f32_16x16x32_bf16 v[176:179], a[160:163], a[112:115], v[176:179]
  v_cvt_pk_bf16_f32 v32, v48, v49
  v_cvt_pk_bf16_f32 v33, v50, v51
  v_mfma_f32_16x16x32_bf16 v[180:183], a[160:163], a[116:119], v[180:183]
  v_cvt_pk_bf16_f32 v34, v64, v65
  v_cvt_pk_bf16_f32 v35, v66, v67
  v_mfma_f32_16x16x32_bf16 v[184:187], a[160:163], a[120:123], v[184:187]
  v_cvt_pk_bf16_f32 v36, v52, v53
  v_cvt_pk_bf16_f32 v37, v54, v55
  v_mfma_f32_16x16x32_bf16 v[188:191], a[160:163], a[124:127], v[188:191]
  v_cvt_pk_bf16_f32 v38, v68, v69
  v_cvt_pk_bf16_f32 v39, v70, v71
  v_mfma_f32_16x16x32_bf16 v[204:207], a[164:167], a[124:127], v[204:207]
  v_cvt_pk_bf16_f32 v40, v56, v57
  v_cvt_pk_bf16_f32 v41, v58, v59
  v_mfma_f32_16x16x32_bf16 v[200:203], a[164:167], a[120:123], v[200:203]
  v_cvt_pk_bf16_f32 v42, v72, v73
  v_cvt_pk_bf16_f32 v43, v74, v75
  v_mfma_f32_16x16x32_bf16 v[196:199], a[164:167], a[116:119], v[196:199]
  v_cvt_pk_bf16_f32 v44, v60, v61
  v_cvt_pk_bf16_f32 v45, v62, v63
  v_mfma_f32_16x16x32_bf16 v[192:195], a[164:167], a[112:115], v[192:195]
  v_cvt_pk_bf16_f32 v46, v76, v77
  v_cvt_pk_bf16_f32 v47, v78, v79
  v_mfma_f32_16x16x32_bf16 v[240:243], a[176:179], a[112:115], v[240:243]
  s_add_u32 s38, s38, 131072
  s_cmp_eq_u32 s38, 3670016
  s_cselect_b32 s38, 0, s38
  s_add_u32 s77, s77, 1
  v_mfma_f32_16x16x32_bf16 v[244:247], a[176:179], a[116:119], v[244:247]
  s_cmp_eq_u32 s77, 28
  s_cselect_b32 s4, s44, s4
  s_cselect_b32 s5, s45, s5
  v_mfma_f32_16x16x32_bf16 v[248:251], a[176:179], a[120:123], v[248:251]
  s_cselect_b32 s6, 0x100000, s6
  s_cselect_b32 s38, 0, s38
  s_add_u32 m0, s39, 49152
  v_mfma_f32_16x16x32_bf16 v[252:255], a[176:179], a[124:127], v[252:255]
  buffer_load_dwordx4 v18, s[4:7], s38 offen lds
  s_add_u32 m0, s39, 50176
  s_nop 0
  buffer_load_dwordx4 v19, s[4:7], s38 offen lds
  v_mov_b32 v48, 0xc0135761
  v_mov_b32 v49, 0xc0135761
  v_mov_b32 v50, 0xbdd2d3e8
  v_mov_b32 v51, 0xbdd2d3e8
  v_mov_b32 v52, 1.0
  v_mov_b32 v53, 1.0
  v_and_b32 v25, 15, v17
  v_bfe_u32 v26, v17, 4, 1
  v_lshrrev_b32 v23, 5, v17
  v_lshlrev_b32 v23, 8, v23
  v_lshl_add_u32 v23, v25, 4, v23
  v_lshl_add_u32 v22, v26, 9, v23
  v_lshl_add_u32 v23, v26, 10, v23
  v_add_u32 v24, 0x1000, v22
  s_lshl_b32 s71, s29, 5
  s_lshr_b32 s3, s30, 1
  s_lshl_b32 s35, s3, 4
  s_add_u32 s71, s71, s35
  s_lshr_b32 s35, s28, 4
  s_add_u32 s71, s71, s35
  s_lshl_b32 s71, s71, 11
  s_and_b32 s35, s30, 1
  s_lshl_b32 s35, s35, 7
  s_add_u32 s71, s71, s35
  s_and_b32 s35, s28, 15
  s_lshl_b32 s35, s35, 3
  s_add_u32 s71, s71, s35
  s_lshl_b32 s3, s3, 7
  v_lshlrev_b32 v0, 3, v25
  v_add_u32 v0, s3, v0
  s_lshl_b32 s3, s30, 3
  s_add_u32 s98, s98, s3
  v_pk_mul_f32 v[56:57], v[208:209], v[208:209]
  v_pk_fma_f32 v[56:57], v[56:57], v[50:51], v[48:49]
  v_pk_mul_f32 v[56:57], v[56:57], v[208:209]
  v_exp_f32 v56, v56
  v_pk_mul_f32 v[58:59], v[210:211], v[210:211]
  v_pk_fma_f32 v[58:59], v[58:59], v[50:51], v[48:49]
  v_exp_f32 v57, v57
  v_pk_mul_f32 v[58:59], v[58:59], v[210:211]
  v_pk_mul_f32 v[60:61], v[224:225], v[224:225]
  v_exp_f32 v58, v58
  v_pk_fma_f32 v[60:61], v[60:61], v[50:51], v[48:49]
  v_pk_mul_f32 v[60:61], v[60:61], v[224:225]
  v_exp_f32 v59, v59
  v_pk_mul_f32 v[62:63], v[226:227], v[226:227]
  v_pk_fma_f32 v[62:63], v[62:63], v[50:51], v[48:49]
  v_exp_f32 v60, v60
  v_pk_mul_f32 v[62:63], v[62:63], v[226:227]
  v_pk_add_f32 v[56:57], v[56:57], v[52:53]
  v_exp_f32 v61, v61
  v_pk_add_f32 v[58:59], v[58:59], v[52:53]
  v_exp_f32 v62, v62
  v_rcp_f32 v56, v56
  v_exp_f32 v63, v63
  v_pk_add_f32 v[60:61], v[60:61], v[52:53]
  v_rcp_f32 v57, v57
  v_rcp_f32 v58, v58
  v_pk_add_f32 v[62:63], v[62:63], v[52:53]
  v_rcp_f32 v59, v59
  v_pk_mul_f32 v[56:57], v[56:57], v[208:209]
  v_rcp_f32 v60, v60
  v_pk_mul_f32 v[58:59], v[58:59], v[210:211]
  v_rcp_f32 v61, v61
  v_cvt_pk_bf16_f32 v208, v56, v57
  v_rcp_f32 v62, v62
  v_pk_mul_f32 v[60:61], v[60:61], v[224:225]
  v_rcp_f32 v63, v63
  v_cvt_pk_bf16_f32 v209, v58, v59
  v_cvt_pk_bf16_f32 v210, v60, v61
  v_pk_mul_f32 v[62:63], v[62:63], v[226:227]
  v_cvt_pk_bf16_f32 v211, v62, v63
  v_pk_mul_f32 v[56:57], v[212:213], v[212:213]
  v_pk_fma_f32 v[56:57], v[56:57], v[50:51], v[48:49]
  v_pk_mul_f32 v[56:57], v[56:57], v[212:213]
  v_exp_f32 v56, v56
  v_pk_mul_f32 v[58:59], v[214:215], v[214:215]
  v_pk_fma_f32 v[58:59], v[58:59], v[50:51], v[48:49]
  v_exp_f32 v57, v57
  v_pk_mul_f32 v[58:59], v[58:59], v[214:215]
  v_pk_mul_f32 v[60:61], v[228:229], v[228:229]
  v_exp_f32 v58, v58
  v_pk_fma_f32 v[60:61], v[60:61], v[50:51], v[48:49]
  v_pk_mul_f32 v[60:61], v[60:61], v[228:229]
  v_exp_f32 v59, v59
  v_pk_mul_f32 v[62:63], v[230:231], v[230:231]
  v_pk_fma_f32 v[62:63], v[62:63], v[50:51], v[48:49]
  v_exp_f32 v60, v60
  v_pk_mul_f32 v[62:63], v[62:63], v[230:231]
  v_pk_add_f32 v[56:57], v[56:57], v[52:53]
  v_exp_f32 v61, v61
  v_pk_add_f32 v[58:59], v[58:59], v[52:53]
  v_exp_f32 v62, v62
  v_rcp_f32 v56, v56
  v_exp_f32 v63, v63
  v_pk_add_f32 v[60:61], v[60:61], v[52:53]
  v_rcp_f32 v57, v57
  v_rcp_f32 v58, v58
  v_pk_add_f32 v[62:63], v[62:63], v[52:53]
  v_rcp_f32 v59, v59
  v_pk_mul_f32 v[56:57], v[56:57], v[212:213]
  v_rcp_f32 v60, v60
  v_pk_mul_f32 v[58:59], v[58:59], v[214:215]
  v_rcp_f32 v61, v61
  v_cvt_pk_bf16_f32 v212, v56, v57
  v_rcp_f32 v62, v62
  v_pk_mul_f32 v[60:61], v[60:61], v[228:229]
  v_rcp_f32 v63, v63
  v_cvt_pk_bf16_f32 v213, v58, v59
  v_cvt_pk_bf16_f32 v214, v60, v61
  v_pk_mul_f32 v[62:63], v[62:63], v[230:231]
  v_cvt_pk_bf16_f32 v215, v62, v63
  v_permlane16_swap_b32 v208, v210
  v_permlane16_swap_b32 v209, v211
  buffer_store_dwordx4 v[208:211], v24, s[20:23], s16 offen offset:0 sc1
  v_pk_mul_f32 v[56:57], v[216:217], v[216:217]
  v_pk_fma_f32 v[56:57], v[56:57], v[50:51], v[48:49]
  v_pk_mul_f32 v[56:57], v[56:57], v[216:217]
  v_exp_f32 v56, v56
  v_pk_mul_f32 v[58:59], v[218:219], v[218:219]
  v_pk_fma_f32 v[58:59], v[58:59], v[50:51], v[48:49]
  v_exp_f32 v57, v57
  v_pk_mul_f32 v[58:59], v[58:59], v[218:219]
  v_pk_mul_f32 v[60:61], v[232:233], v[232:233]
  v_exp_f32 v58, v58
  v_pk_fma_f32 v[60:61], v[60:61], v[50:51], v[48:49]
  v_pk_mul_f32 v[60:61], v[60:61], v[232:233]
  v_exp_f32 v59, v59
  v_pk_mul_f32 v[62:63], v[234:235], v[234:235]
  v_pk_fma_f32 v[62:63], v[62:63], v[50:51], v[48:49]
  v_exp_f32 v60, v60
  v_pk_mul_f32 v[62:63], v[62:63], v[234:235]
  v_pk_add_f32 v[56:57], v[56:57], v[52:53]
  v_exp_f32 v61, v61
  v_pk_add_f32 v[58:59], v[58:59], v[52:53]
  v_exp_f32 v62, v62
  v_rcp_f32 v56, v56
  v_exp_f32 v63, v63
  v_pk_add_f32 v[60:61], v[60:61], v[52:53]
  v_rcp_f32 v57, v57
  v_rcp_f32 v58, v58
  v_pk_add_f32 v[62:63], v[62:63], v[52:53]
  v_rcp_f32 v59, v59
  v_pk_mul_f32 v[56:57], v[56:57], v[216:217]
  v_rcp_f32 v60, v60
  v_pk_mul_f32 v[58:59], v[58:59], v[218:219]
  v_rcp_f32 v61, v61
  v_cvt_pk_bf16_f32 v216, v56, v57
  v_rcp_f32 v62, v62
  v_pk_mul_f32 v[60:61], v[60:61], v[232:233]
  v_rcp_f32 v63, v63
  v_cvt_pk_bf16_f32 v217, v58, v59
  v_cvt_pk_bf16_f32 v218, v60, v61
  v_pk_mul_f32 v[62:63], v[62:63], v[234:235]
  v_cvt_pk_bf16_f32 v219, v62, v63
  v_permlane16_swap_b32 v212, v214
  v_permlane16_swap_b32 v213, v215
  buffer_store_dwordx4 v[212:215], v24, s[20:23], s16 offen offset:1024 sc1
  v_pk_mul_f32 v[56:57], v[220:221], v[220:221]
  v_pk_fma_f32 v[56:57], v[56:57], v[50:51], v[48:49]
  v_pk_mul_f32 v[56:57], v[56:57], v[220:221]
  v_exp_f32 v56, v56
  v_pk_mul_f32 v[58:59], v[222:223], v[222:223]
  v_pk_fma_f32 v[58:59], v[58:59], v[50:51], v[48:49]
  v_exp_f32 v57, v57
  v_pk_mul_f32 v[58:59], v[58:59], v[222:223]
  v_pk_mul_f32 v[60:61], v[236:237], v[236:237]
  v_exp_f32 v58, v58
  v_pk_fma_f32 v[60:61], v[60:61], v[50:51], v[48:49]
  v_pk_mul_f32 v[60:61], v[60:61], v[236:237]
  v_exp_f32 v59, v59
  v_pk_mul_f32 v[62:63], v[238:239], v[238:239]
  v_pk_fma_f32 v[62:63], v[62:63], v[50:51], v[48:49]
  v_exp_f32 v60, v60
  v_pk_mul_f32 v[62:63], v[62:63], v[238:239]
  v_pk_add_f32 v[56:57], v[56:57], v[52:53]
  v_exp_f32 v61, v61
  v_pk_add_f32 v[58:59], v[58:59], v[52:53]
  v_exp_f32 v62, v62
  v_rcp_f32 v56, v56
  v_exp_f32 v63, v63
  v_pk_add_f32 v[60:61], v[60:61], v[52:53]
  v_rcp_f32 v57, v57
  v_rcp_f32 v58, v58
  v_pk_add_f32 v[62:63], v[62:63], v[52:53]
  v_rcp_f32 v59, v59
  v_pk_mul_f32 v[56:57], v[56:57], v[220:221]
  v_rcp_f32 v60, v60
  v_pk_mul_f32 v[58:59], v[58:59], v[222:223]
  v_rcp_f32 v61, v61
  v_cvt_pk_bf16_f32 v220, v56, v57
  v_rcp_f32 v62, v62
  v_pk_mul_f32 v[60:61], v[60:61], v[236:237]
  v_rcp_f32 v63, v63
  v_cvt_pk_bf16_f32 v221, v58, v59
  v_cvt_pk_bf16_f32 v222, v60, v61
  v_pk_mul_f32 v[62:63], v[62:63], v[238:239]
  v_cvt_pk_bf16_f32 v223, v62, v63
  v_permlane16_swap_b32 v216, v218
  v_permlane16_swap_b32 v217, v219
  buffer_store_dwordx4 v[216:219], v24, s[20:23], s17 offen offset:0 sc1
  v_pk_mul_f32 v[56:57], v[144:145], v[144:145]
  v_pk_fma_f32 v[56:57], v[56:57], v[50:51], v[48:49]
  v_pk_mul_f32 v[56:57], v[56:57], v[144:145]
  v_exp_f32 v56, v56
  v_pk_mul_f32 v[58:59], v[146:147], v[146:147]
  v_pk_fma_f32 v[58:59], v[58:59], v[50:51], v[48:49]
  v_exp_f32 v57, v57
  v_pk_mul_f32 v[58:59], v[58:59], v[146:147]
  v_pk_mul_f32 v[60:61], v[160:161], v[160:161]
  v_exp_f32 v58, v58
  v_pk_fma_f32 v[60:61], v[60:61], v[50:51], v[48:49]
  v_pk_mul_f32 v[60:61], v[60:61], v[160:161]
  v_exp_f32 v59, v59
  v_pk_mul_f32 v[62:63], v[162:163], v[162:163]
  v_pk_fma_f32 v[62:63], v[62:63], v[50:51], v[48:49]
  v_exp_f32 v60, v60
  v_pk_mul_f32 v[62:63], v[62:63], v[162:163]
  v_pk_add_f32 v[56:57], v[56:57], v[52:53]
  v_exp_f32 v61, v61
  v_pk_add_f32 v[58:59], v[58:59], v[52:53]
  v_exp_f32 v62, v62
  v_rcp_f32 v56, v56
  v_exp_f32 v63, v63
  v_pk_add_f32 v[60:61], v[60:61], v[52:53]
  v_rcp_f32 v57, v57
  v_rcp_f32 v58, v58
  v_pk_add_f32 v[62:63], v[62:63], v[52:53]
  v_rcp_f32 v59, v59
  v_pk_mul_f32 v[56:57], v[56:57], v[144:145]
  v_rcp_f32 v60, v60
  v_pk_mul_f32 v[58:59], v[58:59], v[146:147]
  v_rcp_f32 v61, v61
  v_cvt_pk_bf16_f32 v144, v56, v57
  v_rcp_f32 v62, v62
  v_pk_mul_f32 v[60:61], v[60:61], v[160:161]
  v_rcp_f32 v63, v63
  v_cvt_pk_bf16_f32 v145, v58, v59
  v_cvt_pk_bf16_f32 v146, v60, v61
  v_pk_mul_f32 v[62:63], v[62:63], v[162:163]
  v_cvt_pk_bf16_f32 v147, v62, v63
  v_permlane16_swap_b32 v220, v222
  v_permlane16_swap_b32 v221, v223
  buffer_store_dwordx4 v[220:223], v24, s[20:23], s17 offen offset:1024 sc1
  v_pk_mul_f32 v[56:57], v[148:149], v[148:149]
  v_pk_fma_f32 v[56:57], v[56:57], v[50:51], v[48:49]
  v_pk_mul_f32 v[56:57], v[56:57], v[148:149]
  v_exp_f32 v56, v56
  v_pk_mul_f32 v[58:59], v[150:151], v[150:151]
  v_pk_fma_f32 v[58:59], v[58:59], v[50:51], v[48:49]
  v_exp_f32 v57, v57
  v_pk_mul_f32 v[58:59], v[58:59], v[150:151]
  v_pk_mul_f32 v[60:61], v[164:165], v[164:165]
  v_exp_f32 v58, v58
  v_pk_fma_f32 v[60:61], v[60:61], v[50:51], v[48:49]
  v_pk_mul_f32 v[60:61], v[60:61], v[164:165]
  v_exp_f32 v59, v59
  v_pk_mul_f32 v[62:63], v[166:167], v[166:167]
  v_pk_fma_f32 v[62:63], v[62:63], v[50:51], v[48:49]
  v_exp_f32 v60, v60
  v_pk_mul_f32 v[62:63], v[62:63], v[166:167]
  v_pk_add_f32 v[56:57], v[56:57], v[52:53]
  v_exp_f32 v61, v61
  v_pk_add_f32 v[58:59], v[58:59], v[52:53]
  v_exp_f32 v62, v62
  v_rcp_f32 v56, v56
  v_exp_f32 v63, v63
  v_pk_add_f32 v[60:61], v[60:61], v[52:53]
  v_rcp_f32 v57, v57
  v_rcp_f32 v58, v58
  v_pk_add_f32 v[62:63], v[62:63], v[52:53]
  v_rcp_f32 v59, v59
  v_pk_mul_f32 v[56:57], v[56:57], v[148:149]
  v_rcp_f32 v60, v60
  v_pk_mul_f32 v[58:59], v[58:59], v[150:151]
  v_rcp_f32 v61, v61
  v_cvt_pk_bf16_f32 v148, v56, v57
  v_rcp_f32 v62, v62
  v_pk_mul_f32 v[60:61], v[60:61], v[164:165]
  v_rcp_f32 v63, v63
  v_cvt_pk_bf16_f32 v149, v58, v59
  v_cvt_pk_bf16_f32 v150, v60, v61
  v_pk_mul_f32 v[62:63], v[62:63], v[166:167]
  v_cvt_pk_bf16_f32 v151, v62, v63
  v_permlane16_swap_b32 v144, v146
  v_permlane16_swap_b32 v145, v147
  buffer_store_dwordx4 v[144:147], v22, s[20:23], s16 offen offset:0 sc1
  s_add_u32 s35, s98, 65536
  v_mov_b32 v26, s46
  v_mov_b32 v27, s47
  s_waitcnt vmcnt(7)
  s_mov_b64 exec, 1
  buffer_store_dwordx2 v[26:27], off, s[72:75], s35 offset:1024 sc1
  s_mov_b64 exec, -1
  v_pk_mul_f32 v[56:57], v[152:153], v[152:153]
  v_pk_fma_f32 v[56:57], v[56:57], v[50:51], v[48:49]
  v_pk_mul_f32 v[56:57], v[56:57], v[152:153]
  v_exp_f32 v56, v56
  v_pk_mul_f32 v[58:59], v[154:155], v[154:155]
  v_pk_fma_f32 v[58:59], v[58:59], v[50:51], v[48:49]
  v_exp_f32 v57, v57
  v_pk_mul_f32 v[58:59], v[58:59], v[154:155]
  v_pk_mul_f32 v[60:61], v[168:169], v[168:169]
  v_exp_f32 v58, v58
  v_pk_fma_f32 v[60:61], v[60:61], v[50:51], v[48:49]
  v_pk_mul_f32 v[60:61], v[60:61], v[168:169]
  v_exp_f32 v59, v59
  v_pk_mul_f32 v[62:63], v[170:171], v[170:171]
  v_pk_fma_f32 v[62:63], v[62:63], v[50:51], v[48:49]
  v_exp_f32 v60, v60
  v_pk_mul_f32 v[62:63], v[62:63], v[170:171]
  v_pk_add_f32 v[56:57], v[56:57], v[52:53]
  v_exp_f32 v61, v61
  v_pk_add_f32 v[58:59], v[58:59], v[52:53]
  v_exp_f32 v62, v62
  v_rcp_f32 v56, v56
  v_exp_f32 v63, v63
  v_pk_add_f32 v[60:61], v[60:61], v[52:53]
  v_rcp_f32 v57, v57
  v_rcp_f32 v58, v58
  v_pk_add_f32 v[62:63], v[62:63], v[52:53]
  v_rcp_f32 v59, v59
  v_pk_mul_f32 v[56:57], v[56:57], v[152:153]
  v_rcp_f32 v60, v60
  v_pk_mul_f32 v[58:59], v[58:59], v[154:155]
  v_rcp_f32 v61, v61
  v_cvt_pk_bf16_f32 v152, v56, v57
  v_rcp_f32 v62, v62
  v_pk_mul_f32 v[60:61], v[60:61], v[168:169]
  v_rcp_f32 v63, v63
  v_cvt_pk_bf16_f32 v153, v58, v59
  v_cvt_pk_bf16_f32 v154, v60, v61
  v_pk_mul_f32 v[62:63], v[62:63], v[170:171]
  v_cvt_pk_bf16_f32 v155, v62, v63
  v_permlane16_swap_b32 v148, v150
  v_permlane16_swap_b32 v149, v151
  buffer_store_dwordx4 v[148:151], v22, s[20:23], s16 offen offset:1024 sc1
  v_pk_mul_f32 v[56:57], v[156:157], v[156:157]
  v_pk_fma_f32 v[56:57], v[56:57], v[50:51], v[48:49]
  v_pk_mul_f32 v[56:57], v[56:57], v[156:157]
  v_exp_f32 v56, v56
  v_pk_mul_f32 v[58:59], v[158:159], v[158:159]
  v_pk_fma_f32 v[58:59], v[58:59], v[50:51], v[48:49]
  v_exp_f32 v57, v57
  v_pk_mul_f32 v[58:59], v[58:59], v[158:159]
  v_pk_mul_f32 v[60:61], v[172:173], v[172:173]
  v_exp_f32 v58, v58
  v_pk_fma_f32 v[60:61], v[60:61], v[50:51], v[48:49]
  v_pk_mul_f32 v[60:61], v[60:61], v[172:173]
  v_exp_f32 v59, v59
  v_pk_mul_f32 v[62:63], v[174:175], v[174:175]
  v_pk_fma_f32 v[62:63], v[62:63], v[50:51], v[48:49]
  v_exp_f32 v60, v60
  v_pk_mul_f32 v[62:63], v[62:63], v[174:175]
  v_pk_add_f32 v[56:57], v[56:57], v[52:53]
  v_exp_f32 v61, v61
  v_pk_add_f32 v[58:59], v[58:59], v[52:53]
  v_exp_f32 v62, v62
  v_rcp_f32 v56, v56
  v_exp_f32 v63, v63
  v_pk_add_f32 v[60:61], v[60:61], v[52:53]
  v_rcp_f32 v57, v57
  v_rcp_f32 v58, v58
  v_pk_add_f32 v[62:63], v[62:63], v[52:53]
  v_rcp_f32 v59, v59
  v_pk_mul_f32 v[56:57], v[56:57], v[156:157]
  v_rcp_f32 v60, v60
  v_pk_mul_f32 v[58:59], v[58:59], v[158:159]
  v_rcp_f32 v61, v61
  v_cvt_pk_bf16_f32 v156, v56, v57
  v_rcp_f32 v62, v62
  v_pk_mul_f32 v[60:61], v[60:61], v[172:173]
  v_rcp_f32 v63, v63
  v_cvt_pk_bf16_f32 v157, v58, v59
  v_cvt_pk_bf16_f32 v158, v60, v61
  v_pk_mul_f32 v[62:63], v[62:63], v[174:175]
  v_cvt_pk_bf16_f32 v159, v62, v63
  v_permlane16_swap_b32 v152, v154
  v_permlane16_swap_b32 v153, v155
  v_pk_mul_f32 v[56:57], v[176:177], v[176:177]
  v_pk_fma_f32 v[56:57], v[56:57], v[50:51], v[48:49]
  v_pk_mul_f32 v[56:57], v[56:57], v[176:177]
  v_exp_f32 v56, v56
  v_pk_mul_f32 v[58:59], v[178:179], v[178:179]
  v_pk_fma_f32 v[58:59], v[58:59], v[50:51], v[48:49]
  v_exp_f32 v57, v57
  v_pk_mul_f32 v[58:59], v[58:59], v[178:179]
  v_pk_mul_f32 v[60:61], v[192:193], v[192:193]
  v_exp_f32 v58, v58
  v_pk_fma_f32 v[60:61], v[60:61], v[50:51], v[48:49]
  v_pk_mul_f32 v[60:61], v[60:61], v[192:193]
  v_exp_f32 v59, v59
  v_pk_mul_f32 v[62:63], v[194:195], v[194:195]
  v_pk_fma_f32 v[62:63], v[62:63], v[50:51], v[48:49]
  v_exp_f32 v60, v60
  v_pk_mul_f32 v[62:63], v[62:63], v[194:195]
  v_pk_add_f32 v[56:57], v[56:57], v[52:53]
  v_exp_f32 v61, v61
  v_pk_add_f32 v[58:59], v[58:59], v[52:53]
  v_exp_f32 v62, v62
  v_rcp_f32 v56, v56
  v_exp_f32 v63, v63
  v_pk_add_f32 v[60:61], v[60:61], v[52:53]
  v_rcp_f32 v57, v57
  v_rcp_f32 v58, v58
  v_pk_add_f32 v[62:63], v[62:63], v[52:53]
  v_rcp_f32 v59, v59
  v_pk_mul_f32 v[56:57], v[56:57], v[176:177]
  v_rcp_f32 v60, v60
  v_pk_mul_f32 v[58:59], v[58:59], v[178:179]
  v_rcp_f32 v61, v61
  v_cvt_pk_bf16_f32 v176, v56, v57
  v_rcp_f32 v62, v62
  v_pk_mul_f32 v[60:61], v[60:61], v[192:193]
  v_rcp_f32 v63, v63
  v_cvt_pk_bf16_f32 v177, v58, v59
  v_cvt_pk_bf16_f32 v178, v60, v61
  v_pk_mul_f32 v[62:63], v[62:63], v[194:195]
  v_cvt_pk_bf16_f32 v179, v62, v63
  v_permlane16_swap_b32 v156, v158
  v_permlane16_swap_b32 v157, v159
  buffer_load_dwordx2 v[26:27], off, s[72:75], s98 offset:1024 sc1
  s_sub_u32 s31, s31, 16384
  s_sub_u32 s32, s32, 16384
  s_cmp_eq_u32 s29, 0
  s_cselect_b32 s31, 0x40000000, s31
  s_cselect_b32 s32, 0x40000000, s32
  v_pk_mul_f32 v[56:57], v[180:181], v[180:181]
  v_pk_fma_f32 v[56:57], v[56:57], v[50:51], v[48:49]
  v_pk_mul_f32 v[56:57], v[56:57], v[180:181]
  v_exp_f32 v56, v56
  v_pk_mul_f32 v[58:59], v[182:183], v[182:183]
  v_pk_fma_f32 v[58:59], v[58:59], v[50:51], v[48:49]
  v_exp_f32 v57, v57
  v_pk_mul_f32 v[58:59], v[58:59], v[182:183]
  v_pk_mul_f32 v[60:61], v[196:197], v[196:197]
  v_exp_f32 v58, v58
  v_pk_fma_f32 v[60:61], v[60:61], v[50:51], v[48:49]
  v_pk_mul_f32 v[60:61], v[60:61], v[196:197]
  v_exp_f32 v59, v59
  v_pk_mul_f32 v[62:63], v[198:199], v[198:199]
  v_pk_fma_f32 v[62:63], v[62:63], v[50:51], v[48:49]
  v_exp_f32 v60, v60
  v_pk_mul_f32 v[62:63], v[62:63], v[198:199]
  v_pk_add_f32 v[56:57], v[56:57], v[52:53]
  v_exp_f32 v61, v61
  v_pk_add_f32 v[58:59], v[58:59], v[52:53]
  v_exp_f32 v62, v62
  v_rcp_f32 v56, v56
  v_exp_f32 v63, v63
  v_pk_add_f32 v[60:61], v[60:61], v[52:53]
  v_rcp_f32 v57, v57
  v_rcp_f32 v58, v58
  v_pk_add_f32 v[62:63], v[62:63], v[52:53]
  v_rcp_f32 v59, v59
  v_pk_mul_f32 v[56:57], v[56:57], v[180:181]
  v_rcp_f32 v60, v60
  v_pk_mul_f32 v[58:59], v[58:59], v[182:183]
  v_rcp_f32 v61, v61
  v_cvt_pk_bf16_f32 v180, v56, v57
  v_rcp_f32 v62, v62
  v_pk_mul_f32 v[60:61], v[60:61], v[196:197]
  v_rcp_f32 v63, v63
  v_cvt_pk_bf16_f32 v181, v58, v59
  v_cvt_pk_bf16_f32 v182, v60, v61
  v_pk_mul_f32 v[62:63], v[62:63], v[198:199]
  v_cvt_pk_bf16_f32 v183, v62, v63
  v_permlane16_swap_b32 v176, v178
  v_permlane16_swap_b32 v177, v179
  v_pk_mul_f32 v[56:57], v[184:185], v[184:185]
  v_pk_fma_f32 v[56:57], v[56:57], v[50:51], v[48:49]
  v_pk_mul_f32 v[56:57], v[56:57], v[184:185]
  v_exp_f32 v56, v56
  v_pk_mul_f32 v[58:59], v[186:187], v[186:187]
  v_pk_fma_f32 v[58:59], v[58:59], v[50:51], v[48:49]
  v_exp_f32 v57, v57
  v_pk_mul_f32 v[58:59], v[58:59], v[186:187]
  v_pk_mul_f32 v[60:61], v[200:201], v[200:201]
  v_exp_f32 v58, v58
  v_pk_fma_f32 v[60:61], v[60:61], v[50:51], v[48:49]
  v_pk_mul_f32 v[60:61], v[60:61], v[200:201]
  v_exp_f32 v59, v59
  v_pk_mul_f32 v[62:63], v[202:203], v[202:203]
  v_pk_fma_f32 v[62:63], v[62:63], v[50:51], v[48:49]
  v_exp_f32 v60, v60
  v_pk_mul_f32 v[62:63], v[62:63], v[202:203]
  v_pk_add_f32 v[56:57], v[56:57], v[52:53]
  v_exp_f32 v61, v61
  v_pk_add_f32 v[58:59], v[58:59], v[52:53]
  v_exp_f32 v62, v62
  v_rcp_f32 v56, v56
  v_exp_f32 v63, v63
  v_pk_add_f32 v[60:61], v[60:61], v[52:53]
  v_rcp_f32 v57, v57
  v_rcp_f32 v58, v58
  v_pk_add_f32 v[62:63], v[62:63], v[52:53]
  v_rcp_f32 v59, v59
  v_pk_mul_f32 v[56:57], v[56:57], v[184:185]
  v_rcp_f32 v60, v60
  v_pk_mul_f32 v[58:59], v[58:59], v[186:187]
  v_rcp_f32 v61, v61
  v_cvt_pk_bf16_f32 v184, v56, v57
  v_rcp_f32 v62, v62
  v_pk_mul_f32 v[60:61], v[60:61], v[200:201]
  v_rcp_f32 v63, v63
  v_cvt_pk_bf16_f32 v185, v58, v59
  v_cvt_pk_bf16_f32 v186, v60, v61
  v_pk_mul_f32 v[62:63], v[62:63], v[202:203]
  v_cvt_pk_bf16_f32 v187, v62, v63
  v_permlane16_swap_b32 v180, v182
  v_permlane16_swap_b32 v181, v183
  s_waitcnt vmcnt(0)
  s_cmp_eq_u32 s29, 0
  s_cbranch_scc1 L_nokv28
  v_cmp_eq_u64 vcc, s[46:47], v[26:27]
  s_cmp_eq_u64 vcc, exec
  s_cbranch_scc1 L_polld30
  s_mov_b32 s63, 0x40000
L_poll29:
  buffer_load_dwordx2 v[26:27], off, s[72:75], s98 offset:1024 sc1
  s_waitcnt vmcnt(0)
  v_cmp_eq_u64 vcc, s[46:47], v[26:27]
  s_cmp_eq_u64 vcc, exec
  s_cbranch_scc1 L_polld30
  s_sleep 1
  s_sub_u32 s63, s63, 1
  s_cmp_lg_u32 s63, 0
  s_cbranch_scc1 L_poll29
L_polld30:
L_nokv28:
  buffer_load_dwordx4 a[224:227], v1, s[20:23], s31 offen offset:0 sc1
  buffer_load_dwordx4 a[228:231], v1, s[20:23], s31 offen offset:1024 sc1
  buffer_load_dwordx4 a[232:235], v1, s[20:23], s31 offen offset:2048 sc1
  buffer_load_dwordx4 a[236:239], v1, s[20:23], s31 offen offset:3072 sc1
  buffer_load_dwordx4 a[240:243], v1, s[20:23], s32 offen offset:0 sc1
  buffer_load_dwordx4 a[244:247], v1, s[20:23], s32 offen offset:1024 sc1
  buffer_load_dwordx4 a[248:251], v1, s[20:23], s32 offen offset:2048 sc1
  buffer_load_dwordx4 a[252:255], v1, s[20:23], s32 offen offset:3072 sc1
  buffer_store_dwordx4 v[152:155], v22, s[20:23], s17 offen offset:0 sc1
  buffer_store_dwordx4 v[156:159], v22, s[20:23], s17 offen offset:1024 sc1
  v_pk_mul_f32 v[56:57], v[188:189], v[188:189]
  v_pk_fma_f32 v[56:57], v[56:57], v[50:51], v[48:49]
  v_pk_mul_f32 v[56:57], v[56:57], v[188:189]
  v_exp_f32 v56, v56
  v_pk_mul_f32 v[58:59], v[190:191], v[190:191]
  v_pk_fma_f32 v[58:59], v[58:59], v[50:51], v[48:49]
  v_exp_f32 v57, v57
  v_pk_mul_f32 v[58:59], v[58:59], v[190:191]
  v_pk_mul_f32 v[60:61], v[204:205], v[204:205]
  v_exp_f32 v58, v58
  v_pk_fma_f32 v[60:61], v[60:61], v[50:51], v[48:49]
  v_pk_mul_f32 v[60:61], v[60:61], v[204:205]
  v_exp_f32 v59, v59
  v_pk_mul_f32 v[62:63], v[206:207], v[206:207]
  v_pk_fma_f32 v[62:63], v[62:63], v[50:51], v[48:49]
  v_exp_f32 v60, v60
  v_pk_mul_f32 v[62:63], v[62:63], v[206:207]
  v_pk_add_f32 v[56:57], v[56:57], v[52:53]
  v_exp_f32 v61, v61
  v_pk_add_f32 v[58:59], v[58:59], v[52:53]
  v_exp_f32 v62, v62
  v_rcp_f32 v56, v56
  v_exp_f32 v63, v63
  v_pk_add_f32 v[60:61], v[60:61], v[52:53]
  v_rcp_f32 v57, v57
  v_rcp_f32 v58, v58
  v_pk_add_f32 v[62:63], v[62:63], v[52:53]
  v_rcp_f32 v59, v59
  v_pk_mul_f32 v[56:57], v[56:57], v[188:189]
  v_rcp_f32 v60, v60
  v_pk_mul_f32 v[58:59], v[58:59], v[190:191]
  v_rcp_f32 v61, v61
  v_cvt_pk_bf16_f32 v188, v56, v57
  v_rcp_f32 v62, v62
  v_pk_mul_f32 v[60:61], v[60:61], v[204:205]
  v_rcp_f32 v63, v63
  v_cvt_pk_bf16_f32 v189, v58, v59
  v_cvt_pk_bf16_f32 v190, v60, v61
  v_pk_mul_f32 v[62:63], v[62:63], v[206:207]
  v_cvt_pk_bf16_f32 v191, v62, v63
  v_permlane16_swap_b32 v184, v186
  v_permlane16_swap_b32 v185, v187
  v_pk_mul_f32 v[56:57], v[240:241], v[240:241]
  v_pk_fma_f32 v[56:57], v[56:57], v[50:51], v[48:49]
  v_pk_mul_f32 v[56:57], v[56:57], v[240:241]
  v_exp_f32 v56, v56
  v_pk_mul_f32 v[58:59], v[242:243], v[242:243]
  v_pk_fma_f32 v[58:59], v[58:59], v[50:51], v[48:49]
  v_exp_f32 v57, v57
  v_pk_mul_f32 v[58:59], v[58:59], v[242:243]
  v_pk_mul_f32 v[60:61], v[244:245], v[244:245]
  v_exp_f32 v58, v58
  v_pk_fma_f32 v[60:61], v[60:61], v[50:51], v[48:49]
  v_pk_mul_f32 v[60:61], v[60:61], v[244:245]
  v_exp_f32 v59, v59
  v_pk_mul_f32 v[62:63], v[246:247], v[246:247]
  v_pk_fma_f32 v[62:63], v[62:63], v[50:51], v[48:49]
  v_exp_f32 v60, v60
  v_pk_mul_f32 v[62:63], v[62:63], v[246:247]
  v_pk_add_f32 v[56:57], v[56:57], v[52:53]
  v_exp_f32 v61, v61
  v_pk_add_f32 v[58:59], v[58:59], v[52:53]
  v_exp_f32 v62, v62
  v_rcp_f32 v56, v56
  v_exp_f32 v63, v63
  v_pk_add_f32 v[60:61], v[60:61], v[52:53]
  v_rcp_f32 v57, v57
  v_rcp_f32 v58, v58
  v_pk_add_f32 v[62:63], v[62:63], v[52:53]
  v_rcp_f32 v59, v59
  v_pk_mul_f32 v[56:57], v[56:57], v[240:241]
  v_rcp_f32 v60, v60
  v_pk_mul_f32 v[58:59], v[58:59], v[242:243]
  v_rcp_f32 v61, v61
  v_cvt_pk_bf16_f32 v240, v56, v57
  v_rcp_f32 v62, v62
  v_pk_mul_f32 v[60:61], v[60:61], v[244:245]
  v_rcp_f32 v63, v63
  v_cvt_pk_bf16_f32 v241, v58, v59
  v_cvt_pk_bf16_f32 v242, v60, v61
  v_pk_mul_f32 v[62:63], v[62:63], v[246:247]
  v_cvt_pk_bf16_f32 v243, v62, v63
  v_permlane16_swap_b32 v188, v190
  v_permlane16_swap_b32 v189, v191
  v_pk_mul_f32 v[56:57], v[248:249], v[248:249]
  v_pk_fma_f32 v[56:57], v[56:57], v[50:51], v[48:49]
  v_pk_mul_f32 v[56:57], v[56:57], v[248:249]
  v_exp_f32 v56, v56
  v_pk_mul_f32 v[58:59], v[250:251], v[250:251]
  v_pk_fma_f32 v[58:59], v[58:59], v[50:51], v[48:49]
  v_exp_f32 v57, v57
  v_pk_mul_f32 v[58:59], v[58:59], v[250:251]
  v_pk_mul_f32 v[60:61], v[252:253], v[252:253]
  v_exp_f32 v58, v58
  v_pk_fma_f32 v[60:61], v[60:61], v[50:51], v[48:49]
  v_pk_mul_f32 v[60:61], v[60:61], v[252:253]
  v_exp_f32 v59, v59
  v_pk_mul_f32 v[62:63], v[254:255], v[254:255]
  v_pk_fma_f32 v[62:63], v[62:63], v[50:51], v[48:49]
  v_exp_f32 v60, v60
  v_pk_mul_f32 v[62:63], v[62:63], v[254:255]
  v_pk_add_f32 v[56:57], v[56:57], v[52:53]
  v_exp_f32 v61, v61
  v_pk_add_f32 v[58:59], v[58:59], v[52:53]
  v_exp_f32 v62, v62
  v_rcp_f32 v56, v56
  v_exp_f32 v63, v63
  v_pk_add_f32 v[60:61], v[60:61], v[52:53]
  v_rcp_f32 v57, v57
  v_rcp_f32 v58, v58
  v_pk_add_f32 v[62:63], v[62:63], v[52:53]
  v_rcp_f32 v59, v59
  v_pk_mul_f32 v[56:57], v[56:57], v[248:249]
  v_rcp_f32 v60, v60
  v_pk_mul_f32 v[58:59], v[58:59], v[250:251]
  v_rcp_f32 v61, v61
  v_cvt_pk_bf16_f32 v248, v56, v57
  v_rcp_f32 v62, v62
  v_pk_mul_f32 v[60:61], v[60:61], v[252:253]
  v_rcp_f32 v63, v63
  v_cvt_pk_bf16_f32 v249, v58, v59
  v_cvt_pk_bf16_f32 v250, v60, v61
  v_pk_mul_f32 v[62:63], v[62:63], v[254:255]
  v_cvt_pk_bf16_f32 v251, v62, v63
  v_permlane16_swap_b32 v240, v242
  v_permlane16_swap_b32 v241, v243
  s_nop 0
  v_permlane16_swap_b32 v248, v250
  v_permlane16_swap_b32 v249, v251
  s_lshl_b32 s35, s29, 2
  s_add_u32 s35, s35, s30
  s_cmp_lt_u32 s35, 4
  s_cselect_b32 s3, 0xf149f2ca, 0
  v_mov_b32 v216, s3
  v_mov_b32 v217, s3
  v_mov_b32 v218, s3
  v_mov_b32 v219, s3
  s_cmp_lt_u32 s35, 3
  s_cselect_b32 s3, 0xf149f2ca, 0
  v_mov_b32 v220, s3
  v_mov_b32 v221, s3
  v_mov_b32 v222, s3
  v_mov_b32 v223, s3
  s_cmp_lt_u32 s35, 2
  s_cselect_b32 s3, 0xf149f2ca, 0
  v_mov_b32 v224, s3
  v_mov_b32 v225, s3
  v_mov_b32 v226, s3
  v_mov_b32 v227, s3
  s_cmp_lt_u32 s35, 1
  s_cselect_b32 s3, 0xf149f2ca, 0
  v_mov_b32 v228, s3
  v_mov_b32 v229, s3
  v_mov_b32 v230, s3
  v_mov_b32 v231, s3
  v_mov_b32 v4, 0xf149f2ca
  v_and_b32 v5, 15, v17
  v_lshrrev_b32 v6, 4, v17
  v_lshlrev_b32 v6, 2, v6
  v_add_u32 v7, 0, v6
  v_cmp_gt_u32 vcc, v7, v5
  s_nop 1
  v_cndmask_b32 v208, v4, v216, vcc
  v_cndmask_b32 v212, 0, v4, vcc
  v_add_u32 v7, 1, v6
  v_cmp_gt_u32 vcc, v7, v5
  s_nop 1
  v_cndmask_b32 v209, v4, v217, vcc
  v_cndmask_b32 v213, 0, v4, vcc
  v_add_u32 v7, 2, v6
  v_cmp_gt_u32 vcc, v7, v5
  s_nop 1
  v_cndmask_b32 v210, v4, v218, vcc
  v_cndmask_b32 v214, 0, v4, vcc
  v_add_u32 v7, 3, v6
  v_cmp_gt_u32 vcc, v7, v5
  s_nop 1
  v_cndmask_b32 v211, v4, v219, vcc
  v_cndmask_b32 v215, 0, v4, vcc
  v_mov_b32 v204, 0x3f803f80
  v_mov_b32 v205, 0x3f803f80
  v_mov_b32 v206, 0x3f803f80
  v_mov_b32 v207, 0x3f803f80
  s_lshl_b32 s3, s50, 2
  v_lshrrev_b32 v25, 4, v17
  v_bfe_u32 v26, v17, 2, 2
  v_lshl_add_u32 v27, v25, 3, v26
  v_lshlrev_b32 v27, 8, v27
  v_and_b32 v26, 3, v17
  v_lshl_add_u32 v27, v26, 3, v27
  v_bfe_u32 v26, v17, 2, 3
  v_xor_b32 v26, s3, v26
  v_xor_b32 v28, 0, v26
  v_lshl_add_u32 v10, v28, 5, v27
  v_xor_b32 v28, 1, v26
  v_lshl_add_u32 v11, v28, 5, v27
  v_xor_b32 v28, 2, v26
  v_lshl_add_u32 v12, v28, 5, v27
  v_xor_b32 v28, 3, v26
  v_lshl_add_u32 v13, v28, 5, v27
  v_lshlrev_b32 v14, 11, v5
  v_lshl_add_u32 v14, v25, 3, v14
  v_lshlrev_b32 v15, 3, v25
  v_lshlrev_b32 v16, 11, v5
  v_and_b32 v26, 1, v25
  v_lshl_add_u32 v16, v26, 5, v16
  v_lshrrev_b32 v26, 1, v25
  v_lshl_add_u32 v16, v26, 4, v16
  s_waitcnt vmcnt(2)
  ds_write_b128 v3, a[224:227] offset:0
  ds_write_b128 v3, a[228:231] offset:1024
  ds_write_b128 v3, a[232:235] offset:2048
  ds_write_b128 v3, a[236:239] offset:3072
  ds_write_b128 v3, a[240:243] offset:32768
  ds_write_b128 v3, a[244:247] offset:33792
  ds_write_b128 v3, a[248:251] offset:34816
  ds_write_b128 v3, a[252:255] offset:35840
  s_waitcnt lgkmcnt(0)
  s_barrier
  ds_read_b128 a[0:3], v3 offset:0
  ds_read_b128 a[4:7], v3 offset:1024
  ds_read_b128 a[8:11], v3 offset:2048
  ds_read_b128 a[12:15], v3 offset:3072
  ds_read_b128 a[16:19], v3 offset:4096
  ds_read_b128 a[20:23], v3 offset:5120
  ds_read_b128 a[24:27], v3 offset:6144
  ds_read_b128 a[28:31], v3 offset:7168
  ds_read_b128 a[32:35], v3 offset:8192
  ds_read_b128 a[36:39], v3 offset:9216
  ds_read_b128 a[40:43], v3 offset:10240
  ds_read_b128 a[44:47], v3 offset:11264
  ds_read_b128 a[48:51], v3 offset:12288
  ds_read_b128 a[52:55], v3 offset:13312
  ds_read_b128 a[56:59], v3 offset:14336
  ds_read_b128 a[60:63], v3 offset:15360
  ds_read_b128 a[64:67], v3 offset:16384
  ds_read_b128 a[68:71], v3 offset:17408
  ds_read_b128 a[72:75], v3 offset:18432
  ds_read_b128 a[76:79], v3 offset:19456
  s_mov_b32 s42, 0x3e8293ee
  s_mov_b32 s43, 0x3e8293ee
  s_lshl_b32 s3, s68, 2
  s_add_u32 s3, s3, s30
  s_mul_i32 s3, s3, 294912
  s_add_u32 s3, s3, 16777216
  s_mul_i32 s35, s50, 114688
  s_add_u32 s3, s3, s35
  s_add_u32 s8, s60, s3
  s_addc_u32 s9, s61, 0
  s_mov_b32 s10, 294912
  s_mov_b32 s11, 0x20000
  s_mul_i32 s35, s50, 81920
  s_sub_u32 s35, 229376, s35
  s_add_u32 s10, s35, 32768
  s_lshl_b32 s31, s76, 12
  s_mov_b32 s32, 0
  s_mov_b32 s12, s40
  s_mov_b32 s13, s41
  s_mov_b32 s14, 4194304
  s_mov_b32 s15, 0x20000
  s_mov_b32 s24, s54
  s_mov_b32 s25, s55
  s_mov_b32 s26, 2048
  s_mov_b32 s27, 0x20000
  s_lshl_b32 s3, s68, 18
  s_lshl_b32 s48, s30, 16
  s_add_u32 s48, s48, s3
  s_lshl_b32 s36, s69, 7
  s_add_u32 s48, s48, s36
  s_add_u32 s49, s48, 0x8000
  s_waitcnt lgkmcnt(3)
  v_mfma_f32_16x16x32_bf16 v[52:55], a[0:3], v[32:35], v[208:211]
  ds_read_b128 a[80:83], v3 offset:32768
  ds_read_b128 a[84:87], v3 offset:33792
  v_mfma_f32_16x16x32_bf16 v[56:59], a[4:7], v[32:35], v[216:219]
  ds_read_b128 a[88:91], v3 offset:34816
  v_mfma_f32_16x16x32_bf16 v[60:63], a[8:11], v[32:35], v[216:219]
  ds_read_b128 a[92:95], v3 offset:35840
  v_mfma_f32_16x16x32_bf16 v[64:67], a[12:15], v[32:35], v[216:219]
  ds_read_b128 a[96:99], v3 offset:36864
  v_mfma_f32_16x16x32_bf16 v[68:71], a[16:19], v[32:35], v[220:223]
  ds_read_b128 a[100:103], v3 offset:37888
  v_mfma_f32_16x16x32_bf16 v[72:75], a[20:23], v[32:35], v[220:223]
  ds_read_b128 a[104:107], v3 offset:38912
  ds_read_b128 a[108:111], v3 offset:39936
  v_mfma_f32_16x16x32_bf16 v[76:79], a[24:27], v[32:35], v[220:223]
  ds_read_b128 a[112:115], v3 offset:40960
  v_mfma_f32_16x16x32_bf16 v[80:83], a[28:31], v[32:35], v[220:223]
  ds_read_b128 a[116:119], v3 offset:41984
  v_mfma_f32_16x16x32_bf16 v[84:87], a[32:35], v[32:35], v[224:227]
  ds_read_b128 a[120:123], v3 offset:43008
  v_mfma_f32_16x16x32_bf16 v[88:91], a[36:39], v[32:35], v[224:227]
  ds_read_b128 a[124:127], v3 offset:44032
  v_mfma_f32_16x16x32_bf16 v[92:95], a[40:43], v[32:35], v[224:227]
  ds_read_b128 a[128:131], v3 offset:45056
  v_mfma_f32_16x16x32_bf16 v[96:99], a[44:47], v[32:35], v[224:227]
  ds_read_b128 a[132:135], v3 offset:46080
  ds_read_b128 a[136:139], v3 offset:47104
  v_mfma_f32_16x16x32_bf16 v[100:103], a[48:51], v[32:35], v[228:231]
  ds_read_b128 a[140:143], v3 offset:48128
  v_mfma_f32_16x16x32_bf16 v[104:107], a[52:55], v[32:35], v[228:231]
  ds_read_b128 a[144:147], v3 offset:49152
  v_mfma_f32_16x16x32_bf16 v[108:111], a[56:59], v[32:35], v[228:231]
  ds_read_b128 a[148:151], v3 offset:50176
  v_mfma_f32_16x16x32_bf16 v[112:115], a[60:63], v[32:35], v[228:231]
  ds_read_b128 a[152:155], v3 offset:51200
  v_mfma_f32_16x16x32_bf16 v[116:119], a[64:67], v[32:35], v[212:215]
  ds_read_b128 a[156:159], v3 offset:52224
  s_nop 4
  v_max3_f32 v6, v52, v53, v54
  v_max3_f32 v7, v55, v56, v57
  v_max3_f32 v6, v6, v58, v59
  v_max3_f32 v7, v7, v60, v61
  v_max3_f32 v6, v6, v62, v63
  v_max3_f32 v7, v7, v64, v65
  v_max3_f32 v6, v6, v66, v67
  buffer_store_dwordx4 v[176:179], v22, s[20:23], s16 offen offset:2048 sc1
  v_max3_f32 v7, v7, v68, v69
  v_max3_f32 v6, v6, v70, v71
  v_max3_f32 v7, v7, v72, v73
  v_max3_f32 v6, v6, v74, v75
  v_max3_f32 v7, v7, v76, v77
  v_max3_f32 v6, v6, v78, v79
  v_max3_f32 v7, v7, v80, v81
  v_max3_f32 v6, v6, v82, v83
  buffer_store_dwordx4 v[180:183], v22, s[20:23], s16 offen offset:3072 sc1
  v_max3_f32 v7, v7, v84, v85
  v_max3_f32 v6, v6, v86, v87
  v_max3_f32 v7, v7, v88, v89
  v_max3_f32 v6, v6, v90, v91
  v_max3_f32 v7, v7, v92, v93
  v_max3_f32 v6, v6, v94, v95
  v_max3_f32 v7, v7, v96, v97
  v_max3_f32 v6, v6, v98, v99
  v_max3_f32 v7, v7, v100, v101
  v_max3_f32 v6, v6, v102, v103
  v_max3_f32 v7, v7, v104, v105
  v_max3_f32 v6, v6, v106, v107
  v_max3_f32 v7, v7, v108, v109
  v_max3_f32 v6, v6, v110, v111
  v_max3_f32 v7, v7, v112, v113
  v_max3_f32 v6, v6, v114, v115
  v_max3_f32 v7, v7, v116, v117
  v_max3_f32 v6, v6, v118, v119
  v_max_f32 v6, v6, v7
  v_mov_b32 v7, v6
  s_nop 1
  v_permlane32_swap_b32 v7, v6
  s_nop 1
  v_max_f32 v6, v6, v7
  v_mov_b32 v7, v6
  s_nop 1
  v_permlane16_swap_b32 v7, v6
  s_nop 1
  v_max_f32 v6, v6, v7
  v_mul_f32 v8, s42, v6
  v_sub_f32 v8, 0, v8
  v_mov_b32 v9, v8
  v_pk_fma_f32 v[52:53], v[52:53], s[42:43], v[8:9]
  v_pk_fma_f32 v[54:55], v[54:55], s[42:43], v[8:9]
  v_pk_fma_f32 v[56:57], v[56:57], s[42:43], v[8:9]
  v_pk_fma_f32 v[58:59], v[58:59], s[42:43], v[8:9]
  v_pk_fma_f32 v[60:61], v[60:61], s[42:43], v[8:9]
  v_pk_fma_f32 v[62:63], v[62:63], s[42:43], v[8:9]
  v_pk_fma_f32 v[64:65], v[64:65], s[42:43], v[8:9]
  v_pk_fma_f32 v[66:67], v[66:67], s[42:43], v[8:9]
  buffer_store_dwordx4 v[184:187], v22, s[20:23], s17 offen offset:2048 sc1
  v_pk_fma_f32 v[68:69], v[68:69], s[42:43], v[8:9]
  v_pk_fma_f32 v[70:71], v[70:71], s[42:43], v[8:9]
  v_pk_fma_f32 v[72:73], v[72:73], s[42:43], v[8:9]
  v_pk_fma_f32 v[74:75], v[74:75], s[42:43], v[8:9]
  v_pk_fma_f32 v[76:77], v[76:77], s[42:43], v[8:9]
  v_pk_fma_f32 v[78:79], v[78:79], s[42:43], v[8:9]
  v_pk_fma_f32 v[80:81], v[80:81], s[42:43], v[8:9]
  v_pk_fma_f32 v[82:83], v[82:83], s[42:43], v[8:9]
  buffer_store_dwordx4 v[188:191], v22, s[20:23], s17 offen offset:3072 sc1
  v_pk_fma_f32 v[84:85], v[84:85], s[42:43], v[8:9]
  v_pk_fma_f32 v[86:87], v[86:87], s[42:43], v[8:9]
  v_pk_fma_f32 v[88:89], v[88:89], s[42:43], v[8:9]
  v_pk_fma_f32 v[90:91], v[90:91], s[42:43], v[8:9]
  v_pk_fma_f32 v[92:93], v[92:93], s[42:43], v[8:9]
  v_pk_fma_f32 v[94:95], v[94:95], s[42:43], v[8:9]
  v_pk_fma_f32 v[96:97], v[96:97], s[42:43], v[8:9]
  v_pk_fma_f32 v[98:99], v[98:99], s[42:43], v[8:9]
  v_pk_fma_f32 v[100:101], v[100:101], s[42:43], v[8:9]
  v_pk_fma_f32 v[102:103], v[102:103], s[42:43], v[8:9]
  v_pk_fma_f32 v[104:105], v[104:105], s[42:43], v[8:9]
  v_pk_fma_f32 v[106:107], v[106:107], s[42:43], v[8:9]
  v_pk_fma_f32 v[108:109], v[108:109], s[42:43], v[8:9]
  v_pk_fma_f32 v[110:111], v[110:111], s[42:43], v[8:9]
  v_pk_fma_f32 v[112:113], v[112:113], s[42:43], v[8:9]
  v_pk_fma_f32 v[114:115], v[114:115], s[42:43], v[8:9]
  v_pk_fma_f32 v[116:117], v[116:117], s[42:43], v[8:9]
  v_pk_fma_f32 v[118:119], v[118:119], s[42:43], v[8:9]
  buffer_store_dwordx4 v[240:243], v23, s[20:23], s18 offen sc1
  buffer_store_dwordx4 v[248:251], v23, s[20:23], s19 offen sc1
  s_waitcnt lgkmcnt(0)
  v_exp_f32 v52, v52
  v_mfma_f32_16x16x32_bf16 v[124:127], a[4:7], v[36:39], v[208:211]
  v_exp_f32 v53, v53
  v_exp_f32 v54, v54
  v_exp_f32 v55, v55
  v_exp_f32 v56, v56
  v_exp_f32 v57, v57
  v_mfma_f32_16x16x32_bf16 v[128:131], a[8:11], v[36:39], v[216:219]
  v_cvt_pk_bf16_f32 v48, v52, v53
  v_exp_f32 v58, v58
  v_exp_f32 v59, v59
  v_cvt_pk_bf16_f32 v49, v54, v55
  v_exp_f32 v60, v60
  v_mfma_f32_16x16x32_bf16 v[132:135], a[12:15], v[36:39], v[216:219]
  v_exp_f32 v61, v61
  v_cvt_pk_bf16_f32 v50, v56, v57
  v_exp_f32 v62, v62
  v_exp_f32 v63, v63
  v_cvt_pk_bf16_f32 v51, v58, v59
  v_exp_f32 v64, v64
  v_mfma_f32_16x16x32_bf16 v[136:139], a[16:19], v[36:39], v[220:223]
  v_exp_f32 v65, v65
  v_cvt_pk_bf16_f32 v52, v60, v61
  v_exp_f32 v66, v66
  v_exp_f32 v67, v67
  v_cvt_pk_bf16_f32 v53, v62, v63
  v_mfma_f32_16x16x32_bf16 v[140:143], a[20:23], v[36:39], v[220:223]
  v_exp_f32 v68, v68
  v_exp_f32 v69, v69
  v_cvt_pk_bf16_f32 v54, v64, v65
  v_exp_f32 v70, v70
  v_exp_f32 v71, v71
  v_cvt_pk_bf16_f32 v55, v66, v67
  v_mfma_f32_16x16x32_bf16 v[144:147], a[24:27], v[36:39], v[220:223]
  v_exp_f32 v72, v72
  v_exp_f32 v73, v73
  v_cvt_pk_bf16_f32 v56, v68, v69
  v_exp_f32 v74, v74
  v_exp_f32 v75, v75
  v_mfma_f32_16x16x32_bf16 v[148:151], a[28:31], v[36:39], v[220:223]
  v_cvt_pk_bf16_f32 v57, v70, v71
  v_exp_f32 v76, v76
  v_exp_f32 v77, v77
  v_cvt_pk_bf16_f32 v58, v72, v73
  v_exp_f32 v78, v78
  v_mfma_f32_16x16x32_bf16 v[152:155], a[32:35], v[36:39], v[224:227]
  v_exp_f32 v79, v79
  v_cvt_pk_bf16_f32 v59, v74, v75
  v_exp_f32 v80, v80
  v_exp_f32 v81, v81
  v_cvt_pk_bf16_f32 v60, v76, v77
  v_exp_f32 v82, v82
  v_mfma_f32_16x16x32_bf16 v[156:159], a[36:39], v[36:39], v[224:227]
  v_exp_f32 v83, v83
  v_cvt_pk_bf16_f32 v61, v78, v79
  v_exp_f32 v84, v84
  v_exp_f32 v85, v85
  v_cvt_pk_bf16_f32 v62, v80, v81
  v_mfma_f32_16x16x32_bf16 v[160:163], a[40:43], v[36:39], v[224:227]
  v_exp_f32 v86, v86
  v_exp_f32 v87, v87
  v_cvt_pk_bf16_f32 v63, v82, v83
  v_exp_f32 v88, v88
  v_exp_f32 v89, v89
  v_cvt_pk_bf16_f32 v64, v84, v85
  v_mfma_f32_16x16x32_bf16 v[164:167], a[44:47], v[36:39], v[224:227]
  v_exp_f32 v90, v90
  v_exp_f32 v91, v91
  v_cvt_pk_bf16_f32 v65, v86, v87
  v_exp_f32 v92, v92
  v_exp_f32 v93, v93
  v_mfma_f32_16x16x32_bf16 v[168:171], a[48:51], v[36:39], v[228:231]
  v_cvt_pk_bf16_f32 v66, v88, v89
  v_exp_f32 v94, v94
  v_exp_f32 v95, v95
  v_cvt_pk_bf16_f32 v67, v90, v91
  v_exp_f32 v96, v96
  v_mfma_f32_16x16x32_bf16 v[172:175], a[52:55], v[36:39], v[228:231]
  v_exp_f32 v97, v97
  v_cvt_pk_bf16_f32 v68, v92, v93
  v_exp_f32 v98, v98
  v_exp_f32 v99, v99
  v_cvt_pk_bf16_f32 v69, v94, v95
  v_exp_f32 v100, v100
  v_mfma_f32_16x16x32_bf16 v[176:179], a[56:59], v[36:39], v[228:231]
  v_exp_f32 v101, v101
  v_cvt_pk_bf16_f32 v70, v96, v97
  v_exp_f32 v102, v102
  v_exp_f32 v103, v103
  v_cvt_pk_bf16_f32 v71, v98, v99
  v_mfma_f32_16x16x32_bf16 v[180:183], a[60:63], v[36:39], v[228:231]
  v_exp_f32 v104, v104
  v_exp_f32 v105, v105
  v_cvt_pk_bf16_f32 v72, v100, v101
  v_exp_f32 v106, v106
  v_exp_f32 v107, v107
  v_cvt_pk_bf16_f32 v73, v102, v103
  v_mfma_f32_16x16x32_bf16 v[184:187], a[64:67], v[36:39], 0
  v_exp_f32 v108, v108
  v_exp_f32 v109, v109
  v_cvt_pk_bf16_f32 v74, v104, v105
  v_exp_f32 v110, v110
  v_exp_f32 v111, v111
  v_mfma_f32_16x16x32_bf16 v[188:191], a[68:71], v[36:39], v[212:215]
  v_cvt_pk_bf16_f32 v75, v106, v107
  v_exp_f32 v112, v112
  v_exp_f32 v113, v113
  v_cvt_pk_bf16_f32 v76, v108, v109
  v_exp_f32 v114, v114
  v_exp_f32 v115, v115
  v_cvt_pk_bf16_f32 v77, v110, v111
  v_exp_f32 v116, v116
  v_exp_f32 v117, v117
  v_cvt_pk_bf16_f32 v78, v112, v113
  v_exp_f32 v118, v118
  v_exp_f32 v119, v119
  v_cvt_pk_bf16_f32 v79, v114, v115
  s_waitcnt vmcnt(0)
  v_mov_b32 v24, s46
  v_mov_b32 v25, s47
  v_lshlrev_b32 v26, 12, v17
  s_mov_b64 exec, 0xff
  buffer_store_dwordx2 v[24:25], v26, s[72:75], s71 offen offset:512 sc1
  s_mov_b64 exec, -1
  buffer_load_dwordx2 v[232:233], v14, s[12:15], s48 offen offset:0
  buffer_load_dwordx2 v[234:235], v14, s[12:15], s49 offen offset:0
  buffer_load_dwordx2 v[236:237], v14, s[12:15], s48 offen offset:32
  buffer_load_dwordx2 v[238:239], v14, s[12:15], s49 offen offset:32
  buffer_load_dwordx2 v[240:241], v14, s[12:15], s48 offen offset:64
  buffer_load_dwordx2 v[242:243], v14, s[12:15], s49 offen offset:64
  buffer_load_dwordx2 v[244:245], v14, s[12:15], s48 offen offset:96
  buffer_load_dwordx2 v[246:247], v14, s[12:15], s49 offen offset:96
  buffer_load_dwordx2 v[248:249], v15, s[24:27], s36 offen offset:0
  buffer_load_dwordx2 v[250:251], v15, s[24:27], s36 offen offset:32
  buffer_load_dwordx2 v[252:253], v15, s[24:27], s36 offen offset:64
  buffer_load_dwordx2 v[254:255], v15, s[24:27], s36 offen offset:96
  s_nop 0
  v_cvt_pk_bf16_f32 v80, v116, v117
  v_cvt_pk_bf16_f32 v81, v118, v119
  v_mov_b32 v82, 0
  v_mov_b32 v83, 0
  v_max3_f32 v6, v124, v125, v126
  v_max3_f32 v7, v127, v128, v129
  v_max3_f32 v6, v6, v130, v131
  v_max3_f32 v7, v7, v132, v133
  v_max3_f32 v6, v6, v134, v135
  v_max3_f32 v7, v7, v136, v137
  v_max3_f32 v6, v6, v138, v139
  v_max3_f32 v7, v7, v140, v141
  v_max3_f32 v6, v6, v142, v143
  v_max3_f32 v7, v7, v144, v145
  v_max3_f32 v6, v6, v146, v147
  v_max3_f32 v7, v7, v148, v149
  v_max3_f32 v6, v6, v150, v151
  v_max3_f32 v7, v7, v152, v153
  v_max3_f32 v6, v6, v154, v155
  v_max3_f32 v7, v7, v156, v157
  v_max3_f32 v6, v6, v158, v159
  v_max3_f32 v7, v7, v160, v161
  v_max3_f32 v6, v6, v162, v163
  v_max3_f32 v7, v7, v164, v165
  v_max3_f32 v6, v6, v166, v167
  v_max3_f32 v7, v7, v168, v169
  v_max3_f32 v6, v6, v170, v171
  v_max3_f32 v7, v7, v172, v173
  v_max3_f32 v6, v6, v174, v175
  v_max3_f32 v7, v7, v176, v177
  v_max3_f32 v6, v6, v178, v179
  v_max3_f32 v7, v7, v180, v181
  v_max3_f32 v6, v6, v182, v183
  v_max3_f32 v7, v7, v184, v185
  v_max3_f32 v6, v6, v186, v187
  v_max3_f32 v7, v7, v188, v189
  v_max3_f32 v6, v6, v190, v191
  v_max_f32 v6, v6, v7
  v_mov_b32 v7, v6
  s_nop 1
  v_permlane32_swap_b32 v7, v6
  s_nop 1
  v_max_f32 v6, v6, v7
  v_mov_b32 v7, v6
  s_nop 1
  v_permlane16_swap_b32 v7, v6
  s_nop 1
  v_max_f32 v6, v6, v7
  v_mul_f32 v8, s42, v6
  v_sub_f32 v8, 0, v8
  v_mov_b32 v9, v8
  v_pk_fma_f32 v[124:125], v[124:125], s[42:43], v[8:9]
  v_pk_fma_f32 v[126:127], v[126:127], s[42:43], v[8:9]
  v_pk_fma_f32 v[128:129], v[128:129], s[42:43], v[8:9]
  v_pk_fma_f32 v[130:131], v[130:131], s[42:43], v[8:9]
  v_pk_fma_f32 v[132:133], v[132:133], s[42:43], v[8:9]
  v_pk_fma_f32 v[134:135], v[134:135], s[42:43], v[8:9]
  v_pk_fma_f32 v[136:137], v[136:137], s[42:43], v[8:9]
  v_pk_fma_f32 v[138:139], v[138:139], s[42:43], v[8:9]
  v_pk_fma_f32 v[140:141], v[140:141], s[42:43], v[8:9]
  v_pk_fma_f32 v[142:143], v[142:143], s[42:43], v[8:9]
  v_pk_fma_f32 v[144:145], v[144:145], s[42:43], v[8:9]
  v_pk_fma_f32 v[146:147], v[146:147], s[42:43], v[8:9]
  v_pk_fma_f32 v[148:149], v[148:149], s[42:43], v[8:9]
  v_pk_fma_f32 v[150:151], v[150:151], s[42:43], v[8:9]
  v_pk_fma_f32 v[152:153], v[152:153], s[42:43], v[8:9]
  v_pk_fma_f32 v[154:155], v[154:155], s[42:43], v[8:9]
  v_pk_fma_f32 v[156:157], v[156:157], s[42:43], v[8:9]
  v_pk_fma_f32 v[158:159], v[158:159], s[42:43], v[8:9]
  v_pk_fma_f32 v[160:161], v[160:161], s[42:43], v[8:9]
  v_pk_fma_f32 v[162:163], v[162:163], s[42:43], v[8:9]
  v_pk_fma_f32 v[164:165], v[164:165], s[42:43], v[8:9]
  v_pk_fma_f32 v[166:167], v[166:167], s[42:43], v[8:9]
  v_pk_fma_f32 v[168:169], v[168:169], s[42:43], v[8:9]
  v_pk_fma_f32 v[170:171], v[170:171], s[42:43], v[8:9]
  v_pk_fma_f32 v[172:173], v[172:173], s[42:43], v[8:9]
  v_pk_fma_f32 v[174:175], v[174:175], s[42:43], v[8:9]
  v_pk_fma_f32 v[176:177], v[176:177], s[42:43], v[8:9]
  v_pk_fma_f32 v[178:179], v[178:179], s[42:43], v[8:9]
  v_pk_fma_f32 v[180:181], v[180:181], s[42:43], v[8:9]
  v_pk_fma_f32 v[182:183], v[182:183], s[42:43], v[8:9]
  v_pk_fma_f32 v[184:185], v[184:185], s[42:43], v[8:9]
  v_pk_fma_f32 v[186:187], v[186:187], s[42:43], v[8:9]
  v_pk_fma_f32 v[188:189], v[188:189], s[42:43], v[8:9]
  v_pk_fma_f32 v[190:191], v[190:191], s[42:43], v[8:9]
  v_exp_f32 v124, v124
  v_mfma_f32_16x16x32_bf16 v[192:195], a[80:83], v[48:51], 0
  v_exp_f32 v125, v125
  v_exp_f32 v126, v126
  v_mfma_f32_16x16x32_bf16 v[196:199], a[84:87], v[48:51], 0
  v_exp_f32 v127, v127
  v_exp_f32 v128, v128
  v_mfma_f32_16x16x32_bf16 v[200:203], v[204:207], v[48:51], 0
  v_exp_f32 v129, v129
  v_cvt_pk_bf16_f32 v122, v124, v125
  v_mfma_f32_16x16x32_bf16 v[192:195], a[88:91], v[52:55], v[192:195]
  v_exp_f32 v130, v130
  v_exp_f32 v131, v131
  v_mfma_f32_16x16x32_bf16 v[196:199], a[92:95], v[52:55], v[196:199]
  v_cvt_pk_bf16_f32 v123, v126, v127
  v_exp_f32 v132, v132
  v_mfma_f32_16x16x32_bf16 v[200:203], v[204:207], v[52:55], v[200:203]
  v_exp_f32 v133, v133
  v_cvt_pk_bf16_f32 v124, v128, v129
  v_mfma_f32_16x16x32_bf16 v[192:195], a[96:99], v[56:59], v[192:195]
  v_exp_f32 v134, v134
  v_exp_f32 v135, v135
  v_mfma_f32_16x16x32_bf16 v[196:199], a[100:103], v[56:59], v[196:199]
  v_cvt_pk_bf16_f32 v125, v130, v131
  v_exp_f32 v136, v136
  v_mfma_f32_16x16x32_bf16 v[200:203], v[204:207], v[56:59], v[200:203]
  v_exp_f32 v137, v137
  v_cvt_pk_bf16_f32 v126, v132, v133
  v_mfma_f32_16x16x32_bf16 v[192:195], a[104:107], v[60:63], v[192:195]
  v_exp_f32 v138, v138
  v_exp_f32 v139, v139
  v_mfma_f32_16x16x32_bf16 v[196:199], a[108:111], v[60:63], v[196:199]
  v_cvt_pk_bf16_f32 v127, v134, v135
  v_exp_f32 v140, v140
  v_exp_f32 v141, v141
  v_mfma_f32_16x16x32_bf16 v[200:203], v[204:207], v[60:63], v[200:203]
  v_cvt_pk_bf16_f32 v128, v136, v137
  v_exp_f32 v142, v142
  v_mfma_f32_16x16x32_bf16 v[192:195], a[112:115], v[64:67], v[192:195]
  v_exp_f32 v143, v143
  v_cvt_pk_bf16_f32 v129, v138, v139
  v_mfma_f32_16x16x32_bf16 v[196:199], a[116:119], v[64:67], v[196:199]
  v_exp_f32 v144, v144
  v_exp_f32 v145, v145
  v_mfma_f32_16x16x32_bf16 v[200:203], v[204:207], v[64:67], v[200:203]
  v_cvt_pk_bf16_f32 v130, v140, v141
  v_exp_f32 v146, v146
  v_mfma_f32_16x16x32_bf16 v[192:195], a[120:123], v[68:71], v[192:195]
  v_exp_f32 v147, v147
  v_cvt_pk_bf16_f32 v131, v142, v143
  v_mfma_f32_16x16x32_bf16 v[196:199], a[124:127], v[68:71], v[196:199]
  v_exp_f32 v148, v148
  v_exp_f32 v149, v149
  v_mfma_f32_16x16x32_bf16 v[200:203], v[204:207], v[68:71], v[200:203]
  v_cvt_pk_bf16_f32 v132, v144, v145
  v_exp_f32 v150, v150
  v_mfma_f32_16x16x32_bf16 v[192:195], a[128:131], v[72:75], v[192:195]
  v_exp_f32 v151, v151
  v_cvt_pk_bf16_f32 v133, v146, v147
  v_mfma_f32_16x16x32_bf16 v[196:199], a[132:135], v[72:75], v[196:199]
  v_exp_f32 v152, v152
  v_exp_f32 v153, v153
  v_mfma_f32_16x16x32_bf16 v[200:203], v[204:207], v[72:75], v[200:203]
  v_cvt_pk_bf16_f32 v134, v148, v149
  v_exp_f32 v154, v154
  v_mfma_f32_16x16x32_bf16 v[192:195], a[136:139], v[76:79], v[192:195]
  v_exp_f32 v155, v155
  v_cvt_pk_bf16_f32 v135, v150, v151
  v_exp_f32 v156, v156
  v_mfma_f32_16x16x32_bf16 v[196:199], a[140:143], v[76:79], v[196:199]
  v_exp_f32 v157, v157
  v_cvt_pk_bf16_f32 v136, v152, v153
  v_mfma_f32_16x16x32_bf16 v[200:203], v[204:207], v[76:79], v[200:203]
  v_exp_f32 v158, v158
  v_exp_f32 v159, v159
  v_mfma_f32_16x16x32_bf16 v[192:195], a[144:147], v[80:83], v[192:195]
  v_cvt_pk_bf16_f32 v137, v154, v155
  v_exp_f32 v160, v160
  v_mfma_f32_16x16x32_bf16 v[196:199], a[148:151], v[80:83], v[196:199]
  v_exp_f32 v161, v161
  v_cvt_pk_bf16_f32 v138, v156, v157
  v_mfma_f32_16x16x32_bf16 v[200:203], v[204:207], v[80:83], v[200:203]
  v_exp_f32 v162, v162
  v_exp_f32 v163, v163
  v_mfma_f32_16x16x32_bf16 v[52:55], a[8:11], v[40:43], v[208:211]
  v_cvt_pk_bf16_f32 v139, v158, v159
  v_exp_f32 v164, v164
  v_mfma_f32_16x16x32_bf16 v[56:59], a[12:15], v[40:43], v[216:219]
  v_exp_f32 v165, v165
  v_cvt_pk_bf16_f32 v140, v160, v161
  v_mfma_f32_16x16x32_bf16 v[60:63], a[16:19], v[40:43], v[220:223]
  v_exp_f32 v166, v166
  v_exp_f32 v167, v167
  v_mfma_f32_16x16x32_bf16 v[64:67], a[20:23], v[40:43], v[220:223]
  v_cvt_pk_bf16_f32 v141, v162, v163
  v_exp_f32 v168, v168
  v_mfma_f32_16x16x32_bf16 v[68:71], a[24:27], v[40:43], v[220:223]
  v_exp_f32 v169, v169
  v_cvt_pk_bf16_f32 v142, v164, v165
  v_mfma_f32_16x16x32_bf16 v[72:75], a[28:31], v[40:43], v[220:223]
  v_exp_f32 v170, v170
  v_exp_f32 v171, v171
  v_cvt_pk_bf16_f32 v143, v166, v167
  v_mfma_f32_16x16x32_bf16 v[76:79], a[32:35], v[40:43], v[224:227]
  v_exp_f32 v172, v172
  v_exp_f32 v173, v173
  v_mfma_f32_16x16x32_bf16 v[80:83], a[36:39], v[40:43], v[224:227]
  v_cvt_pk_bf16_f32 v144, v168, v169
  v_exp_f32 v174, v174
  v_mfma_f32_16x16x32_bf16 v[84:87], a[40:43], v[40:43], v[224:227]
  v_exp_f32 v175, v175
  v_cvt_pk_bf16_f32 v145, v170, v171
  v_mfma_f32_16x16x32_bf16 v[88:91], a[44:47], v[40:43], v[224:227]
  v_exp_f32 v176, v176
  v_exp_f32 v177, v177
  v_mfma_f32_16x16x32_bf16 v[92:95], a[48:51], v[40:43], v[228:231]
  v_cvt_pk_bf16_f32 v146, v172, v173
  v_exp_f32 v178, v178
  v_mfma_f32_16x16x32_bf16 v[96:99], a[52:55], v[40:43], v[228:231]
  v_exp_f32 v179, v179
  v_cvt_pk_bf16_f32 v147, v174, v175
  v_mfma_f32_16x16x32_bf16 v[100:103], a[56:59], v[40:43], v[228:231]
  v_exp_f32 v180, v180
  v_exp_f32 v181, v181
  v_mfma_f32_16x16x32_bf16 v[104:107], a[60:63], v[40:43], v[228:231]
  v_cvt_pk_bf16_f32 v148, v176, v177
  v_exp_f32 v182, v182
  v_mfma_f32_16x16x32_bf16 v[108:111], a[64:67], v[40:43], 0
  v_exp_f32 v183, v183
  v_cvt_pk_bf16_f32 v149, v178, v179
  v_mfma_f32_16x16x32_bf16 v[112:115], a[68:71], v[40:43], 0
  v_exp_f32 v184, v184
  v_exp_f32 v185, v185
  v_mfma_f32_16x16x32_bf16 v[116:119], a[72:75], v[40:43], v[212:215]
  v_cvt_pk_bf16_f32 v150, v180, v181
  v_exp_f32 v186, v186
  v_exp_f32 v187, v187
  v_cvt_pk_bf16_f32 v151, v182, v183
  v_exp_f32 v188, v188
  v_exp_f32 v189, v189
  v_cvt_pk_bf16_f32 v152, v184, v185
  v_exp_f32 v190, v190
  v_exp_f32 v191, v191
  v_cvt_pk_bf16_f32 v153, v186, v187
  v_rcp_f32 v4, v200
  s_nop 0
  v_mul_f32 v192, v192, v4
  v_mul_f32 v193, v193, v4
  v_mul_f32 v194, v194, v4
  v_mul_f32 v195, v195, v4
  v_mul_f32 v196, v196, v4
  v_mul_f32 v197, v197, v4
  v_mul_f32 v198, v198, v4
  v_mul_f32 v199, v199, v4
  v_cvt_pk_bf16_f32 v28, v192, v193
  v_cvt_pk_bf16_f32 v29, v194, v195
  v_cvt_pk_bf16_f32 v30, v196, v197
  v_cvt_pk_bf16_f32 v31, v198, v199
  s_nop 1
  v_permlane16_swap_b32 v28, v30
  v_permlane16_swap_b32 v29, v31
  buffer_store_dwordx4 v[28:31], v22, s[20:23], s33 offen offset:0 sc1
  v_cvt_pk_bf16_f32 v154, v188, v189
  v_cvt_pk_bf16_f32 v155, v190, v191
  v_mov_b32 v120, 0
  v_mov_b32 v121, 0
  v_max3_f32 v6, v52, v53, v54
  v_max3_f32 v7, v55, v56, v57
  v_max3_f32 v6, v6, v58, v59
  v_max3_f32 v7, v7, v60, v61
  v_max3_f32 v6, v6, v62, v63
  v_max3_f32 v7, v7, v64, v65
  v_max3_f32 v6, v6, v66, v67
  v_max3_f32 v7, v7, v68, v69
  v_max3_f32 v6, v6, v70, v71
  v_max3_f32 v7, v7, v72, v73
  v_max3_f32 v6, v6, v74, v75
  v_max3_f32 v7, v7, v76, v77
  v_max3_f32 v6, v6, v78, v79
  v_max3_f32 v7, v7, v80, v81
  v_max3_f32 v6, v6, v82, v83
  v_max3_f32 v7, v7, v84, v85
  v_max3_f32 v6, v6, v86, v87
  v_max3_f32 v7, v7, v88, v89
  v_max3_f32 v6, v6, v90, v91
  v_max3_f32 v7, v7, v92, v93
  v_max3_f32 v6, v6, v94, v95
  v_max3_f32 v7, v7, v96, v97
  v_max3_f32 v6, v6, v98, v99
  v_max3_f32 v7, v7, v100, v101
  v_max3_f32 v6, v6, v102, v103
  v_max3_f32 v7, v7, v104, v105
  v_max3_f32 v6, v6, v106, v107
  v_max3_f32 v7, v7, v108, v109
  v_max3_f32 v6, v6, v110, v111
  v_max3_f32 v7, v7, v112, v113
  v_max3_f32 v6, v6, v114, v115
  v_max3_f32 v7, v7, v116, v117
  v_max3_f32 v6, v6, v118, v119
  v_max_f32 v6, v6, v7
  v_mov_b32 v7, v6
  s_nop 1
  v_permlane32_swap_b32 v7, v6
  s_nop 1
  v_max_f32 v6, v6, v7
  v_mov_b32 v7, v6
  s_nop 1
  v_permlane16_swap_b32 v7, v6
  s_nop 1
  v_max_f32 v6, v6, v7
  v_mul_f32 v8, s42, v6
  v_sub_f32 v8, 0, v8
  v_mov_b32 v9, v8
  v_pk_fma_f32 v[52:53], v[52:53], s[42:43], v[8:9]
  v_pk_fma_f32 v[54:55], v[54:55], s[42:43], v[8:9]
  v_pk_fma_f32 v[56:57], v[56:57], s[42:43], v[8:9]
  v_pk_fma_f32 v[58:59], v[58:59], s[42:43], v[8:9]
  v_pk_fma_f32 v[60:61], v[60:61], s[42:43], v[8:9]
  v_pk_fma_f32 v[62:63], v[62:63], s[42:43], v[8:9]
  v_pk_fma_f32 v[64:65], v[64:65], s[42:43], v[8:9]
  v_pk_fma_f32 v[66:67], v[66:67], s[42:43], v[8:9]
  v_pk_fma_f32 v[68:69], v[68:69], s[42:43], v[8:9]
  v_pk_fma_f32 v[70:71], v[70:71], s[42:43], v[8:9]
  v_pk_fma_f32 v[72:73], v[72:73], s[42:43], v[8:9]
  v_pk_fma_f32 v[74:75], v[74:75], s[42:43], v[8:9]
  v_pk_fma_f32 v[76:77], v[76:77], s[42:43], v[8:9]
  v_pk_fma_f32 v[78:79], v[78:79], s[42:43], v[8:9]
  v_pk_fma_f32 v[80:81], v[80:81], s[42:43], v[8:9]
  v_pk_fma_f32 v[82:83], v[82:83], s[42:43], v[8:9]
  v_pk_fma_f32 v[84:85], v[84:85], s[42:43], v[8:9]
  v_pk_fma_f32 v[86:87], v[86:87], s[42:43], v[8:9]
  v_pk_fma_f32 v[88:89], v[88:89], s[42:43], v[8:9]
  v_pk_fma_f32 v[90:91], v[90:91], s[42:43], v[8:9]
  v_pk_fma_f32 v[92:93], v[92:93], s[42:43], v[8:9]
  v_pk_fma_f32 v[94:95], v[94:95], s[42:43], v[8:9]
  v_pk_fma_f32 v[96:97], v[96:97], s[42:43], v[8:9]
  v_pk_fma_f32 v[98:99], v[98:99], s[42:43], v[8:9]
  v_pk_fma_f32 v[100:101], v[100:101], s[42:43], v[8:9]
  v_pk_fma_f32 v[102:103], v[102:103], s[42:43], v[8:9]
  v_pk_fma_f32 v[104:105], v[104:105], s[42:43], v[8:9]
  v_pk_fma_f32 v[106:107], v[106:107], s[42:43], v[8:9]
  v_pk_fma_f32 v[108:109], v[108:109], s[42:43], v[8:9]
  v_pk_fma_f32 v[110:111], v[110:111], s[42:43], v[8:9]
  v_pk_fma_f32 v[112:113], v[112:113], s[42:43], v[8:9]
  v_pk_fma_f32 v[114:115], v[114:115], s[42:43], v[8:9]
  v_pk_fma_f32 v[116:117], v[116:117], s[42:43], v[8:9]
  v_pk_fma_f32 v[118:119], v[118:119], s[42:43], v[8:9]
  v_exp_f32 v52, v52
  v_mfma_f32_16x16x32_bf16 v[192:195], a[80:83], v[120:123], 0
  v_exp_f32 v53, v53
  v_exp_f32 v54, v54
  v_mfma_f32_16x16x32_bf16 v[196:199], a[84:87], v[120:123], 0
  v_exp_f32 v55, v55
  v_exp_f32 v56, v56
  v_mfma_f32_16x16x32_bf16 v[200:203], v[204:207], v[120:123], 0
  v_exp_f32 v57, v57
  v_cvt_pk_bf16_f32 v48, v52, v53
  v_mfma_f32_16x16x32_bf16 v[192:195], a[88:91], v[124:127], v[192:195]
  v_exp_f32 v58, v58
  v_exp_f32 v59, v59
  v_mfma_f32_16x16x32_bf16 v[196:199], a[92:95], v[124:127], v[196:199]
  v_cvt_pk_bf16_f32 v49, v54, v55
  v_exp_f32 v60, v60
  v_mfma_f32_16x16x32_bf16 v[200:203], v[204:207], v[124:127], v[200:203]
  v_exp_f32 v61, v61
  v_cvt_pk_bf16_f32 v50, v56, v57
  v_mfma_f32_16x16x32_bf16 v[192:195], a[96:99], v[128:131], v[192:195]
  v_exp_f32 v62, v62
  v_exp_f32 v63, v63
  v_mfma_f32_16x16x32_bf16 v[196:199], a[100:103], v[128:131], v[196:199]
  v_cvt_pk_bf16_f32 v51, v58, v59
  v_exp_f32 v64, v64
  v_mfma_f32_16x16x32_bf16 v[200:203], v[204:207], v[128:131], v[200:203]
  v_exp_f32 v65, v65
  v_cvt_pk_bf16_f32 v52, v60, v61
  v_mfma_f32_16x16x32_bf16 v[192:195], a[104:107], v[132:135], v[192:195]
  v_exp_f32 v66, v66
  v_exp_f32 v67, v67
  v_mfma_f32_16x16x32_bf16 v[196:199], a[108:111], v[132:135], v[196:199]
  v_cvt_pk_bf16_f32 v53, v62, v63
  v_exp_f32 v68, v68
  v_exp_f32 v69, v69
  v_mfma_f32_16x16x32_bf16 v[200:203], v[204:207], v[132:135], v[200:203]
  v_cvt_pk_bf16_f32 v54, v64, v65
  v_exp_f32 v70, v70
  v_mfma_f32_16x16x32_bf16 v[192:195], a[112:115], v[136:139], v[192:195]
  v_exp_f32 v71, v71
  v_cvt_pk_bf16_f32 v55, v66, v67
  v_mfma_f32_16x16x32_bf16 v[196:199], a[116:119], v[136:139], v[196:199]
  v_exp_f32 v72, v72
  v_exp_f32 v73, v73
  v_mfma_f32_16x16x32_bf16 v[200:203], v[204:207], v[136:139], v[200:203]
  v_cvt_pk_bf16_f32 v56, v68, v69
  v_exp_f32 v74, v74
  v_mfma_f32_16x16x32_bf16 v[192:195], a[120:123], v[140:143], v[192:195]
  v_exp_f32 v75, v75
  v_cvt_pk_bf16_f32 v57, v70, v71
  v_mfma_f32_16x16x32_bf16 v[196:199], a[124:127], v[140:143], v[196:199]
  v_exp_f32 v76, v76
  v_exp_f32 v77, v77
  v_mfma_f32_16x16x32_bf16 v[200:203], v[204:207], v[140:143], v[200:203]
  v_cvt_pk_bf16_f32 v58, v72, v73
  v_exp_f32 v78, v78
  v_mfma_f32_16x16x32_bf16 v[192:195], a[128:131], v[144:147], v[192:195]
  v_exp_f32 v79, v79
  v_cvt_pk_bf16_f32 v59, v74, v75
  v_mfma_f32_16x16x32_bf16 v[196:199], a[132:135], v[144:147], v[196:199]
  v_exp_f32 v80, v80
  v_exp_f32 v81, v81
  v_mfma_f32_16x16x32_bf16 v[200:203], v[204:207], v[144:147], v[200:203]
  v_cvt_pk_bf16_f32 v60, v76, v77
  v_exp_f32 v82, v82
  v_mfma_f32_16x16x32_bf16 v[192:195], a[136:139], v[148:151], v[192:195]
  v_exp_f32 v83, v83
  v_cvt_pk_bf16_f32 v61, v78, v79
  v_exp_f32 v84, v84
  v_mfma_f32_16x16x32_bf16 v[196:199], a[140:143], v[148:151], v[196:199]
  v_exp_f32 v85, v85
  v_cvt_pk_bf16_f32 v62, v80, v81
  v_mfma_f32_16x16x32_bf16 v[200:203], v[204:207], v[148:151], v[200:203]
  v_exp_f32 v86, v86
  v_exp_f32 v87, v87
  v_mfma_f32_16x16x32_bf16 v[192:195], a[144:147], v[152:155], v[192:195]
  v_cvt_pk_bf16_f32 v63, v82, v83
  v_exp_f32 v88, v88
  v_mfma_f32_16x16x32_bf16 v[196:199], a[148:151], v[152:155], v[196:199]
  v_exp_f32 v89, v89
  v_cvt_pk_bf16_f32 v64, v84, v85
  v_mfma_f32_16x16x32_bf16 v[200:203], v[204:207], v[152:155], v[200:203]
  v_exp_f32 v90, v90
  v_exp_f32 v91, v91
  v_mfma_f32_16x16x32_bf16 v[124:127], a[12:15], v[44:47], v[208:211]
  v_cvt_pk_bf16_f32 v65, v86, v87
  v_exp_f32 v92, v92
  v_mfma_f32_16x16x32_bf16 v[128:131], a[16:19], v[44:47], v[220:223]
  v_exp_f32 v93, v93
  v_cvt_pk_bf16_f32 v66, v88, v89
  v_mfma_f32_16x16x32_bf16 v[132:135], a[20:23], v[44:47], v[220:223]
  v_exp_f32 v94, v94
  v_exp_f32 v95, v95
  v_mfma_f32_16x16x32_bf16 v[136:139], a[24:27], v[44:47], v[220:223]
  v_cvt_pk_bf16_f32 v67, v90, v91
  v_exp_f32 v96, v96
  v_mfma_f32_16x16x32_bf16 v[140:143], a[28:31], v[44:47], v[220:223]
  v_exp_f32 v97, v97
  v_cvt_pk_bf16_f32 v68, v92, v93
  v_mfma_f32_16x16x32_bf16 v[144:147], a[32:35], v[44:47], v[224:227]
  v_exp_f32 v98, v98
  v_exp_f32 v99, v99
  v_cvt_pk_bf16_f32 v69, v94, v95
  v_mfma_f32_16x16x32_bf16 v[148:151], a[36:39], v[44:47], v[224:227]
  v_exp_f32 v100, v100
  v_exp_f32 v101, v101
  v_mfma_f32_16x16x32_bf16 v[152:155], a[40:43], v[44:47], v[224:227]
  v_cvt_pk_bf16_f32 v70, v96, v97
  v_exp_f32 v102, v102
  v_mfma_f32_16x16x32_bf16 v[156:159], a[44:47], v[44:47], v[224:227]
  v_exp_f32 v103, v103
  v_cvt_pk_bf16_f32 v71, v98, v99
  v_mfma_f32_16x16x32_bf16 v[160:163], a[48:51], v[44:47], v[228:231]
  v_exp_f32 v104, v104
  v_exp_f32 v105, v105
  v_mfma_f32_16x16x32_bf16 v[164:167], a[52:55], v[44:47], v[228:231]
  v_cvt_pk_bf16_f32 v72, v100, v101
  v_exp_f32 v106, v106
  v_mfma_f32_16x16x32_bf16 v[168:171], a[56:59], v[44:47], v[228:231]
  v_exp_f32 v107, v107
  v_cvt_pk_bf16_f32 v73, v102, v103
  v_mfma_f32_16x16x32_bf16 v[172:175], a[60:63], v[44:47], v[228:231]
  v_exp_f32 v108, v108
  v_exp_f32 v109, v109
  v_mfma_f32_16x16x32_bf16 v[176:179], a[64:67], v[44:47], 0
  v_cvt_pk_bf16_f32 v74, v104, v105
  v_exp_f32 v110, v110
  v_mfma_f32_16x16x32_bf16 v[180:183], a[68:71], v[44:47], 0
  v_exp_f32 v111, v111
  v_cvt_pk_bf16_f32 v75, v106, v107
  v_mfma_f32_16x16x32_bf16 v[184:187], a[72:75], v[44:47], 0
  v_exp_f32 v112, v112
  v_exp_f32 v113, v113
  v_mfma_f32_16x16x32_bf16 v[188:191], a[76:79], v[44:47], v[212:215]
  v_cvt_pk_bf16_f32 v76, v108, v109
  v_exp_f32 v114, v114
  v_exp_f32 v115, v115
  v_cvt_pk_bf16_f32 v77, v110, v111
  v_exp_f32 v116, v116
  v_exp_f32 v117, v117
  v_cvt_pk_bf16_f32 v78, v112, v113
  v_exp_f32 v118, v118
  v_exp_f32 v119, v119
  v_cvt_pk_bf16_f32 v79, v114, v115
  buffer_load_dwordx2 v[26:27], v0, s[72:75], s99 offen offset:512 sc1
  v_rcp_f32 v4, v200
  s_nop 0
  v_mul_f32 v192, v192, v4
  v_mul_f32 v193, v193, v4
  v_mul_f32 v194, v194, v4
  v_mul_f32 v195, v195, v4
  v_mul_f32 v196, v196, v4
  v_mul_f32 v197, v197, v4
  v_mul_f32 v198, v198, v4
  v_mul_f32 v199, v199, v4
  v_cvt_pk_bf16_f32 v28, v192, v193
  v_cvt_pk_bf16_f32 v29, v194, v195
  v_cvt_pk_bf16_f32 v30, v196, v197
  v_cvt_pk_bf16_f32 v31, v198, v199
  s_nop 1
  v_permlane16_swap_b32 v28, v30
  v_permlane16_swap_b32 v29, v31
  buffer_store_dwordx4 v[28:31], v22, s[20:23], s33 offen offset:1024 sc1
  v_cvt_pk_bf16_f32 v80, v116, v117
  v_cvt_pk_bf16_f32 v81, v118, v119
  v_mov_b32 v82, 0
  v_mov_b32 v83, 0
  v_max3_f32 v6, v124, v125, v126
  v_max3_f32 v7, v127, v128, v129
  v_max3_f32 v6, v6, v130, v131
  v_max3_f32 v7, v7, v132, v133
  v_max3_f32 v6, v6, v134, v135
  v_max3_f32 v7, v7, v136, v137
  v_max3_f32 v6, v6, v138, v139
  v_max3_f32 v7, v7, v140, v141
  v_max3_f32 v6, v6, v142, v143
  v_max3_f32 v7, v7, v144, v145
  v_max3_f32 v6, v6, v146, v147
  v_max3_f32 v7, v7, v148, v149
  v_max3_f32 v6, v6, v150, v151
  v_max3_f32 v7, v7, v152, v153
  v_max3_f32 v6, v6, v154, v155
  v_max3_f32 v7, v7, v156, v157
  v_max3_f32 v6, v6, v158, v159
  v_max3_f32 v7, v7, v160, v161
  v_max3_f32 v6, v6, v162, v163
  v_max3_f32 v7, v7, v164, v165
  v_max3_f32 v6, v6, v166, v167
  v_max3_f32 v7, v7, v168, v169
  v_max3_f32 v6, v6, v170, v171
  v_max3_f32 v7, v7, v172, v173
  v_max3_f32 v6, v6, v174, v175
  v_max3_f32 v7, v7, v176, v177
  v_max3_f32 v6, v6, v178, v179
  v_max3_f32 v7, v7, v180, v181
  v_max3_f32 v6, v6, v182, v183
  v_max3_f32 v7, v7, v184, v185
  v_max3_f32 v6, v6, v186, v187
  v_max3_f32 v7, v7, v188, v189
  v_max3_f32 v6, v6, v190, v191
  v_max_f32 v6, v6, v7
  v_mov_b32 v7, v6
  s_nop 1
  v_permlane32_swap_b32 v7, v6
  s_nop 1
  v_max_f32 v6, v6, v7
  v_mov_b32 v7, v6
  s_nop 1
  v_permlane16_swap_b32 v7, v6
  s_nop 1
  v_max_f32 v6, v6, v7
  v_mul_f32 v8, s42, v6
  v_sub_f32 v8, 0, v8
  v_mov_b32 v9, v8
  v_pk_fma_f32 v[124:125], v[124:125], s[42:43], v[8:9]
  v_pk_fma_f32 v[126:127], v[126:127], s[42:43], v[8:9]
  v_pk_fma_f32 v[128:129], v[128:129], s[42:43], v[8:9]
  v_pk_fma_f32 v[130:131], v[130:131], s[42:43], v[8:9]
  v_pk_fma_f32 v[132:133], v[132:133], s[42:43], v[8:9]
  v_pk_fma_f32 v[134:135], v[134:135], s[42:43], v[8:9]
  v_pk_fma_f32 v[136:137], v[136:137], s[42:43], v[8:9]
  v_pk_fma_f32 v[138:139], v[138:139], s[42:43], v[8:9]
  v_pk_fma_f32 v[140:141], v[140:141], s[42:43], v[8:9]
  v_pk_fma_f32 v[142:143], v[142:143], s[42:43], v[8:9]
  v_pk_fma_f32 v[144:145], v[144:145], s[42:43], v[8:9]
  v_pk_fma_f32 v[146:147], v[146:147], s[42:43], v[8:9]
  v_pk_fma_f32 v[148:149], v[148:149], s[42:43], v[8:9]
  v_pk_fma_f32 v[150:151], v[150:151], s[42:43], v[8:9]
  v_pk_fma_f32 v[152:153], v[152:153], s[42:43], v[8:9]
  v_pk_fma_f32 v[154:155], v[154:155], s[42:43], v[8:9]
  v_pk_fma_f32 v[156:157], v[156:157], s[42:43], v[8:9]
  v_pk_fma_f32 v[158:159], v[158:159], s[42:43], v[8:9]
  v_pk_fma_f32 v[160:161], v[160:161], s[42:43], v[8:9]
  v_pk_fma_f32 v[162:163], v[162:163], s[42:43], v[8:9]
  v_pk_fma_f32 v[164:165], v[164:165], s[42:43], v[8:9]
  v_pk_fma_f32 v[166:167], v[166:167], s[42:43], v[8:9]
  v_pk_fma_f32 v[168:169], v[168:169], s[42:43], v[8:9]
  v_pk_fma_f32 v[170:171], v[170:171], s[42:43], v[8:9]
  v_pk_fma_f32 v[172:173], v[172:173], s[42:43], v[8:9]
  v_pk_fma_f32 v[174:175], v[174:175], s[42:43], v[8:9]
  v_pk_fma_f32 v[176:177], v[176:177], s[42:43], v[8:9]
  v_pk_fma_f32 v[178:179], v[178:179], s[42:43], v[8:9]
  v_pk_fma_f32 v[180:181], v[180:181], s[42:43], v[8:9]
  v_pk_fma_f32 v[182:183], v[182:183], s[42:43], v[8:9]
  v_pk_fma_f32 v[184:185], v[184:185], s[42:43], v[8:9]
  v_pk_fma_f32 v[186:187], v[186:187], s[42:43], v[8:9]
  v_pk_fma_f32 v[188:189], v[188:189], s[42:43], v[8:9]
  v_pk_fma_f32 v[190:191], v[190:191], s[42:43], v[8:9]
  v_exp_f32 v124, v124
  v_mfma_f32_16x16x32_bf16 v[192:195], a[88:91], v[48:51], 0
  v_exp_f32 v125, v125
  v_exp_f32 v126, v126
  v_exp_f32 v127, v127
  v_mfma_f32_16x16x32_bf16 v[196:199], a[92:95], v[48:51], 0
  v_exp_f32 v128, v128
  v_exp_f32 v129, v129
  v_cvt_pk_bf16_f32 v122, v124, v125
  v_mfma_f32_16x16x32_bf16 v[200:203], v[204:207], v[48:51], 0
  v_exp_f32 v130, v130
  v_exp_f32 v131, v131
  v_cvt_pk_bf16_f32 v123, v126, v127
  v_exp_f32 v132, v132
  v_mfma_f32_16x16x32_bf16 v[192:195], a[96:99], v[52:55], v[192:195]
  v_exp_f32 v133, v133
  v_cvt_pk_bf16_f32 v124, v128, v129
  v_exp_f32 v134, v134
  v_mfma_f32_16x16x32_bf16 v[196:199], a[100:103], v[52:55], v[196:199]
  v_exp_f32 v135, v135
  v_cvt_pk_bf16_f32 v125, v130, v131
  v_exp_f32 v136, v136
  v_exp_f32 v137, v137
  v_mfma_f32_16x16x32_bf16 v[200:203], v[204:207], v[52:55], v[200:203]
  v_cvt_pk_bf16_f32 v126, v132, v133
  v_exp_f32 v138, v138
  v_exp_f32 v139, v139
  v_mfma_f32_16x16x32_bf16 v[192:195], a[104:107], v[56:59], v[192:195]
  v_cvt_pk_bf16_f32 v127, v134, v135
  v_exp_f32 v140, v140
  v_exp_f32 v141, v141
  v_mfma_f32_16x16x32_bf16 v[196:199], a[108:111], v[56:59], v[196:199]
  v_cvt_pk_bf16_f32 v128, v136, v137
  v_exp_f32 v142, v142
  v_exp_f32 v143, v143
  v_cvt_pk_bf16_f32 v129, v138, v139
  v_mfma_f32_16x16x32_bf16 v[200:203], v[204:207], v[56:59], v[200:203]
  v_exp_f32 v144, v144
  v_exp_f32 v145, v145
  v_cvt_pk_bf16_f32 v130, v140, v141
  v_mfma_f32_16x16x32_bf16 v[192:195], a[112:115], v[60:63], v[192:195]
  v_exp_f32 v146, v146
  v_exp_f32 v147, v147
  v_cvt_pk_bf16_f32 v131, v142, v143
  v_exp_f32 v148, v148
  v_mfma_f32_16x16x32_bf16 v[196:199], a[116:119], v[60:63], v[196:199]
  v_exp_f32 v149, v149
  v_cvt_pk_bf16_f32 v132, v144, v145
  v_exp_f32 v150, v150
  v_mfma_f32_16x16x32_bf16 v[200:203], v[204:207], v[60:63], v[200:203]
  v_exp_f32 v151, v151
  v_cvt_pk_bf16_f32 v133, v146, v147
  v_exp_f32 v152, v152
  v_mfma_f32_16x16x32_bf16 v[192:195], a[120:123], v[64:67], v[192:195]
  v_exp_f32 v153, v153
  v_cvt_pk_bf16_f32 v134, v148, v149
  v_exp_f32 v154, v154
  v_exp_f32 v155, v155
  v_mfma_f32_16x16x32_bf16 v[196:199], a[124:127], v[64:67], v[196:199]
  v_cvt_pk_bf16_f32 v135, v150, v151
  v_exp_f32 v156, v156
  v_exp_f32 v157, v157
  v_mfma_f32_16x16x32_bf16 v[200:203], v[204:207], v[64:67], v[200:203]
  v_cvt_pk_bf16_f32 v136, v152, v153
  v_exp_f32 v158, v158
  v_exp_f32 v159, v159
  v_cvt_pk_bf16_f32 v137, v154, v155
  v_mfma_f32_16x16x32_bf16 v[192:195], a[128:131], v[68:71], v[192:195]
  v_exp_f32 v160, v160
  v_exp_f32 v161, v161
  v_cvt_pk_bf16_f32 v138, v156, v157
  v_mfma_f32_16x16x32_bf16 v[196:199], a[132:135], v[68:71], v[196:199]
  v_exp_f32 v162, v162
  v_exp_f32 v163, v163
  v_cvt_pk_bf16_f32 v139, v158, v159
  v_mfma_f32_16x16x32_bf16 v[200:203], v[204:207], v[68:71], v[200:203]
  v_exp_f32 v164, v164
  v_exp_f32 v165, v165
  v_cvt_pk_bf16_f32 v140, v160, v161
  v_exp_f32 v166, v166
  v_mfma_f32_16x16x32_bf16 v[192:195], a[136:139], v[72:75], v[192:195]
  v_exp_f32 v167, v167
  v_cvt_pk_bf16_f32 v141, v162, v163
  v_exp_f32 v168, v168
  v_mfma_f32_16x16x32_bf16 v[196:199], a[140:143], v[72:75], v[196:199]
  v_exp_f32 v169, v169
  v_cvt_pk_bf16_f32 v142, v164, v165
  v_exp_f32 v170, v170
  v_exp_f32 v171, v171
  v_mfma_f32_16x16x32_bf16 v[200:203], v[204:207], v[72:75], v[200:203]
  v_cvt_pk_bf16_f32 v143, v166, v167
  v_exp_f32 v172, v172
  v_exp_f32 v173, v173
  v_mfma_f32_16x16x32_bf16 v[192:195], a[144:147], v[76:79], v[192:195]
  v_cvt_pk_bf16_f32 v144, v168, v169
  v_exp_f32 v174, v174
  v_exp_f32 v175, v175
  v_mfma_f32_16x16x32_bf16 v[196:199], a[148:151], v[76:79], v[196:199]
  v_cvt_pk_bf16_f32 v145, v170, v171
  v_exp_f32 v176, v176
  v_exp_f32 v177, v177
  v_cvt_pk_bf16_f32 v146, v172, v173
  v_mfma_f32_16x16x32_bf16 v[200:203], v[204:207], v[76:79], v[200:203]
  v_exp_f32 v178, v178
  v_exp_f32 v179, v179
  v_cvt_pk_bf16_f32 v147, v174, v175
  v_mfma_f32_16x16x32_bf16 v[192:195], a[152:155], v[80:83], v[192:195]
  v_exp_f32 v180, v180
  v_exp_f32 v181, v181
  v_cvt_pk_bf16_f32 v148, v176, v177
  v_exp_f32 v182, v182
  v_mfma_f32_16x16x32_bf16 v[196:199], a[156:159], v[80:83], v[196:199]
  v_exp_f32 v183, v183
  v_cvt_pk_bf16_f32 v149, v178, v179
  v_exp_f32 v184, v184
  v_mfma_f32_16x16x32_bf16 v[200:203], v[204:207], v[80:83], v[200:203]
  v_exp_f32 v185, v185
  v_cvt_pk_bf16_f32 v150, v180, v181
  v_exp_f32 v186, v186
  v_exp_f32 v187, v187
  v_cvt_pk_bf16_f32 v151, v182, v183
  v_exp_f32 v188, v188
  v_exp_f32 v189, v189
  v_cvt_pk_bf16_f32 v152, v184, v185
  v_exp_f32 v190, v190
  v_exp_f32 v191, v191
  v_cvt_pk_bf16_f32 v153, v186, v187
  v_rcp_f32 v4, v200
  s_nop 0
  v_mul_f32 v192, v192, v4
  v_mul_f32 v193, v193, v4
  v_mul_f32 v194, v194, v4
  v_mul_f32 v195, v195, v4
  v_mul_f32 v196, v196, v4
  v_mul_f32 v197, v197, v4
  v_mul_f32 v198, v198, v4
  v_mul_f32 v199, v199, v4
  v_cvt_pk_bf16_f32 v28, v192, v193
  v_cvt_pk_bf16_f32 v29, v194, v195
  v_cvt_pk_bf16_f32 v30, v196, v197
  v_cvt_pk_bf16_f32 v31, v198, v199
  s_nop 1
  v_permlane16_swap_b32 v28, v30
  v_permlane16_swap_b32 v29, v31
  buffer_store_dwordx4 v[28:31], v22, s[20:23], s34 offen offset:0 sc1
  v_cvt_pk_bf16_f32 v154, v188, v189
  v_cvt_pk_bf16_f32 v155, v190, v191
  v_mov_b32 v120, 0
  v_mov_b32 v121, 0
  s_waitcnt vmcnt(2)
  v_cmp_eq_u64 vcc, s[46:47], v[26:27]
  s_cmp_eq_u64 vcc, exec
  s_cbranch_scc1 L_polld32
  s_mov_b32 s63, 0x40000
L_poll31:
  buffer_load_dwordx2 v[26:27], v0, s[72:75], s99 offen offset:512 sc1
  s_waitcnt vmcnt(0)
  v_cmp_eq_u64 vcc, s[46:47], v[26:27]
  s_cmp_eq_u64 vcc, exec
  s_cbranch_scc1 L_polld32
  s_sleep 1
  s_sub_u32 s63, s63, 1
  s_cmp_lg_u32 s63, 0
  s_cbranch_scc1 L_poll31
L_polld32:
  buffer_load_dwordx4 a[160:163], v1, s[8:11], s31 offen offset:0 sc1
  buffer_load_dwordx4 a[164:167], v1, s[8:11], s31 offen offset:1024 sc1
  buffer_load_dwordx4 a[168:171], v1, s[8:11], s31 offen offset:2048 sc1
  buffer_load_dwordx4 a[172:175], v1, s[8:11], s31 offen offset:3072 sc1
  s_add_u32 s31, s31, 4096
  s_cmp_eq_u32 s31, 114688
  s_cselect_b32 s31, 0, s31
  s_add_u32 s32, s32, 1
  s_cmp_eq_u32 s32, 28
  s_cselect_b32 s31, s35, s31
  buffer_load_dwordx4 a[176:179], v1, s[8:11], s31 offen offset:0 sc1
  buffer_load_dwordx4 a[180:183], v1, s[8:11], s31 offen offset:1024 sc1
  s_mov_b32 s3, 0xffff0000
  v_mfma_f32_16x16x32_bf16 v[192:195], a[88:91], v[120:123], 0
  v_lshlrev_b32 v112, 16, v248
  v_and_b32 v113, s3, v248
  v_lshlrev_b32 v114, 16, v249
  v_and_b32 v115, s3, v249
  v_mfma_f32_16x16x32_bf16 v[196:199], a[92:95], v[120:123], 0
  v_lshlrev_b32 v48, 16, v232
  v_and_b32 v49, s3, v232
  v_lshlrev_b32 v50, 16, v233
  v_and_b32 v51, s3, v233
  v_mfma_f32_16x16x32_bf16 v[200:203], v[204:207], v[120:123], 0
  v_add_f32 v48, v48, v112
  v_add_f32 v49, v49, v113
  v_add_f32 v50, v50, v114
  v_add_f32 v51, v51, v115
  v_mfma_f32_16x16x32_bf16 v[192:195], a[96:99], v[124:127], v[192:195]
  v_lshlrev_b32 v52, 16, v234
  v_and_b32 v53, s3, v234
  v_lshlrev_b32 v54, 16, v235
  v_and_b32 v55, s3, v235
  v_mfma_f32_16x16x32_bf16 v[196:199], a[100:103], v[124:127], v[196:199]
  v_add_f32 v52, v52, v112
  v_add_f32 v53, v53, v113
  v_add_f32 v54, v54, v114
  v_mfma_f32_16x16x32_bf16 v[200:203], v[204:207], v[124:127], v[200:203]
  v_add_f32 v55, v55, v115
  v_lshlrev_b32 v112, 16, v250
  v_and_b32 v113, s3, v250
  v_lshlrev_b32 v114, 16, v251
  v_mfma_f32_16x16x32_bf16 v[192:195], a[104:107], v[128:131], v[192:195]
  v_and_b32 v115, s3, v251
  v_lshlrev_b32 v56, 16, v236
  v_and_b32 v57, s3, v236
  v_lshlrev_b32 v58, 16, v237
  v_mfma_f32_16x16x32_bf16 v[196:199], a[108:111], v[128:131], v[196:199]
  v_and_b32 v59, s3, v237
  v_add_f32 v56, v56, v112
  v_add_f32 v57, v57, v113
  v_add_f32 v58, v58, v114
  v_mfma_f32_16x16x32_bf16 v[200:203], v[204:207], v[128:131], v[200:203]
  v_add_f32 v59, v59, v115
  v_lshlrev_b32 v60, 16, v238
  v_and_b32 v61, s3, v238
  v_mfma_f32_16x16x32_bf16 v[192:195], a[112:115], v[132:135], v[192:195]
  v_lshlrev_b32 v62, 16, v239
  v_and_b32 v63, s3, v239
  v_add_f32 v60, v60, v112
  v_add_f32 v61, v61, v113
  v_mfma_f32_16x16x32_bf16 v[196:199], a[116:119], v[132:135], v[196:199]
  v_add_f32 v62, v62, v114
  v_add_f32 v63, v63, v115
  v_lshlrev_b32 v112, 16, v252
  v_and_b32 v113, s3, v252
  v_mfma_f32_16x16x32_bf16 v[200:203], v[204:207], v[132:135], v[200:203]
  v_lshlrev_b32 v114, 16, v253
  v_and_b32 v115, s3, v253
  v_lshlrev_b32 v64, 16, v240
  v_and_b32 v65, s3, v240
  v_mfma_f32_16x16x32_bf16 v[192:195], a[120:123], v[136:139], v[192:195]
  v_lshlrev_b32 v66, 16, v241
  v_and_b32 v67, s3, v241
  v_add_f32 v64, v64, v112
  v_add_f32 v65, v65, v113
  v_mfma_f32_16x16x32_bf16 v[196:199], a[124:127], v[136:139], v[196:199]
  v_add_f32 v66, v66, v114
  v_add_f32 v67, v67, v115
  v_lshlrev_b32 v68, 16, v242
  v_mfma_f32_16x16x32_bf16 v[200:203], v[204:207], v[136:139], v[200:203]
  v_and_b32 v69, s3, v242
  v_lshlrev_b32 v70, 16, v243
  v_and_b32 v71, s3, v243
  v_add_f32 v68, v68, v112
  v_mfma_f32_16x16x32_bf16 v[192:195], a[128:131], v[140:143], v[192:195]
  v_add_f32 v69, v69, v113
  v_add_f32 v70, v70, v114
  v_add_f32 v71, v71, v115
  v_lshlrev_b32 v112, 16, v254
  v_mfma_f32_16x16x32_bf16 v[196:199], a[132:135], v[140:143], v[196:199]
  v_and_b32 v113, s3, v254
  v_lshlrev_b32 v114, 16, v255
  v_and_b32 v115, s3, v255
  v_lshlrev_b32 v72, 16, v244
  v_mfma_f32_16x16x32_bf16 v[200:203], v[204:207], v[140:143], v[200:203]
  v_and_b32 v73, s3, v244
  v_lshlrev_b32 v74, 16, v245
  v_and_b32 v75, s3, v245
  v_mfma_f32_16x16x32_bf16 v[192:195], a[136:139], v[144:147], v[192:195]
  v_add_f32 v72, v72, v112
  v_add_f32 v73, v73, v113
  v_add_f32 v74, v74, v114
  v_add_f32 v75, v75, v115
  v_mfma_f32_16x16x32_bf16 v[196:199], a[140:143], v[144:147], v[196:199]
  v_lshlrev_b32 v76, 16, v246
  v_and_b32 v77, s3, v246
  v_lshlrev_b32 v78, 16, v247
  v_and_b32 v79, s3, v247
  v_mfma_f32_16x16x32_bf16 v[200:203], v[204:207], v[144:147], v[200:203]
  v_add_f32 v76, v76, v112
  v_add_f32 v77, v77, v113
  v_add_f32 v78, v78, v114
  v_add_f32 v79, v79, v115
  v_mfma_f32_16x16x32_bf16 v[192:195], a[144:147], v[148:151], v[192:195]
  v_mov_b32 v80, 0
  v_mov_b32 v81, 0
  v_mov_b32 v82, 0
  v_mov_b32 v83, 0
  v_mfma_f32_16x16x32_bf16 v[196:199], a[148:151], v[148:151], v[196:199]
  v_mov_b32 v84, 0
  v_mov_b32 v85, 0
  v_mov_b32 v86, 0
  v_mfma_f32_16x16x32_bf16 v[200:203], v[204:207], v[148:151], v[200:203]
  v_mov_b32 v87, 0
  v_mov_b32 v88, 0
  v_mov_b32 v89, 0
  v_mov_b32 v90, 0
  v_mfma_f32_16x16x32_bf16 v[192:195], a[152:155], v[152:155], v[192:195]
  v_mov_b32 v91, 0
  v_mov_b32 v92, 0
  v_mov_b32 v93, 0
  v_mov_b32 v94, 0
  v_mfma_f32_16x16x32_bf16 v[196:199], a[156:159], v[152:155], v[196:199]
  v_mov_b32 v95, 0
  v_mov_b32 v96, 0
  v_mov_b32 v97, 0
  v_mov_b32 v98, 0
  v_mfma_f32_16x16x32_bf16 v[200:203], v[204:207], v[152:155], v[200:203]
  v_mov_b32 v99, 0
  v_mov_b32 v100, 0
  v_mov_b32 v101, 0
  v_mov_b32 v102, 0
  v_mov_b32 v103, 0
  v_mov_b32 v104, 0
  v_mov_b32 v105, 0
  v_mov_b32 v106, 0
  v_mov_b32 v107, 0
  v_mov_b32 v108, 0
  v_mov_b32 v109, 0
  v_mov_b32 v110, 0
  v_mov_b32 v111, 0
  v_rcp_f32 v4, v200
  s_nop 0
  v_mul_f32 v192, v192, v4
  v_mul_f32 v193, v193, v4
  v_mul_f32 v194, v194, v4
  v_mul_f32 v195, v195, v4
  v_mul_f32 v196, v196, v4
  v_mul_f32 v197, v197, v4
  v_mul_f32 v198, v198, v4
  v_mul_f32 v199, v199, v4
  v_cvt_pk_bf16_f32 v28, v192, v193
  v_cvt_pk_bf16_f32 v29, v194, v195
  v_cvt_pk_bf16_f32 v30, v196, v197
  v_cvt_pk_bf16_f32 v31, v198, v199
  s_nop 1
  v_permlane16_swap_b32 v28, v30
  v_permlane16_swap_b32 v29, v31
  buffer_store_dwordx4 v[28:31], v22, s[20:23], s34 offen offset:1024 sc1
  v_xor_b32 v4, 128, v10
  v_xor_b32 v5, 128, v11
  v_xor_b32 v6, 128, v12
  v_xor_b32 v7, 128, v13
  s_add_u32 s12, s60, 41943040
  s_addc_u32 s13, s61, 0
  s_mov_b32 s14, 8388608
  s_mov_b32 s15, 0x20000
  s_lshl_b32 s33, s99, 4
  s_lshl_b32 s3, s30, 13
  s_add_u32 s33, s33, s3
  s_add_u32 s33, s33, 4096
  ds_read_b64_tr_b16 v[112:113], v10 offset:0
  ds_read_b64_tr_b16 v[114:115], v10 offset:1024
  ds_read_b64_tr_b16 v[116:117], v11 offset:0
  ds_read_b64_tr_b16 v[118:119], v11 offset:1024
  ds_read_b64_tr_b16 v[120:121], v12 offset:0
  ds_read_b64_tr_b16 v[122:123], v12 offset:1024
  ds_read_b64_tr_b16 v[124:125], v13 offset:0
  ds_read_b64_tr_b16 v[126:127], v13 offset:1024
  ds_read_b64_tr_b16 v[128:129], v4 offset:0
  ds_read_b64_tr_b16 v[130:131], v4 offset:1024
  ds_read_b64_tr_b16 v[132:133], v5 offset:0
  ds_read_b64_tr_b16 v[134:135], v5 offset:1024
  ds_read_b64_tr_b16 v[136:137], v6 offset:0
  ds_read_b64_tr_b16 v[138:139], v6 offset:1024
  ds_read_b64_tr_b16 v[140:141], v7 offset:0
  ds_read_b64_tr_b16 v[142:143], v7 offset:1024
  s_mov_b32 s37, 9
  s_add_u32 s26, s35, 16384
  s_add_u32 s27, s26, 8192
L_g2_loop:
  s_cmp_lg_u32 s37, 9
  s_cbranch_scc1 L_w53
  s_waitcnt vmcnt(5)
L_w53:
  s_waitcnt vmcnt(10) lgkmcnt(10)
  s_cmp_lg_u32 s37, 3
  s_cbranch_scc1 L_ofl54
  buffer_load_dwordx2 v[28:29], v0, s[72:75], s99 offen offset:768 sc1
L_ofl54:
  v_mfma_f32_16x16x32_bf16 v[48:51], v[112:115], a[160:163], v[48:51]
  buffer_load_dwordx4 a[184:187], v1, s[8:11], s31 offen offset:2048 sc1
  v_mfma_f32_16x16x32_bf16 v[52:55], v[112:115], a[164:167], v[52:55]
  ds_read_b64_tr_b16 v[112:113], v10 offset:8192
  ds_read_b64_tr_b16 v[114:115], v10 offset:9216
  v_mfma_f32_16x16x32_bf16 v[60:63], v[116:119], a[164:167], v[60:63]
  buffer_load_dwordx4 a[188:191], v1, s[8:11], s31 offen offset:3072 sc1
  s_add_u32 m0, s39, 51200
  v_mfma_f32_16x16x32_bf16 v[56:59], v[116:119], a[160:163], v[56:59]
  ds_read_b64_tr_b16 v[116:117], v11 offset:8192
  ds_read_b64_tr_b16 v[118:119], v11 offset:9216
  v_mfma_f32_16x16x32_bf16 v[64:67], v[120:123], a[160:163], v[64:67]
  buffer_load_dwordx4 v20, s[4:7], s38 offen lds
  v_mfma_f32_16x16x32_bf16 v[68:71], v[120:123], a[164:167], v[68:71]
  ds_read_b64_tr_b16 v[120:121], v12 offset:8192
  ds_read_b64_tr_b16 v[122:123], v12 offset:9216
  s_waitcnt lgkmcnt(10)
  v_mfma_f32_16x16x32_bf16 v[76:79], v[124:127], a[164:167], v[76:79]
  s_add_u32 m0, s39, 52224
  v_mfma_f32_16x16x32_bf16 v[72:75], v[124:127], a[160:163], v[72:75]
  ds_read_b64_tr_b16 v[124:125], v13 offset:8192
  ds_read_b64_tr_b16 v[126:127], v13 offset:9216
  v_mfma_f32_16x16x32_bf16 v[80:83], v[128:131], a[160:163], v[80:83]
  buffer_load_dwordx4 v21, s[4:7], s38 offen lds
  v_mfma_f32_16x16x32_bf16 v[84:87], v[128:131], a[164:167], v[84:87]
  ds_read_b64_tr_b16 v[128:129], v4 offset:8192
  ds_read_b64_tr_b16 v[130:131], v4 offset:9216
  v_mfma_f32_16x16x32_bf16 v[92:95], v[132:135], a[164:167], v[92:95]
  s_add_u32 s38, s38, 131072
  s_cmp_eq_u32 s38, 3670016
  s_cselect_b32 s38, 0, s38
  v_mfma_f32_16x16x32_bf16 v[88:91], v[132:135], a[160:163], v[88:91]
  ds_read_b64_tr_b16 v[132:133], v5 offset:8192
  ds_read_b64_tr_b16 v[134:135], v5 offset:9216
  s_waitcnt lgkmcnt(12)
  v_mfma_f32_16x16x32_bf16 v[96:99], v[136:139], a[160:163], v[96:99]
  s_add_u32 s77, s77, 1
  s_cmp_eq_u32 s77, 28
  s_cselect_b32 s4, s44, s4
  s_cselect_b32 s5, s45, s5
  s_cselect_b32 s6, 0x100000, s6
  s_cselect_b32 s38, 0, s38
  v_mfma_f32_16x16x32_bf16 v[100:103], v[136:139], a[164:167], v[100:103]
  ds_read_b64_tr_b16 v[136:137], v6 offset:8192
  ds_read_b64_tr_b16 v[138:139], v6 offset:9216
  v_mfma_f32_16x16x32_bf16 v[108:111], v[140:143], a[164:167], v[108:111]
  s_add_u32 s31, s31, 4096
  s_cmp_eq_u32 s31, 114688
  s_cselect_b32 s31, 0, s31
  s_add_u32 s32, s32, 1
  s_cmp_eq_u32 s32, 28
  s_cselect_b32 s31, s35, s31
  v_mfma_f32_16x16x32_bf16 v[104:107], v[140:143], a[160:163], v[104:107]
  ds_read_b64_tr_b16 v[140:141], v7 offset:8192
  ds_read_b64_tr_b16 v[142:143], v7 offset:9216
  s_cmp_lg_u32 s37, 9
  s_cbranch_scc1 L_w55
  s_waitcnt vmcnt(7)
L_w55:
  s_waitcnt vmcnt(10) lgkmcnt(10)
  v_mfma_f32_16x16x32_bf16 v[48:51], v[112:115], a[168:171], v[48:51]
  buffer_load_dwordx4 a[192:195], v1, s[8:11], s31 offen offset:0 sc1
  v_mfma_f32_16x16x32_bf16 v[52:55], v[112:115], a[172:175], v[52:55]
  v_mfma_f32_16x16x32_bf16 v[60:63], v[116:119], a[172:175], v[60:63]
  buffer_load_dwordx4 a[196:199], v1, s[8:11], s31 offen offset:1024 sc1
  v_mfma_f32_16x16x32_bf16 v[56:59], v[116:119], a[168:171], v[56:59]
  s_waitcnt lgkmcnt(0)
  s_barrier
  v_mfma_f32_16x16x32_bf16 v[64:67], v[120:123], a[168:171], v[64:67]
  ds_read_b64_tr_b16 v[112:113], v10 offset:16384
  ds_read_b64_tr_b16 v[114:115], v10 offset:17408
  v_mfma_f32_16x16x32_bf16 v[68:71], v[120:123], a[172:175], v[68:71]
  ds_read_b64_tr_b16 v[116:117], v11 offset:16384
  ds_read_b64_tr_b16 v[118:119], v11 offset:17408
  v_mfma_f32_16x16x32_bf16 v[76:79], v[124:127], a[172:175], v[76:79]
  ds_read_b64_tr_b16 v[120:121], v12 offset:16384
  ds_read_b64_tr_b16 v[122:123], v12 offset:17408
  s_add_u32 m0, s39, 0
  v_mfma_f32_16x16x32_bf16 v[72:75], v[124:127], a[168:171], v[72:75]
  ds_read_b64_tr_b16 v[124:125], v13 offset:16384
  ds_read_b64_tr_b16 v[126:127], v13 offset:17408
  v_mfma_f32_16x16x32_bf16 v[80:83], v[128:131], a[168:171], v[80:83]
  buffer_load_dwordx4 v18, s[4:7], s38 offen lds
  v_mfma_f32_16x16x32_bf16 v[84:87], v[128:131], a[172:175], v[84:87]
  ds_read_b64_tr_b16 v[128:129], v4 offset:16384
  ds_read_b64_tr_b16 v[130:131], v4 offset:17408
  v_mfma_f32_16x16x32_bf16 v[92:95], v[132:135], a[172:175], v[92:95]
  s_add_u32 m0, s39, 1024
  v_mfma_f32_16x16x32_bf16 v[88:91], v[132:135], a[168:171], v[88:91]
  ds_read_b64_tr_b16 v[132:133], v5 offset:16384
  ds_read_b64_tr_b16 v[134:135], v5 offset:17408
  v_mfma_f32_16x16x32_bf16 v[96:99], v[136:139], a[168:171], v[96:99]
  buffer_load_dwordx4 v19, s[4:7], s38 offen lds
  v_mfma_f32_16x16x32_bf16 v[100:103], v[136:139], a[172:175], v[100:103]
  ds_read_b64_tr_b16 v[136:137], v6 offset:16384
  ds_read_b64_tr_b16 v[138:139], v6 offset:17408
  v_mfma_f32_16x16x32_bf16 v[108:111], v[140:143], a[172:175], v[108:111]
  v_mfma_f32_16x16x32_bf16 v[104:107], v[140:143], a[168:171], v[104:107]
  ds_read_b64_tr_b16 v[140:141], v7 offset:16384
  ds_read_b64_tr_b16 v[142:143], v7 offset:17408
  s_cmp_lg_u32 s37, 9
  s_cbranch_scc1 L_w56
  s_waitcnt vmcnt(9)
L_w56:
  s_waitcnt vmcnt(10) lgkmcnt(10)
  v_mfma_f32_16x16x32_bf16 v[48:51], v[112:115], a[176:179], v[48:51]
  buffer_load_dwordx4 a[200:203], v1, s[8:11], s31 offen offset:2048 sc1
  v_mfma_f32_16x16x32_bf16 v[52:55], v[112:115], a[180:183], v[52:55]
  ds_read_b64_tr_b16 v[112:113], v10 offset:24576
  ds_read_b64_tr_b16 v[114:115], v10 offset:25600
  v_mfma_f32_16x16x32_bf16 v[60:63], v[116:119], a[180:183], v[60:63]
  buffer_load_dwordx4 a[204:207], v1, s[8:11], s31 offen offset:3072 sc1
  s_add_u32 m0, s39, 2048
  v_mfma_f32_16x16x32_bf16 v[56:59], v[116:119], a[176:179], v[56:59]
  ds_read_b64_tr_b16 v[116:117], v11 offset:24576
  ds_read_b64_tr_b16 v[118:119], v11 offset:25600
  v_mfma_f32_16x16x32_bf16 v[64:67], v[120:123], a[176:179], v[64:67]
  buffer_load_dwordx4 v20, s[4:7], s38 offen lds
  v_mfma_f32_16x16x32_bf16 v[68:71], v[120:123], a[180:183], v[68:71]
  ds_read_b64_tr_b16 v[120:121], v12 offset:24576
  ds_read_b64_tr_b16 v[122:123], v12 offset:25600
  s_waitcnt lgkmcnt(10)
  v_mfma_f32_16x16x32_bf16 v[76:79], v[124:127], a[180:183], v[76:79]
  s_add_u32 m0, s39, 3072
  v_mfma_f32_16x16x32_bf16 v[72:75], v[124:127], a[176:179], v[72:75]
  ds_read_b64_tr_b16 v[124:125], v13 offset:24576
  ds_read_b64_tr_b16 v[126:127], v13 offset:25600
  v_mfma_f32_16x16x32_bf16 v[80:83], v[128:131], a[176:179], v[80:83]
  buffer_load_dwordx4 v21, s[4:7], s38 offen lds
  v_mfma_f32_16x16x32_bf16 v[84:87], v[128:131], a[180:183], v[84:87]
  ds_read_b64_tr_b16 v[128:129], v4 offset:24576
  ds_read_b64_tr_b16 v[130:131], v4 offset:25600
  v_mfma_f32_16x16x32_bf16 v[92:95], v[132:135], a[180:183], v[92:95]
  s_add_u32 s38, s38, 131072
  s_cmp_eq_u32 s38, 3670016
  s_cselect_b32 s38, 0, s38
  v_mfma_f32_16x16x32_bf16 v[88:91], v[132:135], a[176:179], v[88:91]
  ds_read_b64_tr_b16 v[132:133], v5 offset:24576
  ds_read_b64_tr_b16 v[134:135], v5 offset:25600
  s_waitcnt lgkmcnt(12)
  v_mfma_f32_16x16x32_bf16 v[96:99], v[136:139], a[176:179], v[96:99]
  s_add_u32 s77, s77, 1
  s_cmp_eq_u32 s77, 28
  s_cselect_b32 s4, s44, s4
  s_cselect_b32 s5, s45, s5
  s_cselect_b32 s6, 0x100000, s6
  s_cselect_b32 s38, 0, s38
  v_mfma_f32_16x16x32_bf16 v[100:103], v[136:139], a[180:183], v[100:103]
  ds_read_b64_tr_b16 v[136:137], v6 offset:24576
  ds_read_b64_tr_b16 v[138:139], v6 offset:25600
  v_mfma_f32_16x16x32_bf16 v[108:111], v[140:143], a[180:183], v[108:111]
  s_add_u32 s31, s31, 4096
  s_cmp_eq_u32 s31, 114688
  s_cselect_b32 s31, 0, s31
  s_add_u32 s32, s32, 1
  s_cmp_eq_u32 s32, 28
  s_cselect_b32 s31, s35, s31
  v_mfma_f32_16x16x32_bf16 v[104:107], v[140:143], a[176:179], v[104:107]
  ds_read_b64_tr_b16 v[140:141], v7 offset:24576
  ds_read_b64_tr_b16 v[142:143], v7 offset:25600
  s_waitcnt vmcnt(10) lgkmcnt(10)
  v_mfma_f32_16x16x32_bf16 v[48:51], v[112:115], a[184:187], v[48:51]
  buffer_load_dwordx4 a[208:211], v1, s[8:11], s31 offen offset:0 sc1
  v_mfma_f32_16x16x32_bf16 v[52:55], v[112:115], a[188:191], v[52:55]
  v_mfma_f32_16x16x32_bf16 v[60:63], v[116:119], a[188:191], v[60:63]
  buffer_load_dwordx4 a[212:215], v1, s[8:11], s31 offen offset:1024 sc1
  v_mfma_f32_16x16x32_bf16 v[56:59], v[116:119], a[184:187], v[56:59]
  s_waitcnt lgkmcnt(0)
  s_barrier
  v_mfma_f32_16x16x32_bf16 v[64:67], v[120:123], a[184:187], v[64:67]
  ds_read_b64_tr_b16 v[112:113], v10 offset:32768
  ds_read_b64_tr_b16 v[114:115], v10 offset:33792
  v_mfma_f32_16x16x32_bf16 v[68:71], v[120:123], a[188:191], v[68:71]
  ds_read_b64_tr_b16 v[116:117], v11 offset:32768
  ds_read_b64_tr_b16 v[118:119], v11 offset:33792
  v_mfma_f32_16x16x32_bf16 v[76:79], v[124:127], a[188:191], v[76:79]
  ds_read_b64_tr_b16 v[120:121], v12 offset:32768
  ds_read_b64_tr_b16 v[122:123], v12 offset:33792
  s_add_u32 m0, s39, 16384
  v_mfma_f32_16x16x32_bf16 v[72:75], v[124:127], a[184:187], v[72:75]
  ds_read_b64_tr_b16 v[124:125], v13 offset:32768
  ds_read_b64_tr_b16 v[126:127], v13 offset:33792
  v_mfma_f32_16x16x32_bf16 v[80:83], v[128:131], a[184:187], v[80:83]
  buffer_load_dwordx4 v18, s[4:7], s38 offen lds
  v_mfma_f32_16x16x32_bf16 v[84:87], v[128:131], a[188:191], v[84:87]
  ds_read_b64_tr_b16 v[128:129], v4 offset:32768
  ds_read_b64_tr_b16 v[130:131], v4 offset:33792
  v_mfma_f32_16x16x32_bf16 v[92:95], v[132:135], a[188:191], v[92:95]
  s_add_u32 m0, s39, 17408
  v_mfma_f32_16x16x32_bf16 v[88:91], v[132:135], a[184:187], v[88:91]
  ds_read_b64_tr_b16 v[132:133], v5 offset:32768
  ds_read_b64_tr_b16 v[134:135], v5 offset:33792
  v_mfma_f32_16x16x32_bf16 v[96:99], v[136:139], a[184:187], v[96:99]
  buffer_load_dwordx4 v19, s[4:7], s38 offen lds
  v_mfma_f32_16x16x32_bf16 v[100:103], v[136:139], a[188:191], v[100:103]
  ds_read_b64_tr_b16 v[136:137], v6 offset:32768
  ds_read_b64_tr_b16 v[138:139], v6 offset:33792
  v_mfma_f32_16x16x32_bf16 v[108:111], v[140:143], a[188:191], v[108:111]
  v_mfma_f32_16x16x32_bf16 v[104:107], v[140:143], a[184:187], v[104:107]
  ds_read_b64_tr_b16 v[140:141], v7 offset:32768
  ds_read_b64_tr_b16 v[142:143], v7 offset:33792
  s_waitcnt vmcnt(10) lgkmcnt(10)
  v_mfma_f32_16x16x32_bf16 v[48:51], v[112:115], a[192:195], v[48:51]
  buffer_load_dwordx4 a[216:219], v1, s[8:11], s31 offen offset:2048 sc1
  v_mfma_f32_16x16x32_bf16 v[52:55], v[112:115], a[196:199], v[52:55]
  ds_read_b64_tr_b16 v[112:113], v10 offset:40960
  ds_read_b64_tr_b16 v[114:115], v10 offset:41984
  v_mfma_f32_16x16x32_bf16 v[60:63], v[116:119], a[196:199], v[60:63]
  buffer_load_dwordx4 a[220:223], v1, s[8:11], s31 offen offset:3072 sc1
  s_add_u32 m0, s39, 18432
  v_mfma_f32_16x16x32_bf16 v[56:59], v[116:119], a[192:195], v[56:59]
  ds_read_b64_tr_b16 v[116:117], v11 offset:40960
  ds_read_b64_tr_b16 v[118:119], v11 offset:41984
  v_mfma_f32_16x16x32_bf16 v[64:67], v[120:123], a[192:195], v[64:67]
  buffer_load_dwordx4 v20, s[4:7], s38 offen lds
  v_mfma_f32_16x16x32_bf16 v[68:71], v[120:123], a[196:199], v[68:71]
  ds_read_b64_tr_b16 v[120:121], v12 offset:40960
  ds_read_b64_tr_b16 v[122:123], v12 offset:41984
  s_waitcnt lgkmcnt(10)
  v_mfma_f32_16x16x32_bf16 v[76:79], v[124:127], a[196:199], v[76:79]
  s_add_u32 m0, s39, 19456
  v_mfma_f32_16x16x32_bf16 v[72:75], v[124:127], a[192:195], v[72:75]
  ds_read_b64_tr_b16 v[124:125], v13 offset:40960
  ds_read_b64_tr_b16 v[126:127], v13 offset:41984
  v_mfma_f32_16x16x32_bf16 v[80:83], v[128:131], a[192:195], v[80:83]
  buffer_load_dwordx4 v21, s[4:7], s38 offen lds
  v_mfma_f32_16x16x32_bf16 v[84:87], v[128:131], a[196:199], v[84:87]
  ds_read_b64_tr_b16 v[128:129], v4 offset:40960
  ds_read_b64_tr_b16 v[130:131], v4 offset:41984
  v_mfma_f32_16x16x32_bf16 v[92:95], v[132:135], a[196:199], v[92:95]
  s_add_u32 s38, s38, 131072
  s_cmp_eq_u32 s38, 3670016
  s_cselect_b32 s38, 0, s38
  v_mfma_f32_16x16x32_bf16 v[88:91], v[132:135], a[192:195], v[88:91]
  ds_read_b64_tr_b16 v[132:133], v5 offset:40960
  ds_read_b64_tr_b16 v[134:135], v5 offset:41984
  s_waitcnt lgkmcnt(12)
  v_mfma_f32_16x16x32_bf16 v[96:99], v[136:139], a[192:195], v[96:99]
  s_add_u32 s77, s77, 1
  s_cmp_eq_u32 s77, 28
  s_cselect_b32 s4, s44, s4
  s_cselect_b32 s5, s45, s5
  s_cselect_b32 s6, 0x100000, s6
  s_cselect_b32 s38, 0, s38
  v_mfma_f32_16x16x32_bf16 v[100:103], v[136:139], a[196:199], v[100:103]
  ds_read_b64_tr_b16 v[136:137], v6 offset:40960
  ds_read_b64_tr_b16 v[138:139], v6 offset:41984
  v_mfma_f32_16x16x32_bf16 v[108:111], v[140:143], a[196:199], v[108:111]
  s_add_u32 s31, s31, 4096
  s_cmp_eq_u32 s31, 114688
  s_cselect_b32 s31, 0, s31
  s_add_u32 s32, s32, 1
  s_cmp_eq_u32 s32, 28
  s_cselect_b32 s31, s35, s31
  v_mfma_f32_16x16x32_bf16 v[104:107], v[140:143], a[192:195], v[104:107]
  ds_read_b64_tr_b16 v[140:141], v7 offset:40960
  ds_read_b64_tr_b16 v[142:143], v7 offset:41984
  s_waitcnt vmcnt(10) lgkmcnt(10)
  s_cmp_lg_u32 s37, 3
  s_cbranch_scc1 L_g2skip57
  v_cmp_eq_u64 vcc, s[46:47], v[28:29]
  s_cmp_eq_u64 vcc, exec
  s_cbranch_scc1 L_polld59
  s_mov_b32 s63, 0x40000
L_poll58:
  buffer_load_dwordx2 v[28:29], v0, s[72:75], s99 offen offset:768 sc1
  s_waitcnt vmcnt(0)
  v_cmp_eq_u64 vcc, s[46:47], v[28:29]
  s_cmp_eq_u64 vcc, exec
  s_cbranch_scc1 L_polld59
  s_sleep 1
  s_sub_u32 s63, s63, 1
  s_cmp_lg_u32 s63, 0
  s_cbranch_scc1 L_poll58
L_polld59:
L_g2skip57:
  v_mfma_f32_16x16x32_bf16 v[48:51], v[112:115], a[200:203], v[48:51]
  buffer_load_dwordx4 a[160:163], v1, s[8:11], s31 offen offset:0 sc1
  v_mfma_f32_16x16x32_bf16 v[52:55], v[112:115], a[204:207], v[52:55]
  v_mfma_f32_16x16x32_bf16 v[60:63], v[116:119], a[204:207], v[60:63]
  buffer_load_dwordx4 a[164:167], v1, s[8:11], s31 offen offset:1024 sc1
  v_mfma_f32_16x16x32_bf16 v[56:59], v[116:119], a[200:203], v[56:59]
  s_waitcnt lgkmcnt(0)
  s_barrier
  s_cmp_lg_u32 s37, 9
  s_cbranch_scc1 L_opub60
  v_mov_b32 v24, s46
  v_mov_b32 v25, s47
  v_lshlrev_b32 v26, 12, v17
  s_mov_b64 exec, 0xff
  buffer_store_dwordx2 v[24:25], v26, s[72:75], s71 offen offset:768 sc1
  s_mov_b64 exec, -1
L_opub60:
  v_mfma_f32_16x16x32_bf16 v[64:67], v[120:123], a[200:203], v[64:67]
  ds_read_b64_tr_b16 v[112:113], v10 offset:49152
  ds_read_b64_tr_b16 v[114:115], v10 offset:50176
  v_mfma_f32_16x16x32_bf16 v[68:71], v[120:123], a[204:207], v[68:71]
  ds_read_b64_tr_b16 v[116:117], v11 offset:49152
  ds_read_b64_tr_b16 v[118:119], v11 offset:50176
  v_mfma_f32_16x16x32_bf16 v[76:79], v[124:127], a[204:207], v[76:79]
  ds_read_b64_tr_b16 v[120:121], v12 offset:49152
  ds_read_b64_tr_b16 v[122:123], v12 offset:50176
  s_add_u32 m0, s39, 32768
  v_mfma_f32_16x16x32_bf16 v[72:75], v[124:127], a[200:203], v[72:75]
  ds_read_b64_tr_b16 v[124:125], v13 offset:49152
  ds_read_b64_tr_b16 v[126:127], v13 offset:50176
  v_mfma_f32_16x16x32_bf16 v[80:83], v[128:131], a[200:203], v[80:83]
  buffer_load_dwordx4 v18, s[4:7], s38 offen lds
  v_mfma_f32_16x16x32_bf16 v[84:87], v[128:131], a[204:207], v[84:87]
  ds_read_b64_tr_b16 v[128:129], v4 offset:49152
  ds_read_b64_tr_b16 v[130:131], v4 offset:50176
  v_mfma_f32_16x16x32_bf16 v[92:95], v[132:135], a[204:207], v[92:95]
  s_add_u32 m0, s39, 33792
  v_mfma_f32_16x16x32_bf16 v[88:91], v[132:135], a[200:203], v[88:91]
  ds_read_b64_tr_b16 v[132:133], v5 offset:49152
  ds_read_b64_tr_b16 v[134:135], v5 offset:50176
  v_mfma_f32_16x16x32_bf16 v[96:99], v[136:139], a[200:203], v[96:99]
  buffer_load_dwordx4 v19, s[4:7], s38 offen lds
  v_mfma_f32_16x16x32_bf16 v[100:103], v[136:139], a[204:207], v[100:103]
  ds_read_b64_tr_b16 v[136:137], v6 offset:49152
  ds_read_b64_tr_b16 v[138:139], v6 offset:50176
  v_mfma_f32_16x16x32_bf16 v[108:111], v[140:143], a[204:207], v[108:111]
  v_mfma_f32_16x16x32_bf16 v[104:107], v[140:143], a[200:203], v[104:107]
  ds_read_b64_tr_b16 v[140:141], v7 offset:49152
  ds_read_b64_tr_b16 v[142:143], v7 offset:50176
  s_waitcnt vmcnt(10) lgkmcnt(10)
  v_mfma_f32_16x16x32_bf16 v[48:51], v[112:115], a[208:211], v[48:51]
  buffer_load_dwordx4 a[168:171], v1, s[8:11], s31 offen offset:2048 sc1
  v_mfma_f32_16x16x32_bf16 v[52:55], v[112:115], a[212:215], v[52:55]
  ds_read_b64_tr_b16 v[112:113], v10 offset:57344
  ds_read_b64_tr_b16 v[114:115], v10 offset:58368
  v_mfma_f32_16x16x32_bf16 v[60:63], v[116:119], a[212:215], v[60:63]
  buffer_load_dwordx4 a[172:175], v1, s[8:11], s31 offen offset:3072 sc1
  s_add_u32 m0, s39, 34816
  v_mfma_f32_16x16x32_bf16 v[56:59], v[116:119], a[208:211], v[56:59]
  ds_read_b64_tr_b16 v[116:117], v11 offset:57344
  ds_read_b64_tr_b16 v[118:119], v11 offset:58368
  v_mfma_f32_16x16x32_bf16 v[64:67], v[120:123], a[208:211], v[64:67]
  buffer_load_dwordx4 v20, s[4:7], s38 offen lds
  v_mfma_f32_16x16x32_bf16 v[68:71], v[120:123], a[212:215], v[68:71]
  ds_read_b64_tr_b16 v[120:121], v12 offset:57344
  ds_read_b64_tr_b16 v[122:123], v12 offset:58368
  s_waitcnt lgkmcnt(10)
  v_mfma_f32_16x16x32_bf16 v[76:79], v[124:127], a[212:215], v[76:79]
  s_add_u32 m0, s39, 35840
  v_mfma_f32_16x16x32_bf16 v[72:75], v[124:127], a[208:211], v[72:75]
  ds_read_b64_tr_b16 v[124:125], v13 offset:57344
  ds_read_b64_tr_b16 v[126:127], v13 offset:58368
  v_mfma_f32_16x16x32_bf16 v[80:83], v[128:131], a[208:211], v[80:83]
  buffer_load_dwordx4 v21, s[4:7], s38 offen lds
  v_mfma_f32_16x16x32_bf16 v[84:87], v[128:131], a[212:215], v[84:87]
  ds_read_b64_tr_b16 v[128:129], v4 offset:57344
  ds_read_b64_tr_b16 v[130:131], v4 offset:58368
  v_mfma_f32_16x16x32_bf16 v[92:95], v[132:135], a[212:215], v[92:95]
  s_add_u32 s38, s38, 131072
  s_cmp_eq_u32 s38, 3670016
  s_cselect_b32 s38, 0, s38
  v_mfma_f32_16x16x32_bf16 v[88:91], v[132:135], a[208:211], v[88:91]
  ds_read_b64_tr_b16 v[132:133], v5 offset:57344
  ds_read_b64_tr_b16 v[134:135], v5 offset:58368
  s_waitcnt lgkmcnt(12)
  v_mfma_f32_16x16x32_bf16 v[96:99], v[136:139], a[208:211], v[96:99]
  s_add_u32 s77, s77, 1
  s_cmp_eq_u32 s77, 28
  s_cselect_b32 s4, s44, s4
  s_cselect_b32 s5, s45, s5
  s_cselect_b32 s6, 0x100000, s6
  s_cselect_b32 s38, 0, s38
  v_mfma_f32_16x16x32_bf16 v[100:103], v[136:139], a[212:215], v[100:103]
  ds_read_b64_tr_b16 v[136:137], v6 offset:57344
  ds_read_b64_tr_b16 v[138:139], v6 offset:58368
  v_mfma_f32_16x16x32_bf16 v[108:111], v[140:143], a[212:215], v[108:111]
  s_add_u32 s31, s31, 4096
  s_cmp_eq_u32 s31, 114688
  s_cselect_b32 s31, 0, s31
  s_add_u32 s32, s32, 1
  s_cmp_eq_u32 s32, 28
  s_cselect_b32 s31, s35, s31
  v_mfma_f32_16x16x32_bf16 v[104:107], v[140:143], a[208:211], v[104:107]
  ds_read_b64_tr_b16 v[140:141], v7 offset:57344
  ds_read_b64_tr_b16 v[142:143], v7 offset:58368
  s_waitcnt vmcnt(10) lgkmcnt(10)
  v_mfma_f32_16x16x32_bf16 v[48:51], v[112:115], a[216:219], v[48:51]
  buffer_load_dwordx4 a[176:179], v1, s[8:11], s31 offen offset:0 sc1
  v_mfma_f32_16x16x32_bf16 v[52:55], v[112:115], a[220:223], v[52:55]
  v_mfma_f32_16x16x32_bf16 v[60:63], v[116:119], a[220:223], v[60:63]
  buffer_load_dwordx4 a[180:183], v1, s[8:11], s31 offen offset:1024 sc1
  v_mfma_f32_16x16x32_bf16 v[56:59], v[116:119], a[216:219], v[56:59]
  s_waitcnt lgkmcnt(0)
  s_barrier
  v_mfma_f32_16x16x32_bf16 v[64:67], v[120:123], a[216:219], v[64:67]
  ds_read_b64_tr_b16 v[112:113], v10 offset:0
  ds_read_b64_tr_b16 v[114:115], v10 offset:1024
  v_mfma_f32_16x16x32_bf16 v[68:71], v[120:123], a[220:223], v[68:71]
  ds_read_b64_tr_b16 v[116:117], v11 offset:0
  ds_read_b64_tr_b16 v[118:119], v11 offset:1024
  v_mfma_f32_16x16x32_bf16 v[76:79], v[124:127], a[220:223], v[76:79]
  ds_read_b64_tr_b16 v[120:121], v12 offset:0
  ds_read_b64_tr_b16 v[122:123], v12 offset:1024
  s_add_u32 m0, s39, 49152
  v_mfma_f32_16x16x32_bf16 v[72:75], v[124:127], a[216:219], v[72:75]
  ds_read_b64_tr_b16 v[124:125], v13 offset:0
  ds_read_b64_tr_b16 v[126:127], v13 offset:1024
  v_mfma_f32_16x16x32_bf16 v[80:83], v[128:131], a[216:219], v[80:83]
  buffer_load_dwordx4 v18, s[4:7], s38 offen lds
  v_mfma_f32_16x16x32_bf16 v[84:87], v[128:131], a[220:223], v[84:87]
  ds_read_b64_tr_b16 v[128:129], v4 offset:0
  ds_read_b64_tr_b16 v[130:131], v4 offset:1024
  v_mfma_f32_16x16x32_bf16 v[92:95], v[132:135], a[220:223], v[92:95]
  s_add_u32 m0, s39, 50176
  v_mfma_f32_16x16x32_bf16 v[88:91], v[132:135], a[216:219], v[88:91]
  ds_read_b64_tr_b16 v[132:133], v5 offset:0
  ds_read_b64_tr_b16 v[134:135], v5 offset:1024
  v_mfma_f32_16x16x32_bf16 v[96:99], v[136:139], a[216:219], v[96:99]
  buffer_load_dwordx4 v19, s[4:7], s38 offen lds
  v_mfma_f32_16x16x32_bf16 v[100:103], v[136:139], a[220:223], v[100:103]
  ds_read_b64_tr_b16 v[136:137], v6 offset:0
  ds_read_b64_tr_b16 v[138:139], v6 offset:1024
  v_mfma_f32_16x16x32_bf16 v[108:111], v[140:143], a[220:223], v[108:111]
  v_mfma_f32_16x16x32_bf16 v[104:107], v[140:143], a[216:219], v[104:107]
  ds_read_b64_tr_b16 v[140:141], v7 offset:0
  ds_read_b64_tr_b16 v[142:143], v7 offset:1024
  s_sub_u32 s37, s37, 1
  s_cmp_lg_u32 s37, 1
  s_cbranch_scc1 L_g2_loop
  s_add_u32 m0, s39, 51200
  s_nop 0
  buffer_load_dwordx4 v20, s[4:7], s38 offen lds
  s_add_u32 m0, s39, 52224
  s_nop 0
  buffer_load_dwordx4 v21, s[4:7], s38 offen lds
  buffer_load_dwordx4 a[184:187], v1, s[8:11], s31 offen offset:2048 sc1
  buffer_load_dwordx4 a[188:191], v1, s[8:11], s31 offen offset:3072 sc1
  s_add_u32 s31, s31, 4096
  s_cmp_eq_u32 s31, 114688
  s_cselect_b32 s31, 0, s31
  s_add_u32 s32, s32, 1
  s_cmp_eq_u32 s32, 28
  s_cselect_b32 s31, s35, s31
  buffer_load_dwordx4 a[192:195], v1, s[8:11], s31 offen offset:0 sc1
  buffer_load_dwordx4 a[196:199], v1, s[8:11], s31 offen offset:1024 sc1
  buffer_load_dwordx4 a[200:203], v1, s[8:11], s31 offen offset:2048 sc1
  buffer_load_dwordx4 a[204:207], v1, s[8:11], s31 offen offset:3072 sc1
  s_add_u32 s31, s31, 4096
  s_cmp_eq_u32 s31, 114688
  s_cselect_b32 s31, 0, s31
  s_add_u32 s32, s32, 1
  s_cmp_eq_u32 s32, 28
  s_cselect_b32 s31, s35, s31
  buffer_load_dwordx4 a[208:211], v1, s[8:11], s31 offen offset:0 sc1
  buffer_load_dwordx4 a[212:215], v1, s[8:11], s31 offen offset:1024 sc1
  buffer_load_dwordx4 a[216:219], v1, s[8:11], s31 offen offset:2048 sc1
  buffer_load_dwordx4 a[220:223], v1, s[8:11], s31 offen offset:3072 sc1
  s_add_u32 s31, s31, 4096
  s_cmp_eq_u32 s31, 114688
  s_cselect_b32 s31, 0, s31
  s_add_u32 s32, s32, 1
  s_cmp_eq_u32 s32, 28
  s_cselect_b32 s31, s35, s31
  s_sub_u32 s24, s33, 4096
  s_xor_b32 s25, s24, 0x8000
  ds_read_b64_tr_b16 v[224:225], v4 offset:8192
  ds_read_b64_tr_b16 v[226:227], v4 offset:9216
  ds_read_b64_tr_b16 v[228:229], v5 offset:8192
  ds_read_b64_tr_b16 v[230:231], v5 offset:9216
  ds_read_b64_tr_b16 v[232:233], v6 offset:8192
  ds_read_b64_tr_b16 v[234:235], v6 offset:9216
  ds_read_b64_tr_b16 v[236:237], v7 offset:8192
  ds_read_b64_tr_b16 v[238:239], v7 offset:9216
  s_waitcnt vmcnt(16)
  s_barrier
  s_waitcnt lgkmcnt(8)
  v_mfma_f32_16x16x32_bf16 v[80:83], v[128:131], a[160:163], v[80:83]
  ds_read_b64_tr_b16 v[240:241], v4 offset:16384
  v_mfma_f32_16x16x32_bf16 v[84:87], v[128:131], a[164:167], v[84:87]
  ds_read_b64_tr_b16 v[242:243], v4 offset:17408
  v_mfma_f32_16x16x32_bf16 v[92:95], v[132:135], a[164:167], v[92:95]
  ds_read_b64_tr_b16 v[244:245], v5 offset:16384
  v_mfma_f32_16x16x32_bf16 v[88:91], v[132:135], a[160:163], v[88:91]
  ds_read_b64_tr_b16 v[246:247], v5 offset:17408
  v_mfma_f32_16x16x32_bf16 v[96:99], v[136:139], a[160:163], v[96:99]
  ds_read_b64_tr_b16 v[248:249], v6 offset:16384
  v_mfma_f32_16x16x32_bf16 v[100:103], v[136:139], a[164:167], v[100:103]
  ds_read_b64_tr_b16 v[250:251], v6 offset:17408
  v_mfma_f32_16x16x32_bf16 v[108:111], v[140:143], a[164:167], v[108:111]
  ds_read_b64_tr_b16 v[252:253], v7 offset:16384
  v_mfma_f32_16x16x32_bf16 v[104:107], v[140:143], a[160:163], v[104:107]
  ds_read_b64_tr_b16 v[254:255], v7 offset:17408
  s_waitcnt lgkmcnt(8)
  v_mfma_f32_16x16x32_bf16 v[80:83], v[224:227], a[168:171], v[80:83]
  ds_read_b64_tr_b16 v[208:209], v4 offset:24576
  v_mfma_f32_16x16x32_bf16 v[84:87], v[224:227], a[172:175], v[84:87]
  ds_read_b64_tr_b16 v[210:211], v4 offset:25600
  v_mfma_f32_16x16x32_bf16 v[92:95], v[228:231], a[172:175], v[92:95]
  ds_read_b64_tr_b16 v[212:213], v5 offset:24576
  v_mfma_f32_16x16x32_bf16 v[88:91], v[228:231], a[168:171], v[88:91]
  ds_read_b64_tr_b16 v[214:215], v5 offset:25600
  v_mfma_f32_16x16x32_bf16 v[96:99], v[232:235], a[168:171], v[96:99]
  ds_read_b64_tr_b16 v[216:217], v6 offset:24576
  v_mfma_f32_16x16x32_bf16 v[100:103], v[232:235], a[172:175], v[100:103]
  ds_read_b64_tr_b16 v[218:219], v6 offset:25600
  v_mfma_f32_16x16x32_bf16 v[108:111], v[236:239], a[172:175], v[108:111]
  ds_read_b64_tr_b16 v[220:221], v7 offset:24576
  v_mfma_f32_16x16x32_bf16 v[104:107], v[236:239], a[168:171], v[104:107]
  ds_read_b64_tr_b16 v[222:223], v7 offset:25600
  s_waitcnt vmcnt(14) lgkmcnt(8)
  v_mfma_f32_16x16x32_bf16 v[80:83], v[240:243], a[176:179], v[80:83]
  ds_read_b64_tr_b16 v[224:225], v4 offset:32768
  v_mfma_f32_16x16x32_bf16 v[84:87], v[240:243], a[180:183], v[84:87]
  ds_read_b64_tr_b16 v[226:227], v4 offset:33792
  v_mfma_f32_16x16x32_bf16 v[92:95], v[244:247], a[180:183], v[92:95]
  ds_read_b64_tr_b16 v[228:229], v5 offset:32768
  v_mfma_f32_16x16x32_bf16 v[88:91], v[244:247], a[176:179], v[88:91]
  ds_read_b64_tr_b16 v[230:231], v5 offset:33792
  v_mfma_f32_16x16x32_bf16 v[96:99], v[248:251], a[176:179], v[96:99]
  ds_read_b64_tr_b16 v[232:233], v6 offset:32768
  v_mfma_f32_16x16x32_bf16 v[100:103], v[248:251], a[180:183], v[100:103]
  ds_read_b64_tr_b16 v[234:235], v6 offset:33792
  v_mfma_f32_16x16x32_bf16 v[108:111], v[252:255], a[180:183], v[108:111]
  ds_read_b64_tr_b16 v[236:237], v7 offset:32768
  v_mfma_f32_16x16x32_bf16 v[104:107], v[252:255], a[176:179], v[104:107]
  ds_read_b64_tr_b16 v[238:239], v7 offset:33792
  s_waitcnt vmcnt(8) lgkmcnt(8)
  v_mfma_f32_16x16x32_bf16 v[80:83], v[208:211], a[184:187], v[80:83]
  ds_read_b64_tr_b16 v[240:241], v4 offset:40960
  v_mfma_f32_16x16x32_bf16 v[84:87], v[208:211], a[188:191], v[84:87]
  ds_read_b64_tr_b16 v[242:243], v4 offset:41984
  v_mfma_f32_16x16x32_bf16 v[92:95], v[212:215], a[188:191], v[92:95]
  ds_read_b64_tr_b16 v[244:245], v5 offset:40960
  v_mfma_f32_16x16x32_bf16 v[88:91], v[212:215], a[184:187], v[88:91]
  ds_read_b64_tr_b16 v[246:247], v5 offset:41984
  v_mfma_f32_16x16x32_bf16 v[96:99], v[216:219], a[184:187], v[96:99]
  ds_read_b64_tr_b16 v[248:249], v6 offset:40960
  v_mfma_f32_16x16x32_bf16 v[100:103], v[216:219], a[188:191], v[100:103]
  ds_read_b64_tr_b16 v[250:251], v6 offset:41984
  v_mfma_f32_16x16x32_bf16 v[108:111], v[220:223], a[188:191], v[108:111]
  ds_read_b64_tr_b16 v[252:253], v7 offset:40960
  v_mfma_f32_16x16x32_bf16 v[104:107], v[220:223], a[184:187], v[104:107]
  ds_read_b64_tr_b16 v[254:255], v7 offset:41984
  s_barrier
  s_waitcnt vmcnt(6) lgkmcnt(8)
  v_mfma_f32_16x16x32_bf16 v[80:83], v[224:227], a[192:195], v[80:83]
  ds_read_b64_tr_b16 v[208:209], v4 offset:49152
  v_mfma_f32_16x16x32_bf16 v[84:87], v[224:227], a[196:199], v[84:87]
  ds_read_b64_tr_b16 v[210:211], v4 offset:50176
  v_mfma_f32_16x16x32_bf16 v[92:95], v[228:231], a[196:199], v[92:95]
  ds_read_b64_tr_b16 v[212:213], v5 offset:49152
  v_mfma_f32_16x16x32_bf16 v[88:91], v[228:231], a[192:195], v[88:91]
  ds_read_b64_tr_b16 v[214:215], v5 offset:50176
  v_mfma_f32_16x16x32_bf16 v[96:99], v[232:235], a[192:195], v[96:99]
  ds_read_b64_tr_b16 v[216:217], v6 offset:49152
  v_mfma_f32_16x16x32_bf16 v[100:103], v[232:235], a[196:199], v[100:103]
  ds_read_b64_tr_b16 v[218:219], v6 offset:50176
  v_mfma_f32_16x16x32_bf16 v[108:111], v[236:239], a[196:199], v[108:111]
  ds_read_b64_tr_b16 v[220:221], v7 offset:49152
  v_mfma_f32_16x16x32_bf16 v[104:107], v[236:239], a[192:195], v[104:107]
  ds_read_b64_tr_b16 v[222:223], v7 offset:50176
  s_waitcnt vmcnt(4) lgkmcnt(8)
  v_mfma_f32_16x16x32_bf16 v[80:83], v[240:243], a[200:203], v[80:83]
  ds_read_b64_tr_b16 v[224:225], v4 offset:57344
  v_mfma_f32_16x16x32_bf16 v[84:87], v[240:243], a[204:207], v[84:87]
  ds_read_b64_tr_b16 v[226:227], v4 offset:58368
  v_mfma_f32_16x16x32_bf16 v[92:95], v[244:247], a[204:207], v[92:95]
  ds_read_b64_tr_b16 v[228:229], v5 offset:57344
  v_mfma_f32_16x16x32_bf16 v[88:91], v[244:247], a[200:203], v[88:91]
  ds_read_b64_tr_b16 v[230:231], v5 offset:58368
  v_mfma_f32_16x16x32_bf16 v[96:99], v[248:251], a[200:203], v[96:99]
  ds_read_b64_tr_b16 v[232:233], v6 offset:57344
  v_mfma_f32_16x16x32_bf16 v[100:103], v[248:251], a[204:207], v[100:103]
  ds_read_b64_tr_b16 v[234:235], v6 offset:58368
  v_mfma_f32_16x16x32_bf16 v[108:111], v[252:255], a[204:207], v[108:111]
  ds_read_b64_tr_b16 v[236:237], v7 offset:57344
  v_mfma_f32_16x16x32_bf16 v[104:107], v[252:255], a[200:203], v[104:107]
  ds_read_b64_tr_b16 v[238:239], v7 offset:58368
  s_waitcnt vmcnt(2) lgkmcnt(8)
  v_mfma_f32_16x16x32_bf16 v[80:83], v[208:211], a[208:211], v[80:83]
  v_mfma_f32_16x16x32_bf16 v[84:87], v[208:211], a[212:215], v[84:87]
  v_mfma_f32_16x16x32_bf16 v[92:95], v[212:215], a[212:215], v[92:95]
  v_mfma_f32_16x16x32_bf16 v[88:91], v[212:215], a[208:211], v[88:91]
  v_mfma_f32_16x16x32_bf16 v[96:99], v[216:219], a[208:211], v[96:99]
  v_mfma_f32_16x16x32_bf16 v[100:103], v[216:219], a[212:215], v[100:103]
  v_mfma_f32_16x16x32_bf16 v[108:111], v[220:223], a[212:215], v[108:111]
  v_mfma_f32_16x16x32_bf16 v[104:107], v[220:223], a[208:211], v[104:107]
  s_waitcnt vmcnt(0) lgkmcnt(0)
  v_mfma_f32_16x16x32_bf16 v[80:83], v[224:227], a[216:219], v[80:83]
  ds_read_b64_tr_b16 v[208:209], v10 offset:8192
  v_mfma_f32_16x16x32_bf16 v[84:87], v[224:227], a[220:223], v[84:87]
  ds_read_b64_tr_b16 v[210:211], v10 offset:9216
  v_mfma_f32_16x16x32_bf16 v[92:95], v[228:231], a[220:223], v[92:95]
  ds_read_b64_tr_b16 v[212:213], v11 offset:8192
  v_mfma_f32_16x16x32_bf16 v[88:91], v[228:231], a[216:219], v[88:91]
  ds_read_b64_tr_b16 v[214:215], v11 offset:9216
  v_mfma_f32_16x16x32_bf16 v[96:99], v[232:235], a[216:219], v[96:99]
  ds_read_b64_tr_b16 v[216:217], v12 offset:8192
  v_mfma_f32_16x16x32_bf16 v[100:103], v[232:235], a[220:223], v[100:103]
  ds_read_b64_tr_b16 v[218:219], v12 offset:9216
  v_mfma_f32_16x16x32_bf16 v[108:111], v[236:239], a[220:223], v[108:111]
  ds_read_b64_tr_b16 v[220:221], v13 offset:8192
  v_mfma_f32_16x16x32_bf16 v[104:107], v[236:239], a[216:219], v[104:107]
  ds_read_b64_tr_b16 v[222:223], v13 offset:9216
  s_waitcnt lgkmcnt(8)
  v_mfma_f32_16x16x32_bf16 v[48:51], v[112:115], a[160:163], v[48:51]
  ds_read_b64_tr_b16 v[224:225], v10 offset:16384
  v_mov_b32 v160, s46
  v_mfma_f32_16x16x32_bf16 v[52:55], v[112:115], a[164:167], v[52:55]
  ds_read_b64_tr_b16 v[226:227], v10 offset:17408
  v_mov_b32 v161, s47
  v_lshrrev_b32 v162, 1, v2
  v_mfma_f32_16x16x32_bf16 v[60:63], v[116:119], a[164:167], v[60:63]
  ds_read_b64_tr_b16 v[228:229], v11 offset:16384
  v_cvt_pk_bf16_f32 v144, v80, v81
  v_mfma_f32_16x16x32_bf16 v[56:59], v[116:119], a[160:163], v[56:59]
  ds_read_b64_tr_b16 v[230:231], v11 offset:17408
  v_cvt_pk_bf16_f32 v145, v82, v83
  v_xad_u32 v160, v144, v145, v160
  v_mfma_f32_16x16x32_bf16 v[64:67], v[120:123], a[160:163], v[64:67]
  ds_read_b64_tr_b16 v[232:233], v12 offset:16384
  v_add3_u32 v161, v161, v144, v145
  v_mfma_f32_16x16x32_bf16 v[68:71], v[120:123], a[164:167], v[68:71]
  ds_read_b64_tr_b16 v[234:235], v12 offset:17408
  v_cvt_pk_bf16_f32 v146, v84, v85
  v_cvt_pk_bf16_f32 v147, v86, v87
  v_mfma_f32_16x16x32_bf16 v[76:79], v[124:127], a[164:167], v[76:79]
  ds_read_b64_tr_b16 v[236:237], v13 offset:16384
  buffer_store_dwordx4 v[144:147], v1, s[12:15], s25 offen offset:0 sc1
  v_mfma_f32_16x16x32_bf16 v[72:75], v[124:127], a[160:163], v[72:75]
  ds_read_b64_tr_b16 v[238:239], v13 offset:17408
  v_xad_u32 v160, v146, v147, v160
  v_add3_u32 v161, v161, v146, v147
  s_waitcnt lgkmcnt(8)
  v_mfma_f32_16x16x32_bf16 v[48:51], v[208:211], a[168:171], v[48:51]
  ds_read_b64_tr_b16 v[240:241], v10 offset:24576
  v_cvt_pk_bf16_f32 v148, v88, v89
  v_cvt_pk_bf16_f32 v149, v90, v91
  v_mfma_f32_16x16x32_bf16 v[52:55], v[208:211], a[172:175], v[52:55]
  ds_read_b64_tr_b16 v[242:243], v10 offset:25600
  v_xad_u32 v160, v148, v149, v160
  v_add3_u32 v161, v161, v148, v149
  v_mfma_f32_16x16x32_bf16 v[60:63], v[212:215], a[172:175], v[60:63]
  ds_read_b64_tr_b16 v[244:245], v11 offset:24576
  v_cvt_pk_bf16_f32 v150, v92, v93
  v_cvt_pk_bf16_f32 v151, v94, v95
  v_mfma_f32_16x16x32_bf16 v[56:59], v[212:215], a[168:171], v[56:59]
  ds_read_b64_tr_b16 v[246:247], v11 offset:25600
  buffer_store_dwordx4 v[148:151], v1, s[12:15], s25 offen offset:1024 sc1
  v_xad_u32 v160, v150, v151, v160
  v_add3_u32 v161, v161, v150, v151
  v_mfma_f32_16x16x32_bf16 v[64:67], v[216:219], a[168:171], v[64:67]
  ds_read_b64_tr_b16 v[248:249], v12 offset:24576
  v_cvt_pk_bf16_f32 v152, v96, v97
  v_cvt_pk_bf16_f32 v153, v98, v99
  v_mfma_f32_16x16x32_bf16 v[68:71], v[216:219], a[172:175], v[68:71]
  ds_read_b64_tr_b16 v[250:251], v12 offset:25600
  v_xad_u32 v160, v152, v153, v160
  v_add3_u32 v161, v161, v152, v153
  v_mfma_f32_16x16x32_bf16 v[76:79], v[220:223], a[172:175], v[76:79]
  ds_read_b64_tr_b16 v[252:253], v13 offset:24576
  v_cvt_pk_bf16_f32 v154, v100, v101
  v_cvt_pk_bf16_f32 v155, v102, v103
  v_mfma_f32_16x16x32_bf16 v[72:75], v[220:223], a[168:171], v[72:75]
  ds_read_b64_tr_b16 v[254:255], v13 offset:25600
  buffer_store_dwordx4 v[152:155], v1, s[12:15], s25 offen offset:2048 sc1
  v_xad_u32 v160, v154, v155, v160
  v_add3_u32 v161, v161, v154, v155
  s_waitcnt lgkmcnt(8)
  v_mfma_f32_16x16x32_bf16 v[48:51], v[224:227], a[176:179], v[48:51]
  ds_read_b64_tr_b16 v[208:209], v10 offset:32768
  v_cvt_pk_bf16_f32 v156, v104, v105
  v_mfma_f32_16x16x32_bf16 v[52:55], v[224:227], a[180:183], v[52:55]
  ds_read_b64_tr_b16 v[210:211], v10 offset:33792
  v_cvt_pk_bf16_f32 v157, v106, v107
  v_mfma_f32_16x16x32_bf16 v[60:63], v[228:231], a[180:183], v[60:63]
  ds_read_b64_tr_b16 v[212:213], v11 offset:32768
  v_xad_u32 v160, v156, v157, v160
  v_mfma_f32_16x16x32_bf16 v[56:59], v[228:231], a[176:179], v[56:59]
  ds_read_b64_tr_b16 v[214:215], v11 offset:33792
  v_add3_u32 v161, v161, v156, v157
  v_cvt_pk_bf16_f32 v158, v108, v109
  v_mfma_f32_16x16x32_bf16 v[64:67], v[232:235], a[176:179], v[64:67]
  ds_read_b64_tr_b16 v[216:217], v12 offset:32768
  v_cvt_pk_bf16_f32 v159, v110, v111
  v_mfma_f32_16x16x32_bf16 v[68:71], v[232:235], a[180:183], v[68:71]
  ds_read_b64_tr_b16 v[218:219], v12 offset:33792
  buffer_store_dwordx4 v[156:159], v1, s[12:15], s25 offen offset:3072 sc1
  v_mfma_f32_16x16x32_bf16 v[76:79], v[236:239], a[180:183], v[76:79]
  ds_read_b64_tr_b16 v[220:221], v13 offset:32768
  v_xad_u32 v160, v158, v159, v160
  v_mfma_f32_16x16x32_bf16 v[72:75], v[236:239], a[176:179], v[72:75]
  ds_read_b64_tr_b16 v[222:223], v13 offset:33792
  v_add3_u32 v161, v161, v158, v159
  buffer_store_dwordx2 v[160:161], v162, s[12:15], s25 offen offset:2048 sc1
  s_waitcnt lgkmcnt(8)
  v_mfma_f32_16x16x32_bf16 v[48:51], v[240:243], a[184:187], v[48:51]
  ds_read_b64_tr_b16 v[224:225], v10 offset:40960
  v_mfma_f32_16x16x32_bf16 v[52:55], v[240:243], a[188:191], v[52:55]
  ds_read_b64_tr_b16 v[226:227], v10 offset:41984
  v_mfma_f32_16x16x32_bf16 v[60:63], v[244:247], a[188:191], v[60:63]
  ds_read_b64_tr_b16 v[228:229], v11 offset:40960
  v_mfma_f32_16x16x32_bf16 v[56:59], v[244:247], a[184:187], v[56:59]
  ds_read_b64_tr_b16 v[230:231], v11 offset:41984
  v_mfma_f32_16x16x32_bf16 v[64:67], v[248:251], a[184:187], v[64:67]
  ds_read_b64_tr_b16 v[232:233], v12 offset:40960
  v_mfma_f32_16x16x32_bf16 v[68:71], v[248:251], a[188:191], v[68:71]
  ds_read_b64_tr_b16 v[234:235], v12 offset:41984
  v_mfma_f32_16x16x32_bf16 v[76:79], v[252:255], a[188:191], v[76:79]
  ds_read_b64_tr_b16 v[236:237], v13 offset:40960
  v_mfma_f32_16x16x32_bf16 v[72:75], v[252:255], a[184:187], v[72:75]
  ds_read_b64_tr_b16 v[238:239], v13 offset:41984
  s_waitcnt lgkmcnt(8)
  v_mfma_f32_16x16x32_bf16 v[48:51], v[208:211], a[192:195], v[48:51]
  ds_read_b64_tr_b16 v[240:241], v10 offset:49152
  v_mfma_f32_16x16x32_bf16 v[52:55], v[208:211], a[196:199], v[52:55]
  ds_read_b64_tr_b16 v[242:243], v10 offset:50176
  v_mfma_f32_16x16x32_bf16 v[60:63], v[212:215], a[196:199], v[60:63]
  ds_read_b64_tr_b16 v[244:245], v11 offset:49152
  v_mfma_f32_16x16x32_bf16 v[56:59], v[212:215], a[192:195], v[56:59]
  ds_read_b64_tr_b16 v[246:247], v11 offset:50176
  v_mfma_f32_16x16x32_bf16 v[64:67], v[216:219], a[192:195], v[64:67]
  ds_read_b64_tr_b16 v[248:249], v12 offset:49152
  v_mfma_f32_16x16x32_bf16 v[68:71], v[216:219], a[196:199], v[68:71]
  ds_read_b64_tr_b16 v[250:251], v12 offset:50176
  v_mfma_f32_16x16x32_bf16 v[76:79], v[220:223], a[196:199], v[76:79]
  ds_read_b64_tr_b16 v[252:253], v13 offset:49152
  v_mfma_f32_16x16x32_bf16 v[72:75], v[220:223], a[192:195], v[72:75]
  ds_read_b64_tr_b16 v[254:255], v13 offset:50176
  s_waitcnt lgkmcnt(8)
  v_mfma_f32_16x16x32_bf16 v[48:51], v[224:227], a[200:203], v[48:51]
  ds_read_b64_tr_b16 v[208:209], v10 offset:57344
  v_mfma_f32_16x16x32_bf16 v[52:55], v[224:227], a[204:207], v[52:55]
  ds_read_b64_tr_b16 v[210:211], v10 offset:58368
  v_mfma_f32_16x16x32_bf16 v[60:63], v[228:231], a[204:207], v[60:63]
  ds_read_b64_tr_b16 v[212:213], v11 offset:57344
  v_mfma_f32_16x16x32_bf16 v[56:59], v[228:231], a[200:203], v[56:59]
  ds_read_b64_tr_b16 v[214:215], v11 offset:58368
  v_mfma_f32_16x16x32_bf16 v[64:67], v[232:235], a[200:203], v[64:67]
  ds_read_b64_tr_b16 v[216:217], v12 offset:57344
  v_mfma_f32_16x16x32_bf16 v[68:71], v[232:235], a[204:207], v[68:71]
  ds_read_b64_tr_b16 v[218:219], v12 offset:58368
  v_mfma_f32_16x16x32_bf16 v[76:79], v[236:239], a[204:207], v[76:79]
  ds_read_b64_tr_b16 v[220:221], v13 offset:57344
  v_mfma_f32_16x16x32_bf16 v[72:75], v[236:239], a[200:203], v[72:75]
  ds_read_b64_tr_b16 v[222:223], v13 offset:58368
  s_waitcnt lgkmcnt(8)
  v_mfma_f32_16x16x32_bf16 v[48:51], v[240:243], a[208:211], v[48:51]
  v_mfma_f32_16x16x32_bf16 v[52:55], v[240:243], a[212:215], v[52:55]
  v_mfma_f32_16x16x32_bf16 v[60:63], v[244:247], a[212:215], v[60:63]
  v_mfma_f32_16x16x32_bf16 v[56:59], v[244:247], a[208:211], v[56:59]
  v_mfma_f32_16x16x32_bf16 v[64:67], v[248:251], a[208:211], v[64:67]
  v_mfma_f32_16x16x32_bf16 v[68:71], v[248:251], a[212:215], v[68:71]
  v_mfma_f32_16x16x32_bf16 v[76:79], v[252:255], a[212:215], v[76:79]
  v_mfma_f32_16x16x32_bf16 v[72:75], v[252:255], a[208:211], v[72:75]
  s_waitcnt lgkmcnt(0)
  v_mfma_f32_16x16x32_bf16 v[48:51], v[208:211], a[216:219], v[48:51]
  v_mfma_f32_16x16x32_bf16 v[52:55], v[208:211], a[220:223], v[52:55]
  buffer_load_dwordx4 v[176:179], v1, s[12:15], s24 offen offset:0 sc1
  v_mfma_f32_16x16x32_bf16 v[60:63], v[212:215], a[220:223], v[60:63]
  v_mfma_f32_16x16x32_bf16 v[56:59], v[212:215], a[216:219], v[56:59]
  buffer_load_dwordx4 v[180:183], v1, s[12:15], s24 offen offset:1024 sc1
  v_mfma_f32_16x16x32_bf16 v[64:67], v[216:219], a[216:219], v[64:67]
  buffer_load_dwordx4 v[184:187], v1, s[12:15], s24 offen offset:2048 sc1
  v_mfma_f32_16x16x32_bf16 v[68:71], v[216:219], a[220:223], v[68:71]
  v_mfma_f32_16x16x32_bf16 v[76:79], v[220:223], a[220:223], v[76:79]
  buffer_load_dwordx4 v[188:191], v1, s[12:15], s24 offen offset:3072 sc1
  v_mfma_f32_16x16x32_bf16 v[72:75], v[220:223], a[216:219], v[72:75]
  buffer_load_dwordx2 v[192:193], v162, s[12:15], s24 offen offset:2048 sc1
  s_add_u32 s8, s60, 41943040
  s_addc_u32 s9, s61, 0
  s_mov_b32 s10, 8388608
  s_mov_b32 s11, 0x20000
  s_mov_b32 s31, s24
  s_mov_b32 s63, 0x40000
  s_branch L_exv98
L_exl96:
  s_sleep 4
  buffer_load_dwordx4 v[176:179], v1, s[12:15], s24 offen offset:0 sc1
  buffer_load_dwordx4 v[180:183], v1, s[12:15], s24 offen offset:1024 sc1
  buffer_load_dwordx4 v[184:187], v1, s[12:15], s24 offen offset:2048 sc1
  buffer_load_dwordx4 v[188:191], v1, s[12:15], s24 offen offset:3072 sc1
  buffer_load_dwordx2 v[192:193], v162, s[12:15], s24 offen offset:2048 sc1
L_exv98:
  v_mov_b32 v194, s46
  v_mov_b32 v195, s47
  s_waitcnt vmcnt(4)
  v_xad_u32 v194, v176, v177, v194
  v_add3_u32 v195, v195, v176, v177
  v_xad_u32 v194, v178, v179, v194
  v_add3_u32 v195, v195, v178, v179
  s_waitcnt vmcnt(3)
  v_xad_u32 v194, v180, v181, v194
  v_add3_u32 v195, v195, v180, v181
  v_xad_u32 v194, v182, v183, v194
  v_add3_u32 v195, v195, v182, v183
  s_waitcnt vmcnt(2)
  v_xad_u32 v194, v184, v185, v194
  v_add3_u32 v195, v195, v184, v185
  v_xad_u32 v194, v186, v187, v194
  v_add3_u32 v195, v195, v186, v187
  s_waitcnt vmcnt(1)
  v_xad_u32 v194, v188, v189, v194
  v_add3_u32 v195, v195, v188, v189
  v_xad_u32 v194, v190, v191, v194
  v_add3_u32 v195, v195, v190, v191
  s_waitcnt vmcnt(0)
  v_cmp_eq_u64 vcc, v[192:193], v[194:195]
  s_cmp_eq_u64 vcc, exec
  s_cbranch_scc1 L_exd97
  s_sub_u32 s63, s63, 1
  s_cmp_lg_u32 s63, 0
  s_cbranch_scc1 L_exl96
L_exd97:
  s_mov_b32 s20, s56
  s_mov_b32 s21, s57
  s_mov_b32 s22, 4194304
  s_mov_b32 s23, 0x20000
  s_mov_b32 s3, 0xffff0000
  v_lshlrev_b32 v196, 16, v176
  v_and_b32 v197, s3, v176
  v_lshlrev_b32 v198, 16, v177
  v_and_b32 v199, s3, v177
  v_pk_add_f32 v[48:49], v[48:49], v[196:197]
  v_pk_add_f32 v[50:51], v[50:51], v[198:199]
  v_lshlrev_b32 v196, 16, v178
  v_and_b32 v197, s3, v178
  v_lshlrev_b32 v198, 16, v179
  v_and_b32 v199, s3, v179
  v_pk_add_f32 v[52:53], v[52:53], v[196:197]
  v_pk_add_f32 v[54:55], v[54:55], v[198:199]
  v_lshlrev_b32 v196, 16, v180
  v_and_b32 v197, s3, v180
  v_lshlrev_b32 v198, 16, v181
  v_and_b32 v199, s3, v181
  v_pk_add_f32 v[56:57], v[56:57], v[196:197]
  v_pk_add_f32 v[58:59], v[58:59], v[198:199]
  v_lshlrev_b32 v196, 16, v182
  v_and_b32 v197, s3, v182
  v_lshlrev_b32 v198, 16, v183
  v_and_b32 v199, s3, v183
  v_pk_add_f32 v[60:61], v[60:61], v[196:197]
  v_pk_add_f32 v[62:63], v[62:63], v[198:199]
  v_lshlrev_b32 v196, 16, v184
  v_and_b32 v197, s3, v184
  v_lshlrev_b32 v198, 16, v185
  v_and_b32 v199, s3, v185
  v_pk_add_f32 v[64:65], v[64:65], v[196:197]
  v_pk_add_f32 v[66:67], v[66:67], v[198:199]
  v_lshlrev_b32 v196, 16, v186
  v_and_b32 v197, s3, v186
  v_lshlrev_b32 v198, 16, v187
  v_and_b32 v199, s3, v187
  v_pk_add_f32 v[68:69], v[68:69], v[196:197]
  v_pk_add_f32 v[70:71], v[70:71], v[198:199]
  v_lshlrev_b32 v196, 16, v188
  v_and_b32 v197, s3, v188
  v_lshlrev_b32 v198, 16, v189
  v_and_b32 v199, s3, v189
  v_pk_add_f32 v[72:73], v[72:73], v[196:197]
  v_pk_add_f32 v[74:75], v[74:75], v[198:199]
  v_lshlrev_b32 v196, 16, v190
  v_and_b32 v197, s3, v190
  v_lshlrev_b32 v198, 16, v191
  v_and_b32 v199, s3, v191
  v_pk_add_f32 v[76:77], v[76:77], v[196:197]
  v_pk_add_f32 v[78:79], v[78:79], v[198:199]
  v_cvt_pk_bf16_f32 v208, v48, v49
  v_cvt_pk_bf16_f32 v209, v50, v51
  v_cvt_pk_bf16_f32 v210, v56, v57
  v_cvt_pk_bf16_f32 v211, v58, v59
  s_nop 1
  v_permlane16_swap_b32 v208, v210
  v_permlane16_swap_b32 v209, v211
  buffer_store_dwordx4 v[208:211], v16, s[20:23], s48 offen offset:0
  v_cvt_pk_bf16_f32 v212, v64, v65
  v_cvt_pk_bf16_f32 v213, v66, v67
  v_cvt_pk_bf16_f32 v214, v72, v73
  v_cvt_pk_bf16_f32 v215, v74, v75
  s_nop 1
  v_permlane16_swap_b32 v212, v214
  v_permlane16_swap_b32 v213, v215
  buffer_store_dwordx4 v[212:215], v16, s[20:23], s48 offen offset:64
  v_cvt_pk_bf16_f32 v216, v52, v53
  v_cvt_pk_bf16_f32 v217, v54, v55
  v_cvt_pk_bf16_f32 v218, v60, v61
  v_cvt_pk_bf16_f32 v219, v62, v63
  s_nop 1
  v_permlane16_swap_b32 v216, v218
  v_permlane16_swap_b32 v217, v219
  buffer_store_dwordx4 v[216:219], v16, s[20:23], s49 offen offset:0
  v_cvt_pk_bf16_f32 v220, v68, v69
  v_cvt_pk_bf16_f32 v221, v70, v71
  v_cvt_pk_bf16_f32 v222, v76, v77
  v_cvt_pk_bf16_f32 v223, v78, v79
  s_nop 1
  v_permlane16_swap_b32 v220, v222
  v_permlane16_swap_b32 v221, v223
  buffer_store_dwordx4 v[220:223], v16, s[20:23], s49 offen offset:64
L_end:
  s_endpgm
.section .rodata,"a"
.p2align 6
.amdhsa_kernel parallel_sum__sliding_block__dense_activation_gelu__prompt_kernel
  .amdhsa_next_free_vgpr 512
  .amdhsa_next_free_sgpr 102
  .amdhsa_accum_offset 256
  .amdhsa_group_segment_fixed_size 0
  .amdhsa_kernarg_size 88
  .amdhsa_user_sgpr_count 2
  .amdhsa_user_sgpr_kernarg_segment_ptr 1
  .amdhsa_system_sgpr_workgroup_id_x 1
.end_amdhsa_kernel
```
